```python
import torch

def _softmax(x, axis=-1):
    return torch.softmax(x, dim=axis)
def _gelu(x):
    return torch.nn.functional.gelu(x, approximate="tanh")
def _silu(x):
    return torch.nn.functional.silu(x)
def _sigmoid(x):
    return torch.sigmoid(x)
def _layernorm(x, axis=-1, eps=1e-5):
    m = x.mean(dim=axis, keepdim=True)
    v = x.var(dim=axis, keepdim=True, unbiased=False)
    return (x - m) / torch.sqrt(v + eps)
def _scatter_add(tgt, idx, src, axis=0):
    return tgt.clone().index_add_(axis, idx, src)
def _segment_sum(src, seg, n):
    out = torch.zeros((n,) + src.shape[1:], dtype=src.dtype)
    return out.index_add_(0, seg, src)
def _pad(x, pw):
    flat = tuple(v for pair in reversed(pw) for v in pair)
    return torch.nn.functional.pad(x, flat)

kernel_name = 'parallel_sum__ssm_conv_s5__swiglu_ffn__prompt'

def setup_inputs():

    _w = (lambda a: (lambda t: t.to(torch.bfloat16) if t.is_floating_point() else t)(torch.as_tensor(a)))
    def _A_setup():
        B, S, D = 1, 2048, 640
        P = D
        Lambda_re = -0.5 * (lambda _x: torch.exp(torch.as_tensor(_x)))((lambda *s: torch.randn(*s, dtype=torch.bfloat16) * 0.8)(P))
        Lambda_im = (lambda *s: torch.randn(*s, dtype=torch.bfloat16) * 0.8)(P) * 1.0
        B_re = (lambda *s: torch.randn(*s, dtype=torch.bfloat16) * 0.8)(P, D) * (D ** -0.5)
        B_im = (lambda *s: torch.randn(*s, dtype=torch.bfloat16) * 0.8)(P, D) * (D ** -0.5)
        C_re = (lambda *s: torch.randn(*s, dtype=torch.bfloat16) * 0.8)(D, P) * (P ** -0.5)
        C_im = (lambda *s: torch.randn(*s, dtype=torch.bfloat16) * 0.8)(D, P) * (P ** -0.5)
        log_dt = (lambda *s: torch.randn(*s, dtype=torch.bfloat16) * 0.8)(P) * 0.3 - 2.0
        Dskip = (lambda *s: torch.randn(*s, dtype=torch.bfloat16) * 0.8)(D)
        return {
            "x": _w((lambda *s: torch.randn(*s, dtype=torch.bfloat16) * 0.05)(B, S, D)),
            "Lambda_re": _w(Lambda_re),
            "Lambda_im": _w(Lambda_im),
            "B_re": _w(B_re),
            "B_im": _w(B_im),
            "C_re": _w(C_re),
            "C_im": _w(C_im),
            "log_dt": _w(log_dt),
            "Dskip": _w(Dskip),
        }
    _A_in = _A_setup()

    def _B_setup():
        B, S, D, F = 1, 2048, 640, 1728
        return {
            "x": _w((lambda *s: torch.randn(*s, dtype=torch.bfloat16) * 0.05)(B, S, D)),
            "w_gate": _w((lambda *s: torch.randn(*s, dtype=torch.bfloat16) * 0.05)(D, F)),
            "w_up": _w((lambda *s: torch.randn(*s, dtype=torch.bfloat16) * 0.05)(D, F)),
            "w_down": _w((lambda *s: torch.randn(*s, dtype=torch.bfloat16) * 0.05)(F, D)),
        }
    _B_in = _B_setup()

    return {
        "A_x": _A_in["x"],
        "A_Lambda_re": _A_in["Lambda_re"],
        "A_Lambda_im": _A_in["Lambda_im"],
        "A_B_re": _A_in["B_re"],
        "A_B_im": _A_in["B_im"],
        "A_C_re": _A_in["C_re"],
        "A_C_im": _A_in["C_im"],
        "A_log_dt": _A_in["log_dt"],
        "A_Dskip": _A_in["Dskip"],
        "B_x": _B_in["x"],
        "B_w_gate": _B_in["w_gate"],
        "B_w_up": _B_in["w_up"],
        "B_w_down": _B_in["w_down"],
    }

def reference(A_x, A_Lambda_re, A_Lambda_im, A_B_re, A_B_im, A_C_re, A_C_im, A_log_dt, A_Dskip, B_x, B_w_gate, B_w_up, B_w_down):
    def _A_ref(x, Lambda_re, Lambda_im, B_re, B_im, C_re, C_im, log_dt, Dskip):
        Bsz, L, H = x.shape
        Lam = Lambda_re + 1j * Lambda_im
        Bmat = B_re + 1j * B_im
        Cmat = C_re + 1j * C_im
        dt = torch.exp(log_dt)
        Lam_bar = torch.exp(dt * Lam)
        B_bar = ((Lam_bar - 1.0) / Lam)[:, None] * Bmat
        Bu = torch.einsum("bld,pd->blp", x + 0j, B_bar)
        h = torch.zeros_like(Bu[:, 0, :])
        hs = []
        for t in range(L):
            h = Lam_bar[None, :] * h + Bu[:, t, :]
            hs.append(h)
        hseq = torch.stack(hs, 1)
        y = 2.0 * torch.einsum("blp,dp->bld", hseq, Cmat).real + x * Dskip[None, None, :]
        return y

    def _B_ref(x, w_gate, w_up, w_down):
        g = _silu(x @ w_gate)
        u = x @ w_up
        return (g * u) @ w_down

    x = A_x
    xn = _layernorm(x, axis=-1)
    return x + _A_ref(xn, A_Lambda_re, A_Lambda_im, A_B_re, A_B_im, A_C_re, A_C_im, A_log_dt, A_Dskip) + _B_ref(xn, B_w_gate, B_w_up, B_w_down)
```

```asm
; @launch grid=(256,1,1) block=(256,1,1) lds=163840
.amdgcn_target "amdgcn-amd-amdhsa--gfx950"
.text
.globl parallel_sum__ssm_conv_s5__swiglu_ffn__prompt_kernel
.p2align 8
.type parallel_sum__ssm_conv_s5__swiglu_ffn__prompt_kernel,@function
parallel_sum__ssm_conv_s5__swiglu_ffn__prompt_kernel:
    s_cmp_ge_u32 s2, 256
    s_cbranch_scc1 L_end
    s_load_dwordx16 s[4:19], s[0:1], 0
    s_load_dwordx16 s[20:35], s[0:1], 64
    v_lshrrev_b32 v1, 6, v0
    v_and_b32_e64 v0, 63, v0
    v_readfirstlane_b32 s64, v1
    s_and_b32 s92, s2, 7
    s_lshr_b32 s93, s2, 3
    s_lshr_b32 s65, s64, 1
    s_and_b32 s66, s64, 1
    s_getpc_b64 s[94:95]
L_pc:
    s_sub_u32 s94, s94, L_pc-parallel_sum__ssm_conv_s5__swiglu_ffn__prompt_kernel
    s_subb_u32 s95, s95, 0
    s_lshl_b32 s88, s64, 5
    s_add_u32 s88, s88, s93
    v_and_b32 v2, 3, v0
    v_lshl_add_u32 v2, s88, 2, v2
    v_lshlrev_b32_e64 v2, 7, v2
    v_min_u32 v2, L_last-parallel_sum__ssm_conv_s5__swiglu_ffn__prompt_kernel, v2
    v_mov_b32 v3, s95
    v_add_co_u32 v2, vcc, s94, v2
    s_nop 1
    v_addc_co_u32 v3, vcc, 0, v3, vcc
    global_load_dword v89, v[2:3], off
    s_and_b32 s94, s92, 3
    s_mul_i32 s94, s94, 31
    s_add_u32 s94, s94, s93
    s_lshr_b32 s95, s92, 2
    s_sub_u32 s88, 124, s95
    s_cmp_lt_u32 s94, s88
    s_cselect_b32 s73, 1, 0
    s_cmp_lt_u32 s93, 31
    s_cselect_b32 s73, s73, 0
    s_min_u32 s94, s94, 122
    s_mul_i32 s88, s95, 10
    s_sub_u32 s88, 70, s88
    s_cmp_ge_u32 s94, s88
    s_cselect_b32 s89, 1, 0
    s_cselect_b32 s88, s88, 0
    s_sub_u32 s94, s94, s88
    s_cmp_eq_u32 s2, 243
    s_cselect_b32 s88, 1, 0
    s_add_u32 s94, s94, s88
    s_mul_i32 s80, s94, 37
    s_lshr_b32 s80, s80, 8
    s_mul_i32 s81, s94, 43
    s_lshr_b32 s81, s81, 8
    s_cmp_eq_u32 s89, s95
    s_cselect_b32 s68, s80, s81
    s_cselect_b32 s88, 7, 6
    s_mul_i32 s67, s68, s88
    s_sub_u32 s67, s94, s67
    s_sub_u32 s88, 13, s88
    s_mul_i32 s88, s88, s95
    s_add_u32 s67, s67, s88
    s_mul_i32 s89, s89, 10
    s_add_u32 s68, s68, s89
    s_add_u32 s87, s67, s68
    s_and_b32 s89, s68, 1
    s_mul_i32 s89, s89, 10
    s_lshr_b32 s68, s68, 1
    s_add_u32 s68, s68, s89
    s_cmp_eq_u32 s73, 1
    s_cselect_b32 s68, s68, 18
    s_lshl_b32 s69, s67, 1
    s_add_u32 s69, s69, s65
    s_mov_b64 s[78:79], 0
    s_mul_i32 s95, s87, 86
    s_lshr_b32 s95, s95, 8
    s_mul_i32 s95, s95, 3
    s_sub_u32 s3, s87, s95
    s_mov_b32 s94, 528
    s_cmp_eq_u32 s3, 1
    s_cselect_b32 s94, 33, s94
    s_cmp_eq_u32 s3, 2
    s_cselect_b32 s94, 258, s94
    s_mov_b32 s95, 0
    s_lshl_b64 s[94:95], s[94:95], 0
    s_or_b64 s[78:79], s[78:79], s[94:95]
    s_mul_i32 s95, s87, 86
    s_lshr_b32 s95, s95, 8
    s_mul_i32 s95, s95, 3
    s_sub_u32 s3, s87, s95
    s_mov_b32 s94, 1347
    s_cmp_eq_u32 s3, 1
    s_cselect_b32 s94, 852, s94
    s_cmp_eq_u32 s3, 2
    s_cselect_b32 s94, 1077, s94
    s_mov_b32 s95, 0
    s_lshl_b64 s[94:95], s[94:95], 12
    s_or_b64 s[78:79], s[78:79], s[94:95]
    s_mul_i32 s95, s87, 64
    s_lshr_b32 s95, s95, 8
    s_mul_i32 s95, s95, 4
    s_sub_u32 s3, s87, s95
    s_mov_b32 s94, 39030
    s_cmp_eq_u32 s3, 1
    s_cselect_b32 s94, 27015, s94
    s_cmp_eq_u32 s3, 2
    s_cselect_b32 s94, 30360, s94
    s_cmp_eq_u32 s3, 3
    s_cselect_b32 s94, 34665, s94
    s_mov_b32 s95, 0
    s_lshl_b64 s[94:95], s[94:95], 24
    s_or_b64 s[78:79], s[78:79], s[94:95]
    s_sub_u32 s94, 0x99999999, s78
    s_sub_u32 s95, 0x99, s79
    s_bitcmp1_b32 s2, 2
    s_cselect_b64 s[78:79], s[94:95], s[78:79]
    v_lshrrev_b32 v66, 5, v0
    v_lshrrev_b32 v69, 3, v0
    v_and_b32 v70, 7, v0
    v_lshrrev_b32 v95, 4, v0
    v_xor_b32 v71, v70, v95
    v_lshlrev_b32 v71, 4, v71
    v_and_b32_e64 v73, 3, v69
    v_mad_u32_u24 v72, v66, 20, v73
    v_mul_u32_u24 v72, 1280, v72
    v_add_u32_e64 v72, v72, v71
    s_mul_i32 s94, s69, 101120
    s_lshl_b32 s95, s66, 6
    v_xor_b32 v72, s95, v72
    v_xor_b32_e64 v74, 64, v72
    s_mul_i32 s95, s66, 61440
    s_add_u32 s95, s95, s94
    s_add_u32 s95, s95, -1280
    v_add_u32 v1, s95, v72
    s_mul_i32 s95, s66, -35840
    s_add_u32 s95, s95, s94
    s_add_u32 s95, s95, 48896
    v_add_u32 v2, s95, v74
    v_add_u32 v3, 3072, v1
    v_add_u32 v4, 3072, v2
    v_add_u32 v5, 10240, v1
    s_cmp_lt_u32 s68, 10
    s_cselect_b32 s89, 1, 0
    s_cmp_eq_u32 s65, 0
    s_cselect_b32 s89, s89, 0
    s_sub_u32 s95, s68, 10
    s_min_u32 s88, s68, 17
    s_add_u32 s88, s88, 9
    s_cmp_eq_u32 s65, 0
    s_cselect_b32 s95, s95, s88
    s_cmp_eq_u32 s66, 0
    s_cselect_b32 s90, 0xffffff00, -1
    s_mov_b32 s91, -1
    s_add_u32 s42, s68, s65
    s_cmp_lt_u32 s42, 19
    s_cselect_b32 s42, 2211840, 0
    s_mov_b32 s43, 0x20000
    s_cmp_eq_u32 s89, 1
    s_cbranch_scc1 L_woffS
    v_mul_u32_u24 v72, 3456, v69
    v_and_b32 v73, 2, v69
    v_xor_b32_e64 v73, v73, v70
    v_lshl_add_u32 v72, v73, 4, v72
    s_lshl_b32 s95, s95, 7
    v_add_u32 v11, s95, v72
    v_xor_b32_e64 v74, 64, v11
    v_add_u32 v12, 26624, v74
    v_add_u32 v13, 53248, v11
    v_add_u32 v14, 79872, v74
    s_mov_b32 s83, 221184
    s_mov_b32 s84, 110592
    s_branch L_woffD
L_woffS:
    s_mov_b32 s42, 819200
    v_and_b32 v73, 3, v69
    v_lshl_add_u32 v72, v66, 3, v73
    v_mul_u32_u24 v72, 1280, v72
    v_add_u32_e64 v72, v72, v71
    s_mul_i32 s95, s68, 81920
    v_add_u32 v11, s95, v72
    v_xor_b32 v74, 64, v11
    v_add_u32 v12, 19456, v74
    v_add_u32 v13, 3072, v11
    v_add_u32 v14, 22528, v74
    s_mov_b32 s83, 128
    s_mov_b32 s84, 40960
L_woffD:
    s_lshl_b32 s85, s64, 13
    s_mul_i32 s86, s64, 5120
    s_waitcnt lgkmcnt(0)
    s_load_dword s72, s[34:35], 0
    s_mov_b32 s36, s4
    s_mov_b32 s37, s5
    s_mov_b32 s38, 2621440
    s_mov_b32 s39, 0x20000
    s_cmp_eq_u32 s66, 0
    s_cselect_b64 s[40:41], s[24:25], s[26:27]
    s_cselect_b64 s[56:57], s[10:11], s[12:13]
    s_cselect_b64 s[52:53], s[14:15], s[16:17]
    s_cmp_eq_u32 s83, 128
    s_cselect_b64 s[40:41], s[56:57], s[40:41]
    s_cmp_eq_u32 s73, 0
    s_cbranch_scc1 L_nodma
    s_bfe_u32 s92, s78, 262144
    s_lshl_b32 s80, s92, 7
    s_add_u32 m0, s86, 98304
    s_mov_b64 exec, s[90:91]
    buffer_load_dwordx4 v1, s[36:39], s80 offen offset:0 lds
    s_mov_b64 exec, -1
    buffer_load_dwordx4 v2, s[36:39], s80 offen offset:1024 lds
    buffer_load_dwordx4 v3, s[36:39], s80 offen offset:2048 lds
    buffer_load_dwordx4 v4, s[36:39], s80 offen offset:3072 lds
    s_add_u32 m0, s86, 102400
    s_nop 0
    buffer_load_dwordx4 v5, s[36:39], s80 offen offset:0 lds
    s_bfe_u32 s92, s78, 262144
    s_mul_i32 s81, s92, s83
    s_add_u32 m0, s85, 0
    s_nop 0
    buffer_load_dwordx4 v11, s[40:43], s81 offen offset:0 lds
    buffer_load_dwordx4 v12, s[40:43], s81 offen offset:1024 lds
    buffer_load_dwordx4 v13, s[40:43], s81 offen offset:2048 lds
L_nodma:
    s_and_b32 s92, s2, 7
    s_mul_i32 s94, s93, 9
    s_mul_i32 s95, s94, 529
    s_lshr_b32 s95, s95, 14
    s_mul_i32 s95, s95, 31
    s_sub_u32 s95, s94, s95
    s_lshr_b32 s94, s92, 1
    s_mul_i32 s88, s94, s94
    s_mul_i32 s94, s94, 31
    s_add_u32 s94, s94, s95
    s_add_u32 s88, s88, 125
    s_cmp_lt_u32 s92, 6
    s_cselect_b32 s88, s88, 124
    s_cmp_eq_u32 s93, 31
    s_cselect_b32 s94, s88, s94
    s_mul_i32 s70, s94, 103
    s_lshr_b32 s70, s70, 9
    s_mul_i32 s95, s70, 5
    s_sub_u32 s71, s94, s95
    s_and_b32 s95, s92, 1
    s_mul_i32 s95, s95, 5
    s_add_u32 s71, s71, s95
    s_mov_b32 s88, 0
    s_cmp_eq_u32 s71, 2
    s_cselect_b32 s88, 17164, s88
    s_cmp_eq_u32 s71, 3
    s_cselect_b32 s88, 74881, s88
    s_cmp_eq_u32 s71, 7
    s_cselect_b32 s88, 73798, s88
    s_cmp_eq_u32 s71, 8
    s_cselect_b32 s88, 147729, s88
    s_bfm_b32 s95, s70, 0
    s_and_b32 s95, s95, s88
    s_bcnt1_i32_b32 s82, s95
    s_bitcmp1_b32 s88, s70
    s_cselect_b32 s82, s82, 32
    s_lshl_b32 s94, s92, 5
    s_add_u32 s94, s94, s93
    s_lshl_b32 s94, s94, 2
    s_add_u32 s94, s94, s64
    s_lshl_b32 s100, s94, 1
    s_mul_i32 s101, s100, 1280
    v_mul_u32_u24 v67, 1280, v66
    v_and_b32 v68, 31, v0
    v_lshl_add_u32 v67, v68, 3, v67
    v_add_u32 v94, s100, v66
    v_add_u32 v88, s101, v67
    s_mov_b32 s44, s34
    s_mov_b32 s45, s35
    s_mov_b32 s46, 1572864
    s_mov_b32 s47, 0x20000
    s_add_u32 s48, s34, 1572864
    s_addc_u32 s49, s35, 0
    s_mov_b32 s50, 12513280
    s_mov_b32 s51, 0x20000
    s_mov_b32 s54, 819200
    s_mov_b32 s55, 0x20000
    s_mov_b32 s96, s28
    s_mov_b32 s97, s29
    s_mov_b32 s98, 2211840
    s_mov_b32 s99, 0x20000
    s_sub_u32 s60, s36, 1280
    s_subb_u32 s61, s37, 0
    s_mov_b32 s62, 2622720
    s_mov_b32 s63, 0x20000
    s_mov_b32 s56, s20
    s_mov_b32 s57, s21
    s_mov_b32 s58, 1280
    s_mov_b32 s59, 0x20000
    v_lshrrev_b32_e64 v73, 3, v0
    v_mul_u32_u24 v73, 10240, v73
    v_lshl_add_u32 v73, v70, 4, v73
    v_add_u32 v73, 98304, v73
    v_mov_b32 v76, 0x3f803f80
    v_mov_b32 v77, 0x3f803f80
    v_mov_b32 v78, 0x3f803f80
    v_mov_b32 v79, 0x3f803f80
    s_mov_b32 exec_hi, 0xffff
    ds_write_b128 v73, v[76:79]
    s_mov_b32 exec_hi, -1
    v_and_b32 v73, 15, v0
    v_lshrrev_b32 v76, 1, v73
    v_xor_b32 v76, v76, v95
    v_lshlrev_b32_e64 v76, 4, v76
    v_lshl_add_u32 v93, v73, 7, v76
    s_mul_i32 s93, s65, 10240
    s_add_u32 s93, s93, 98304
    v_add_u32 v23, s93, v93
    v_xor_b32 v24, 64, v23
    s_lshl_b32 s93, s66, 12
    v_add_u32 v25, s93, v93
    v_xor_b32 v26, 64, v25
    v_lshrrev_b32 v74, 2, v73
    v_and_b32_e64 v75, 3, v0
    v_lshl_add_u32 v76, v95, 3, v74
    v_lshlrev_b32_e64 v76, 7, v76
    v_lshl_add_u32 v76, v75, 3, v76
    v_bfe_u32 v77, v0, 3, 2
    s_lshl_b32 s93, s66, 1
    v_xor_b32 v78, s93, v77
    v_lshl_add_u32 v27, v78, 5, v76
    v_xor_b32 v28, 32, v27
    v_lshrrev_b32 v76, 2, v0
    v_lshlrev_b32_e64 v76, 7, v76
    v_lshl_add_u32 v76, v75, 3, v76
    v_lshl_add_u32 v92, v77, 5, v76
    v_mul_u32_u24 v76, 1280, v69
    v_and_b32 v77, 6, v69
    v_xor_b32 v77, v77, v70
    v_lshl_add_u32 v77, v77, 4, v76
    s_lshl_b32 s93, s71, 7
    v_add_u32 v15, s93, v77
    v_add_u32 v16, 9216, v15
    v_add_u32 v17, 18432, v15
    v_add_u32 v18, 27648, v15
    v_add_u32_e64 v76, v76, v71
    s_mul_i32 s93, s71, 81920
    v_add_u32 v19, s93, v76
    v_xor_b32 v77, 64, v19
    v_add_u32 v20, 9216, v77
    v_add_u32 v21, 18432, v19
    v_add_u32 v22, 27648, v77
    v_mad_u32_u24 v80, v74, 20, v75
    s_mul_i32 s93, s69, 481280
    v_lshl_add_u32 v6, v0, 4, s93
    v_add_u32 v7, 1024, v6
    v_add_u32 v8, 2048, v6
    v_add_u32 v9, 3072, v6
    v_add_u32 v10, 4096, v6
    s_add_u32 s93, s70, s71
    s_mul_i32 s94, s93, 52
    s_lshr_b32 s94, s94, 8
    s_mul_i32 s94, s94, 5
    s_sub_u32 s93, s93, s94
    s_mov_b32 s94, 106181136
    s_mov_b32 s95, 17185
    s_cmp_eq_u32 s93, 1
    s_cselect_b32 s94, 106181136, s94
    s_cselect_b32 s95, 17185, s95
    s_cmp_eq_u32 s93, 2
    s_cselect_b32 s94, 106181136, s94
    s_cselect_b32 s95, 17185, s95
    s_cmp_eq_u32 s93, 3
    s_cselect_b32 s94, 106181136, s94
    s_cselect_b32 s95, 17185, s95
    s_cmp_eq_u32 s93, 4
    s_cselect_b32 s94, 106181136, s94
    s_cselect_b32 s95, 17185, s95
    v_lshlrev_b32 v78, 2, v73
    v_lshrrev_b64 v[76:77], v78, s[94:95]
    v_cmp_lt_u32 vcc, 6, v73
    v_and_b32_e64 v79, 15, v76
    s_add_u32 s93, s64, 9
    v_lshl_add_u32 v76, v79, 2, s93
    v_subrev_u32 v77, 27, v76
    v_min_u32 v77, v77, v76
    v_cmp_eq_u32 s[94:95], 36, v76
    v_lshl_add_u32 v78, v79, 1, s65
    v_mul_u32_u24 v90, 81920, v77
    v_cndmask_b32 v77, v77, 27, s[94:95]
    v_lshlrev_b32 v76, 7, v78
    v_cndmask_b32 v90, v90, v76, vcc
    v_mul_u32_u24 v76, 40960, v95
    v_add_u32 v90, v90, v76
    s_mul_i32 s93, s66, 10
    s_add_u32 s93, s93, 27
    v_add_u32 v78, s93, v78
    v_cndmask_b32_e64 v77, v77, v78, vcc
    v_mul_u32_u24 v91, 10240, v77
    v_add_u32 v84, 65536, v25
    v_add_u32 v85, 65536, v26
    v_add_u32 v86, 65536, v27
    v_add_u32 v87, 65536, v28
    s_lshl_b32 s93, s2, 1
    s_add_u32 s93, s93, s65
    s_mul_i32 s94, s93, 13
    v_min_u32 v82, 12, v0
    v_add_lshl_u32 v82, v82, s94, 7
    s_lshl_b32 s93, s93, 1
    s_add_u32 s93, s93, s66
    s_mul_i32 s94, s93, 18
    v_min_u32 v83, 17, v0
    v_add_lshl_u32 v83, v83, s94, 7
    s_min_u32 s93, s68, 17
    s_add_u32 s94, s93, 9
    s_lshl_b32 s94, s94, 1
    s_add_u32 s94, s94, s66
    s_mul_i32 s101, s94, 5120
    s_and_b32 s94, s93, 3
    s_lshl_b32 s94, s94, 11
    s_and_b32 s95, s93, 28
    s_lshl_b32 s95, s95, 6
    s_add_u32 s77, s94, s95
    s_add_u32 s93, s68, 8
    s_and_b32 s94, s93, 3
    s_lshl_b32 s94, s94, 11
    s_and_b32 s95, s93, 28
    s_lshl_b32 s95, s95, 6
    s_add_u32 s76, s94, s95
    s_and_b32 s94, s68, 1
    s_add_u32 s94, s94, 4
    s_lshl_b32 s94, s94, 11
    s_lshr_b32 s95, s68, 1
    s_lshl_b32 s95, s95, 8
    s_add_u32 s94, s94, s95
    s_add_u32 s95, s68, 27
    s_sub_u32 s93, s68, 10
    s_cmp_lt_u32 s68, 10
    s_cselect_b32 s76, s94, s76
    s_cselect_b32 s93, s95, s93
    s_lshl_b32 s93, s93, 1
    s_add_u32 s93, s93, s66
    s_mul_i32 s100, s93, 5120
    s_mul_i32 s93, s69, 12288
    s_lshl_b32 s94, s66, 7
    s_add_u32 s93, s93, s94
    s_add_u32 s93, s93, 344064
    s_add_u32 s76, s76, s93
    s_add_u32 s77, s77, s93
    s_mul_i32 s93, s69, 79
    s_sub_u32 s93, s93, 1
    v_add_u32 v80, s93, v80
    v_mov_b32 v79, 2047
    v_add_u32_e64 v76, 0, v80
    v_med3_i32 v76, v76, 0, v79
    v_lshlrev_b32 v33, 3, v76
    v_add_u32 v76, 4, v80
    v_med3_i32 v76, v76, 0, v79
    v_lshlrev_b32 v37, 3, v76
    v_add_u32 v76, 8, v80
    v_med3_i32 v76, v76, 0, v79
    v_lshlrev_b32 v41, 3, v76
    v_add_u32 v76, 12, v80
    v_med3_i32 v76, v76, 0, v79
    v_lshlrev_b32 v45, 3, v76
    v_add_u32 v76, 16, v80
    v_med3_i32 v76, v76, 0, v79
    v_lshlrev_b32_e64 v49, 3, v76
    s_cmp_eq_u32 s73, 0
    s_cbranch_scc1 L_helper
    buffer_load_dwordx4 v14, s[40:43], s81 offen offset:3072 lds
    s_add_u32 s81, s81, s84
    s_add_u32 m0, s85, 4096
    s_nop 0
    buffer_load_dwordx4 v11, s[40:43], s81 offen offset:0 lds
    buffer_load_dwordx4 v12, s[40:43], s81 offen offset:1024 lds
    buffer_load_dwordx4 v13, s[40:43], s81 offen offset:2048 lds
    buffer_load_dwordx4 v14, s[40:43], s81 offen offset:3072 lds
    s_mov_b64 exec, 0
    s_cmp_lt_u32 s68, 10
    s_cbranch_scc1 L_hopS
    s_cmp_eq_u32 s64, 0
    s_cbranch_scc1 L_pad1
    s_cmp_eq_u32 s64, 1
    s_cbranch_scc1 L_pad2
    s_cmp_eq_u32 s64, 2
    s_cbranch_scc1 L_pad3
    s_branch L_pad4
L_hopS:
    s_cmp_eq_u32 s64, 0
    s_cbranch_scc1 L_pad6
    s_cmp_eq_u32 s64, 1
    s_cbranch_scc1 L_pad7
    s_cmp_eq_u32 s64, 2
    s_cbranch_scc1 L_pad8
    s_branch L_pad9
L_hopend:
    s_mov_b64 exec, -1
    s_bfe_u32 s92, s78, 262148
    s_lshl_b32 s80, s92, 7
    s_add_u32 m0, s86, 118784
    s_mov_b64 exec, s[90:91]
    buffer_load_dwordx4 v1, s[36:39], s80 offen offset:0 lds
    s_mov_b64 exec, -1
    buffer_load_dwordx4 v2, s[36:39], s80 offen offset:1024 lds
    buffer_load_dwordx4 v3, s[36:39], s80 offen offset:2048 lds
    buffer_load_dwordx4 v4, s[36:39], s80 offen offset:3072 lds
    s_add_u32 m0, s86, 122880
    s_nop 0
    buffer_load_dwordx4 v5, s[36:39], s80 offen offset:0 lds
    s_bfe_u32 s92, s78, 262148
    s_mul_i32 s81, s92, s83
    s_add_u32 m0, s85, 32768
    s_nop 0
    buffer_load_dwordx4 v11, s[40:43], s81 offen offset:0 lds
    buffer_load_dwordx4 v12, s[40:43], s81 offen offset:1024 lds
    buffer_load_dwordx4 v13, s[40:43], s81 offen offset:2048 lds
    s_cmp_lt_u32 s68, 10
    s_cbranch_scc1 L_g1S
    s_branch L_g1F
.p2align 12
L_g1F:
L_pad1:
    s_cbranch_execz L_pad5
    s_nop 0
    s_waitcnt vmcnt(8) lgkmcnt(0)
    s_barrier
    ds_read_b128 a[0:3], v23 offset:0
    ds_read_b128 a[4:7], v23 offset:2048
    ds_read_b128 a[8:11], v23 offset:4096
    ds_read_b128 a[12:15], v23 offset:6144
    ds_read_b128 a[16:19], v23 offset:8192
    ds_read_b64_tr_b16 a[36:37], v27 offset:16384
    ds_read_b64_tr_b16 a[38:39], v27 offset:16896
    ds_read_b64_tr_b16 a[40:41], v28 offset:16384
    ds_read_b64_tr_b16 a[42:43], v28 offset:16896
    ds_read_b64_tr_b16 a[44:45], v27 offset:24576
    ds_read_b64_tr_b16 a[46:47], v27 offset:25088
    ds_read_b64_tr_b16 a[48:49], v28 offset:24576
    ds_read_b64_tr_b16 a[50:51], v28 offset:25088
    ds_read_b64_tr_b16 a[20:21], v27 offset:0
    ds_read_b64_tr_b16 a[22:23], v27 offset:512
    ds_read_b64_tr_b16 a[24:25], v28 offset:0
    ds_read_b64_tr_b16 a[26:27], v28 offset:512
    ds_read_b64_tr_b16 a[28:29], v27 offset:8192
    ds_read_b64_tr_b16 a[30:31], v27 offset:8704
    ds_read_b64_tr_b16 a[32:33], v28 offset:8192
    ds_read_b64_tr_b16 a[34:35], v28 offset:8704
    s_waitcnt lgkmcnt(0)
    v_mfma_f32_16x16x32_bf16 v[96:99], a[36:39], a[0:3], 0
    ds_read_b128 a[52:55], v24 offset:0
    v_mfma_f32_16x16x32_bf16 v[100:103], a[36:39], a[4:7], 0
    buffer_load_dwordx4 v14, s[40:43], s81 offen offset:3072 lds
    v_mfma_f32_16x16x32_bf16 v[104:107], a[36:39], a[8:11], 0
    ds_read_b128 a[56:59], v24 offset:2048
    s_add_u32 s81, s81, s84
    v_mfma_f32_16x16x32_bf16 v[108:111], a[36:39], a[12:15], 0
    ds_read_b128 a[60:63], v24 offset:4096
    s_add_u32 m0, s85, 36864
    v_mfma_f32_16x16x32_bf16 v[112:115], a[36:39], a[16:19], 0
    ds_read_b128 a[64:67], v24 offset:6144
    v_mfma_f32_16x16x32_bf16 v[116:119], a[40:43], a[0:3], 0
    buffer_load_dwordx4 v11, s[40:43], s81 offen offset:0 lds
    v_mfma_f32_16x16x32_bf16 v[120:123], a[40:43], a[4:7], 0
    ds_read_b128 a[68:71], v24 offset:8192
    v_mfma_f32_16x16x32_bf16 v[124:127], a[40:43], a[8:11], 0
    buffer_load_dwordx4 v12, s[40:43], s81 offen offset:1024 lds
    v_mfma_f32_16x16x32_bf16 v[128:131], a[40:43], a[12:15], 0
    ds_read_b64_tr_b16 a[88:89], v27 offset:20480
    v_mfma_f32_16x16x32_bf16 v[132:135], a[40:43], a[16:19], 0
    ds_read_b64_tr_b16 a[90:91], v27 offset:20992
    v_mfma_f32_16x16x32_bf16 v[136:139], a[44:47], a[0:3], 0
    buffer_load_dwordx4 v13, s[40:43], s81 offen offset:2048 lds
    v_mfma_f32_16x16x32_bf16 v[140:143], a[44:47], a[4:7], 0
    ds_read_b64_tr_b16 a[92:93], v28 offset:20480
    v_mfma_f32_16x16x32_bf16 v[144:147], a[44:47], a[8:11], 0
    ds_read_b64_tr_b16 a[94:95], v28 offset:20992
    v_mfma_f32_16x16x32_bf16 v[148:151], a[44:47], a[12:15], 0
    buffer_load_dwordx4 v14, s[40:43], s81 offen offset:3072 lds
    v_mfma_f32_16x16x32_bf16 v[152:155], a[44:47], a[16:19], 0
    ds_read_b64_tr_b16 a[96:97], v27 offset:28672
    v_mfma_f32_16x16x32_bf16 v[156:159], a[48:51], a[0:3], 0
    ds_read_b64_tr_b16 a[98:99], v27 offset:29184
    s_bfe_u32 s92, s78, 262152
    v_mfma_f32_16x16x32_bf16 v[160:163], a[48:51], a[4:7], 0
    ds_read_b64_tr_b16 a[100:101], v28 offset:28672
    s_lshl_b32 s80, s92, 7
    s_add_u32 m0, s86, 139264
    v_mfma_f32_16x16x32_bf16 v[164:167], a[48:51], a[8:11], 0
    ds_read_b64_tr_b16 a[102:103], v28 offset:29184
    v_mfma_f32_16x16x32_bf16 v[168:171], a[48:51], a[12:15], 0
    s_mov_b64 exec, s[90:91]
    buffer_load_dwordx4 v1, s[36:39], s80 offen offset:0 lds
    s_mov_b64 exec, -1
    v_mfma_f32_16x16x32_bf16 v[172:175], a[48:51], a[16:19], 0
    ds_read_b64_tr_b16 a[72:73], v27 offset:4096
    v_mfma_f32_16x16x32_bf16 v[176:179], a[20:23], a[0:3], 0
    ds_read_b64_tr_b16 a[74:75], v27 offset:4608
    v_mfma_f32_16x16x32_bf16 v[180:183], a[20:23], a[4:7], 0
    buffer_load_dwordx4 v2, s[36:39], s80 offen offset:1024 lds
    v_mfma_f32_16x16x32_bf16 v[184:187], a[20:23], a[8:11], 0
    ds_read_b64_tr_b16 a[76:77], v28 offset:4096
    v_mfma_f32_16x16x32_bf16 v[188:191], a[20:23], a[12:15], 0
    ds_read_b64_tr_b16 a[78:79], v28 offset:4608
    v_mfma_f32_16x16x32_bf16 v[192:195], a[20:23], a[16:19], 0
    buffer_load_dwordx4 v3, s[36:39], s80 offen offset:2048 lds
    v_mfma_f32_16x16x32_bf16 v[196:199], a[24:27], a[0:3], 0
    ds_read_b64_tr_b16 a[80:81], v27 offset:12288
    v_mfma_f32_16x16x32_bf16 v[200:203], a[24:27], a[4:7], 0
    ds_read_b64_tr_b16 a[82:83], v27 offset:12800
    v_mfma_f32_16x16x32_bf16 v[204:207], a[24:27], a[8:11], 0
    buffer_load_dwordx4 v4, s[36:39], s80 offen offset:3072 lds
    v_mfma_f32_16x16x32_bf16 v[208:211], a[24:27], a[12:15], 0
    ds_read_b64_tr_b16 a[84:85], v28 offset:12288
    s_add_u32 m0, s86, 143360
    v_mfma_f32_16x16x32_bf16 v[212:215], a[24:27], a[16:19], 0
    ds_read_b64_tr_b16 a[86:87], v28 offset:12800
    v_mfma_f32_16x16x32_bf16 v[216:219], a[28:31], a[0:3], 0
    buffer_load_dwordx4 v5, s[36:39], s80 offen offset:0 lds
    v_mfma_f32_16x16x32_bf16 v[220:223], a[28:31], a[4:7], 0
    s_mul_i32 s72, s72, 1664525
    s_add_u32 s72, s72, 1013904223
    v_mfma_f32_16x16x32_bf16 v[224:227], a[28:31], a[8:11], 0
    s_bfe_u32 s92, s78, 262152
    v_mov_b32_e64 v29, s72
    s_mul_i32 s81, s92, s83
    v_mfma_f32_16x16x32_bf16 v[228:231], a[28:31], a[12:15], 0
    s_add_u32 m0, s85, 65536
    v_mfma_f32_16x16x32_bf16 v[232:235], a[28:31], a[16:19], 0
    buffer_load_dwordx4 v11, s[40:43], s81 offen offset:0 lds
    v_mfma_f32_16x16x32_bf16 v[236:239], a[32:35], a[0:3], 0
    v_mfma_f32_16x16x32_bf16 v[240:243], a[32:35], a[4:7], 0
    v_mfma_f32_16x16x32_bf16 v[244:247], a[32:35], a[8:11], 0
    buffer_load_dwordx4 v12, s[40:43], s81 offen offset:1024 lds
    v_mfma_f32_16x16x32_bf16 v[248:251], a[32:35], a[12:15], 0
    v_mfma_f32_16x16x32_bf16 v[252:255], a[32:35], a[16:19], 0
    s_waitcnt vmcnt(7) lgkmcnt(0)
    s_barrier
    v_mfma_f32_16x16x32_bf16 v[96:99], a[88:91], a[52:55], v[96:99]
    ds_read_b128 a[0:3], v23 offset:20480
    v_mfma_f32_16x16x32_bf16 v[100:103], a[88:91], a[56:59], v[100:103]
    buffer_load_dwordx4 v13, s[40:43], s81 offen offset:2048 lds
    v_mfma_f32_16x16x32_bf16 v[104:107], a[88:91], a[60:63], v[104:107]
    ds_read_b128 a[4:7], v23 offset:22528
    v_mfma_f32_16x16x32_bf16 v[108:111], a[88:91], a[64:67], v[108:111]
    ds_read_b128 a[8:11], v23 offset:24576
    v_mfma_f32_16x16x32_bf16 v[112:115], a[88:91], a[68:71], v[112:115]
    buffer_load_dwordx4 v14, s[40:43], s81 offen offset:3072 lds
    v_mfma_f32_16x16x32_bf16 v[116:119], a[92:95], a[52:55], v[116:119]
    ds_read_b128 a[12:15], v23 offset:26624
    v_mfma_f32_16x16x32_bf16 v[120:123], a[92:95], a[56:59], v[120:123]
    ds_read_b128 a[16:19], v23 offset:28672
    s_add_u32 s81, s81, s84
    v_mfma_f32_16x16x32_bf16 v[124:127], a[92:95], a[60:63], v[124:127]
    ds_read_b64_tr_b16 a[36:37], v27 offset:49152
    s_add_u32 m0, s85, 69632
    v_mfma_f32_16x16x32_bf16 v[128:131], a[92:95], a[64:67], v[128:131]
    ds_read_b64_tr_b16 a[38:39], v27 offset:49664
    v_mfma_f32_16x16x32_bf16 v[132:135], a[92:95], a[68:71], v[132:135]
    buffer_load_dwordx4 v11, s[40:43], s81 offen offset:0 lds
    v_mfma_f32_16x16x32_bf16 v[136:139], a[96:99], a[52:55], v[136:139]
    ds_read_b64_tr_b16 a[40:41], v28 offset:49152
    v_mfma_f32_16x16x32_bf16 v[140:143], a[96:99], a[56:59], v[140:143]
    ds_read_b64_tr_b16 a[42:43], v28 offset:49664
    v_mfma_f32_16x16x32_bf16 v[144:147], a[96:99], a[60:63], v[144:147]
    buffer_load_dwordx4 v12, s[40:43], s81 offen offset:1024 lds
    v_mfma_f32_16x16x32_bf16 v[148:151], a[96:99], a[64:67], v[148:151]
    ds_read_b64_tr_b16 a[44:45], v27 offset:57344
    v_mfma_f32_16x16x32_bf16 v[152:155], a[96:99], a[68:71], v[152:155]
    ds_read_b64_tr_b16 a[46:47], v27 offset:57856
    v_mfma_f32_16x16x32_bf16 v[156:159], a[100:103], a[52:55], v[156:159]
    ds_read_b64_tr_b16 a[48:49], v28 offset:57344
    v_mfma_f32_16x16x32_bf16 v[160:163], a[100:103], a[56:59], v[160:163]
    buffer_load_dwordx4 v13, s[40:43], s81 offen offset:2048 lds
    v_mfma_f32_16x16x32_bf16 v[164:167], a[100:103], a[60:63], v[164:167]
    ds_read_b64_tr_b16 a[50:51], v28 offset:57856
    v_mfma_f32_16x16x32_bf16 v[168:171], a[100:103], a[64:67], v[168:171]
    ds_read_b64_tr_b16 a[20:21], v27 offset:32768
    v_mfma_f32_16x16x32_bf16 v[172:175], a[100:103], a[68:71], v[172:175]
    buffer_load_dwordx4 v14, s[40:43], s81 offen offset:3072 lds
    v_mfma_f32_16x16x32_bf16 v[176:179], a[72:75], a[52:55], v[176:179]
    ds_read_b64_tr_b16 a[22:23], v27 offset:33280
    v_mfma_f32_16x16x32_bf16 v[180:183], a[72:75], a[56:59], v[180:183]
    ds_read_b64_tr_b16 a[24:25], v28 offset:32768
    s_bfe_u32 s92, s78, 262156
    v_mfma_f32_16x16x32_bf16 v[184:187], a[72:75], a[60:63], v[184:187]
    ds_read_b64_tr_b16 a[26:27], v28 offset:33280
    s_lshl_b32 s80, s92, 7
    v_mfma_f32_16x16x32_bf16 v[188:191], a[72:75], a[64:67], v[188:191]
    ds_read_b64_tr_b16 a[28:29], v27 offset:40960
    s_add_u32 m0, s86, 98304
    v_mfma_f32_16x16x32_bf16 v[192:195], a[72:75], a[68:71], v[192:195]
    ds_read_b64_tr_b16 a[30:31], v27 offset:41472
    v_mfma_f32_16x16x32_bf16 v[196:199], a[76:79], a[52:55], v[196:199]
    s_mov_b64 exec, s[90:91]
    buffer_load_dwordx4 v1, s[36:39], s80 offen offset:0 lds
    s_mov_b64 exec, -1
    v_mfma_f32_16x16x32_bf16 v[200:203], a[76:79], a[56:59], v[200:203]
    ds_read_b64_tr_b16 a[32:33], v28 offset:40960
    v_mfma_f32_16x16x32_bf16 v[204:207], a[76:79], a[60:63], v[204:207]
    ds_read_b64_tr_b16 a[34:35], v28 offset:41472
    v_mfma_f32_16x16x32_bf16 v[208:211], a[76:79], a[64:67], v[208:211]
    buffer_load_dwordx4 v2, s[36:39], s80 offen offset:1024 lds
    v_mfma_f32_16x16x32_bf16 v[212:215], a[76:79], a[68:71], v[212:215]
    v_mfma_f32_16x16x32_bf16 v[216:219], a[80:83], a[52:55], v[216:219]
    v_mfma_f32_16x16x32_bf16 v[220:223], a[80:83], a[56:59], v[220:223]
    buffer_load_dwordx4 v3, s[36:39], s80 offen offset:2048 lds
    v_mfma_f32_16x16x32_bf16 v[224:227], a[80:83], a[60:63], v[224:227]
    v_mfma_f32_16x16x32_bf16 v[228:231], a[80:83], a[64:67], v[228:231]
    v_mfma_f32_16x16x32_bf16 v[232:235], a[80:83], a[68:71], v[232:235]
    buffer_load_dwordx4 v4, s[36:39], s80 offen offset:3072 lds
    v_mfma_f32_16x16x32_bf16 v[236:239], a[84:87], a[52:55], v[236:239]
    v_mfma_f32_16x16x32_bf16 v[240:243], a[84:87], a[56:59], v[240:243]
    v_mfma_f32_16x16x32_bf16 v[244:247], a[84:87], a[60:63], v[244:247]
    v_mfma_f32_16x16x32_bf16 v[248:251], a[84:87], a[64:67], v[248:251]
    s_add_u32 m0, s86, 102400
    v_mfma_f32_16x16x32_bf16 v[252:255], a[84:87], a[68:71], v[252:255]
    buffer_load_dwordx4 v5, s[36:39], s80 offen offset:0 lds
    s_waitcnt lgkmcnt(0)
    v_mfma_f32_16x16x32_bf16 v[96:99], a[36:39], a[0:3], v[96:99]
    ds_read_b128 a[52:55], v24 offset:20480
    v_mfma_f32_16x16x32_bf16 v[100:103], a[36:39], a[4:7], v[100:103]
    ds_read_b128 a[56:59], v24 offset:22528
    v_mfma_f32_16x16x32_bf16 v[104:107], a[36:39], a[8:11], v[104:107]
    s_bfe_u32 s92, s78, 262156
    ds_read_b128 a[60:63], v24 offset:24576
    v_mfma_f32_16x16x32_bf16 v[108:111], a[36:39], a[12:15], v[108:111]
    s_mul_i32 s81, s92, s83
    v_mfma_f32_16x16x32_bf16 v[112:115], a[36:39], a[16:19], v[112:115]
    ds_read_b128 a[64:67], v24 offset:26624
    s_add_u32 m0, s85, 0
    v_mfma_f32_16x16x32_bf16 v[116:119], a[40:43], a[0:3], v[116:119]
    ds_read_b128 a[68:71], v24 offset:28672
    v_mfma_f32_16x16x32_bf16 v[120:123], a[40:43], a[4:7], v[120:123]
    buffer_load_dwordx4 v11, s[40:43], s81 offen offset:0 lds
    v_mfma_f32_16x16x32_bf16 v[124:127], a[40:43], a[8:11], v[124:127]
    ds_read_b64_tr_b16 a[88:89], v27 offset:53248
    v_mfma_f32_16x16x32_bf16 v[128:131], a[40:43], a[12:15], v[128:131]
    ds_read_b64_tr_b16 a[90:91], v27 offset:53760
    v_mfma_f32_16x16x32_bf16 v[132:135], a[40:43], a[16:19], v[132:135]
    buffer_load_dwordx4 v12, s[40:43], s81 offen offset:1024 lds
    v_mfma_f32_16x16x32_bf16 v[136:139], a[44:47], a[0:3], v[136:139]
    ds_read_b64_tr_b16 a[92:93], v28 offset:53248
    v_mfma_f32_16x16x32_bf16 v[140:143], a[44:47], a[4:7], v[140:143]
    ds_read_b64_tr_b16 a[94:95], v28 offset:53760
    v_mfma_f32_16x16x32_bf16 v[144:147], a[44:47], a[8:11], v[144:147]
    ds_read_b64_tr_b16 a[96:97], v27 offset:61440
    v_mfma_f32_16x16x32_bf16 v[148:151], a[44:47], a[12:15], v[148:151]
    buffer_load_dwordx4 v13, s[40:43], s81 offen offset:2048 lds
    v_mfma_f32_16x16x32_bf16 v[152:155], a[44:47], a[16:19], v[152:155]
    ds_read_b64_tr_b16 a[98:99], v27 offset:61952
    v_mfma_f32_16x16x32_bf16 v[156:159], a[48:51], a[0:3], v[156:159]
    ds_read_b64_tr_b16 a[100:101], v28 offset:61440
    v_mfma_f32_16x16x32_bf16 v[160:163], a[48:51], a[4:7], v[160:163]
    buffer_load_dwordx4 v14, s[40:43], s81 offen offset:3072 lds
    v_mfma_f32_16x16x32_bf16 v[164:167], a[48:51], a[8:11], v[164:167]
    ds_read_b64_tr_b16 a[102:103], v28 offset:61952
    v_mfma_f32_16x16x32_bf16 v[168:171], a[48:51], a[12:15], v[168:171]
    ds_read_b64_tr_b16 a[72:73], v27 offset:36864
    s_add_u32 s81, s81, s84
    v_mfma_f32_16x16x32_bf16 v[172:175], a[48:51], a[16:19], v[172:175]
    ds_read_b64_tr_b16 a[74:75], v27 offset:37376
    s_add_u32 m0, s85, 4096
    v_mfma_f32_16x16x32_bf16 v[176:179], a[20:23], a[0:3], v[176:179]
    ds_read_b64_tr_b16 a[76:77], v28 offset:36864
    v_mfma_f32_16x16x32_bf16 v[180:183], a[20:23], a[4:7], v[180:183]
    buffer_load_dwordx4 v11, s[40:43], s81 offen offset:0 lds
    v_mfma_f32_16x16x32_bf16 v[184:187], a[20:23], a[8:11], v[184:187]
    ds_read_b64_tr_b16 a[78:79], v28 offset:37376
    v_mfma_f32_16x16x32_bf16 v[188:191], a[20:23], a[12:15], v[188:191]
    ds_read_b64_tr_b16 a[80:81], v27 offset:45056
    v_mfma_f32_16x16x32_bf16 v[192:195], a[20:23], a[16:19], v[192:195]
    ds_read_b64_tr_b16 a[82:83], v27 offset:45568
    v_mfma_f32_16x16x32_bf16 v[196:199], a[24:27], a[0:3], v[196:199]
    ds_read_b64_tr_b16 a[84:85], v28 offset:45056
    v_mfma_f32_16x16x32_bf16 v[200:203], a[24:27], a[4:7], v[200:203]
    ds_read_b64_tr_b16 a[86:87], v28 offset:45568
    v_mfma_f32_16x16x32_bf16 v[204:207], a[24:27], a[8:11], v[204:207]
    v_mfma_f32_16x16x32_bf16 v[208:211], a[24:27], a[12:15], v[208:211]
    v_mfma_f32_16x16x32_bf16 v[212:215], a[24:27], a[16:19], v[212:215]
    v_mfma_f32_16x16x32_bf16 v[216:219], a[28:31], a[0:3], v[216:219]
    v_mfma_f32_16x16x32_bf16 v[220:223], a[28:31], a[4:7], v[220:223]
    v_mfma_f32_16x16x32_bf16 v[224:227], a[28:31], a[8:11], v[224:227]
    v_mfma_f32_16x16x32_bf16 v[228:231], a[28:31], a[12:15], v[228:231]
    v_mfma_f32_16x16x32_bf16 v[232:235], a[28:31], a[16:19], v[232:235]
    v_mfma_f32_16x16x32_bf16 v[236:239], a[32:35], a[0:3], v[236:239]
    v_mfma_f32_16x16x32_bf16 v[240:243], a[32:35], a[4:7], v[240:243]
    v_mfma_f32_16x16x32_bf16 v[244:247], a[32:35], a[8:11], v[244:247]
    v_mfma_f32_16x16x32_bf16 v[248:251], a[32:35], a[12:15], v[248:251]
    v_mfma_f32_16x16x32_bf16 v[252:255], a[32:35], a[16:19], v[252:255]
    s_waitcnt vmcnt(10) lgkmcnt(0)
    s_barrier
    v_mfma_f32_16x16x32_bf16 v[96:99], a[88:91], a[52:55], v[96:99]
    ds_read_b128 a[0:3], v23 offset:40960
    v_mfma_f32_16x16x32_bf16 v[100:103], a[88:91], a[56:59], v[100:103]
    buffer_load_dwordx4 v12, s[40:43], s81 offen offset:1024 lds
    v_mfma_f32_16x16x32_bf16 v[104:107], a[88:91], a[60:63], v[104:107]
    ds_read_b128 a[4:7], v23 offset:43008
    v_mfma_f32_16x16x32_bf16 v[108:111], a[88:91], a[64:67], v[108:111]
    ds_read_b128 a[8:11], v23 offset:45056
    v_mfma_f32_16x16x32_bf16 v[112:115], a[88:91], a[68:71], v[112:115]
    ds_read_b128 a[12:15], v23 offset:47104
    v_mfma_f32_16x16x32_bf16 v[116:119], a[92:95], a[52:55], v[116:119]
    buffer_load_dwordx4 v13, s[40:43], s81 offen offset:2048 lds
    v_mfma_f32_16x16x32_bf16 v[120:123], a[92:95], a[56:59], v[120:123]
    ds_read_b128 a[16:19], v23 offset:49152
    v_mfma_f32_16x16x32_bf16 v[124:127], a[92:95], a[60:63], v[124:127]
    ds_read_b64_tr_b16 a[36:37], v86 offset:16384
    v_mfma_f32_16x16x32_bf16 v[128:131], a[92:95], a[64:67], v[128:131]
    ds_read_b64_tr_b16 a[38:39], v86 offset:16896
    v_mfma_f32_16x16x32_bf16 v[132:135], a[92:95], a[68:71], v[132:135]
    buffer_load_dwordx4 v14, s[40:43], s81 offen offset:3072 lds
    v_mfma_f32_16x16x32_bf16 v[136:139], a[96:99], a[52:55], v[136:139]
    ds_read_b64_tr_b16 a[40:41], v87 offset:16384
    v_mfma_f32_16x16x32_bf16 v[140:143], a[96:99], a[56:59], v[140:143]
    ds_read_b64_tr_b16 a[42:43], v87 offset:16896
    v_mfma_f32_16x16x32_bf16 v[144:147], a[96:99], a[60:63], v[144:147]
    ds_read_b64_tr_b16 a[44:45], v86 offset:24576
    v_mfma_f32_16x16x32_bf16 v[148:151], a[96:99], a[64:67], v[148:151]
    buffer_load_dwordx2 v[50:51], v88, s[36:39], 0 offen offset:0
    v_mfma_f32_16x16x32_bf16 v[152:155], a[96:99], a[68:71], v[152:155]
    ds_read_b64_tr_b16 a[46:47], v86 offset:25088
    v_mfma_f32_16x16x32_bf16 v[156:159], a[100:103], a[52:55], v[156:159]
    ds_read_b64_tr_b16 a[48:49], v87 offset:24576
    v_mfma_f32_16x16x32_bf16 v[160:163], a[100:103], a[56:59], v[160:163]
    ds_read_b64_tr_b16 a[50:51], v87 offset:25088
    v_mfma_f32_16x16x32_bf16 v[164:167], a[100:103], a[60:63], v[164:167]
    buffer_load_dwordx2 v[52:53], v88, s[36:39], 0 offen offset:256
    v_mfma_f32_16x16x32_bf16 v[168:171], a[100:103], a[64:67], v[168:171]
    ds_read_b64_tr_b16 a[20:21], v86 offset:0
    v_mfma_f32_16x16x32_bf16 v[172:175], a[100:103], a[68:71], v[172:175]
    ds_read_b64_tr_b16 a[22:23], v86 offset:512
    v_mfma_f32_16x16x32_bf16 v[176:179], a[72:75], a[52:55], v[176:179]
    ds_read_b64_tr_b16 a[24:25], v87 offset:0
    v_mfma_f32_16x16x32_bf16 v[180:183], a[72:75], a[56:59], v[180:183]
    buffer_load_dwordx2 v[54:55], v88, s[36:39], 0 offen offset:512
    v_mfma_f32_16x16x32_bf16 v[184:187], a[72:75], a[60:63], v[184:187]
    ds_read_b64_tr_b16 a[26:27], v87 offset:512
    v_mfma_f32_16x16x32_bf16 v[188:191], a[72:75], a[64:67], v[188:191]
    ds_read_b64_tr_b16 a[28:29], v86 offset:8192
    v_mfma_f32_16x16x32_bf16 v[192:195], a[72:75], a[68:71], v[192:195]
    ds_read_b64_tr_b16 a[30:31], v86 offset:8704
    v_mfma_f32_16x16x32_bf16 v[196:199], a[76:79], a[52:55], v[196:199]
    buffer_load_dwordx2 v[56:57], v88, s[36:39], 0 offen offset:768
    v_mfma_f32_16x16x32_bf16 v[200:203], a[76:79], a[56:59], v[200:203]
    ds_read_b64_tr_b16 a[32:33], v87 offset:8192
    v_mfma_f32_16x16x32_bf16 v[204:207], a[76:79], a[60:63], v[204:207]
    ds_read_b64_tr_b16 a[34:35], v87 offset:8704
    v_mfma_f32_16x16x32_bf16 v[208:211], a[76:79], a[64:67], v[208:211]
    buffer_load_dwordx2 v[58:59], v88, s[36:39], 0 offen offset:1024
    v_mfma_f32_16x16x32_bf16 v[212:215], a[76:79], a[68:71], v[212:215]
    v_mfma_f32_16x16x32_bf16 v[216:219], a[80:83], a[52:55], v[216:219]
    v_mfma_f32_16x16x32_bf16 v[220:223], a[80:83], a[56:59], v[220:223]
    v_mfma_f32_16x16x32_bf16 v[224:227], a[80:83], a[60:63], v[224:227]
    v_mfma_f32_16x16x32_bf16 v[228:231], a[80:83], a[64:67], v[228:231]
    buffer_load_dword v89, v82, s[52:55], 0 offen
    v_mfma_f32_16x16x32_bf16 v[232:235], a[80:83], a[68:71], v[232:235]
    v_mfma_f32_16x16x32_bf16 v[236:239], a[84:87], a[52:55], v[236:239]
    v_mfma_f32_16x16x32_bf16 v[240:243], a[84:87], a[56:59], v[240:243]
    v_mfma_f32_16x16x32_bf16 v[244:247], a[84:87], a[60:63], v[244:247]
    s_bfe_u32 s92, s78, 262160
    v_mfma_f32_16x16x32_bf16 v[248:251], a[84:87], a[64:67], v[248:251]
    s_lshl_b32 s80, s92, 7
    v_mfma_f32_16x16x32_bf16 v[252:255], a[84:87], a[68:71], v[252:255]
    s_add_u32 m0, s86, 118784
    s_waitcnt lgkmcnt(0)
    v_mfma_f32_16x16x32_bf16 v[96:99], a[36:39], a[0:3], v[96:99]
    ds_read_b128 a[52:55], v24 offset:40960
    v_mfma_f32_16x16x32_bf16 v[100:103], a[36:39], a[4:7], v[100:103]
    s_mov_b64 exec, s[90:91]
    buffer_load_dwordx4 v1, s[36:39], s80 offen offset:0 lds
    s_mov_b64 exec, -1
    v_mfma_f32_16x16x32_bf16 v[104:107], a[36:39], a[8:11], v[104:107]
    ds_read_b128 a[56:59], v24 offset:43008
    v_mfma_f32_16x16x32_bf16 v[108:111], a[36:39], a[12:15], v[108:111]
    ds_read_b128 a[60:63], v24 offset:45056
    v_mfma_f32_16x16x32_bf16 v[112:115], a[36:39], a[16:19], v[112:115]
    ds_read_b128 a[64:67], v24 offset:47104
    v_mfma_f32_16x16x32_bf16 v[116:119], a[40:43], a[0:3], v[116:119]
    buffer_load_dwordx4 v2, s[36:39], s80 offen offset:1024 lds
    v_mfma_f32_16x16x32_bf16 v[120:123], a[40:43], a[4:7], v[120:123]
    ds_read_b128 a[68:71], v24 offset:49152
    v_mfma_f32_16x16x32_bf16 v[124:127], a[40:43], a[8:11], v[124:127]
    ds_read_b64_tr_b16 a[88:89], v86 offset:20480
    v_mfma_f32_16x16x32_bf16 v[128:131], a[40:43], a[12:15], v[128:131]
    ds_read_b64_tr_b16 a[90:91], v86 offset:20992
    v_mfma_f32_16x16x32_bf16 v[132:135], a[40:43], a[16:19], v[132:135]
    buffer_load_dwordx4 v3, s[36:39], s80 offen offset:2048 lds
    v_mfma_f32_16x16x32_bf16 v[136:139], a[44:47], a[0:3], v[136:139]
    ds_read_b64_tr_b16 a[92:93], v87 offset:20480
    v_mfma_f32_16x16x32_bf16 v[140:143], a[44:47], a[4:7], v[140:143]
    ds_read_b64_tr_b16 a[94:95], v87 offset:20992
    v_mfma_f32_16x16x32_bf16 v[144:147], a[44:47], a[8:11], v[144:147]
    ds_read_b64_tr_b16 a[96:97], v86 offset:28672
    v_mfma_f32_16x16x32_bf16 v[148:151], a[44:47], a[12:15], v[148:151]
    ds_read_b64_tr_b16 a[98:99], v86 offset:29184
    v_mfma_f32_16x16x32_bf16 v[152:155], a[44:47], a[16:19], v[152:155]
    buffer_load_dwordx4 v4, s[36:39], s80 offen offset:3072 lds
    v_mfma_f32_16x16x32_bf16 v[156:159], a[48:51], a[0:3], v[156:159]
    ds_read_b64_tr_b16 a[100:101], v87 offset:28672
    v_mfma_f32_16x16x32_bf16 v[160:163], a[48:51], a[4:7], v[160:163]
    ds_read_b64_tr_b16 a[102:103], v87 offset:29184
    v_mfma_f32_16x16x32_bf16 v[164:167], a[48:51], a[8:11], v[164:167]
    ds_read_b64_tr_b16 a[72:73], v86 offset:4096
    s_add_u32 m0, s86, 122880
    v_mfma_f32_16x16x32_bf16 v[168:171], a[48:51], a[12:15], v[168:171]
    ds_read_b64_tr_b16 a[74:75], v86 offset:4608
    v_mfma_f32_16x16x32_bf16 v[172:175], a[48:51], a[16:19], v[172:175]
    buffer_load_dwordx4 v5, s[36:39], s80 offen offset:0 lds
    v_mfma_f32_16x16x32_bf16 v[176:179], a[20:23], a[0:3], v[176:179]
    ds_read_b64_tr_b16 a[76:77], v87 offset:4096
    v_mfma_f32_16x16x32_bf16 v[180:183], a[20:23], a[4:7], v[180:183]
    ds_read_b64_tr_b16 a[78:79], v87 offset:4608
    v_mfma_f32_16x16x32_bf16 v[184:187], a[20:23], a[8:11], v[184:187]
    ds_read_b64_tr_b16 a[80:81], v86 offset:12288
    s_bfe_u32 s92, s78, 262160
    v_mfma_f32_16x16x32_bf16 v[188:191], a[20:23], a[12:15], v[188:191]
    v_mfma_f32_16x16x32_bf16 v[192:195], a[20:23], a[16:19], v[192:195]
    ds_read_b64_tr_b16 a[82:83], v86 offset:12800
    s_mul_i32 s81, s92, s83
    v_mfma_f32_16x16x32_bf16 v[196:199], a[24:27], a[0:3], v[196:199]
    ds_read_b64_tr_b16 a[84:85], v87 offset:12288
    s_add_u32 m0, s85, 32768
    v_mfma_f32_16x16x32_bf16 v[200:203], a[24:27], a[4:7], v[200:203]
    buffer_load_dwordx4 v11, s[40:43], s81 offen offset:0 lds
    v_mfma_f32_16x16x32_bf16 v[204:207], a[24:27], a[8:11], v[204:207]
    ds_read_b64_tr_b16 a[86:87], v87 offset:12800
    v_mfma_f32_16x16x32_bf16 v[208:211], a[24:27], a[12:15], v[208:211]
    v_mfma_f32_16x16x32_bf16 v[212:215], a[24:27], a[16:19], v[212:215]
    v_mfma_f32_16x16x32_bf16 v[216:219], a[28:31], a[0:3], v[216:219]
    buffer_load_dwordx4 v12, s[40:43], s81 offen offset:1024 lds
    v_mfma_f32_16x16x32_bf16 v[220:223], a[28:31], a[4:7], v[220:223]
    v_mfma_f32_16x16x32_bf16 v[224:227], a[28:31], a[8:11], v[224:227]
    v_mfma_f32_16x16x32_bf16 v[228:231], a[28:31], a[12:15], v[228:231]
    v_mfma_f32_16x16x32_bf16 v[232:235], a[28:31], a[16:19], v[232:235]
    buffer_load_dwordx4 v13, s[40:43], s81 offen offset:2048 lds
    v_mfma_f32_16x16x32_bf16 v[236:239], a[32:35], a[0:3], v[236:239]
    v_mfma_f32_16x16x32_bf16 v[240:243], a[32:35], a[4:7], v[240:243]
    v_mfma_f32_16x16x32_bf16 v[244:247], a[32:35], a[8:11], v[244:247]
    v_mfma_f32_16x16x32_bf16 v[248:251], a[32:35], a[12:15], v[248:251]
    v_mfma_f32_16x16x32_bf16 v[252:255], a[32:35], a[16:19], v[252:255]
    s_waitcnt vmcnt(14) lgkmcnt(0)
    s_barrier
    v_mfma_f32_16x16x32_bf16 v[96:99], a[88:91], a[52:55], v[96:99]
    ds_read_b128 a[0:3], v23 offset:0
    v_mfma_f32_16x16x32_bf16 v[100:103], a[88:91], a[56:59], v[100:103]
    buffer_load_dwordx4 v14, s[40:43], s81 offen offset:3072 lds
    v_mfma_f32_16x16x32_bf16 v[104:107], a[88:91], a[60:63], v[104:107]
    ds_read_b128 a[4:7], v23 offset:2048
    v_mfma_f32_16x16x32_bf16 v[108:111], a[88:91], a[64:67], v[108:111]
    ds_read_b128 a[8:11], v23 offset:4096
    v_mfma_f32_16x16x32_bf16 v[112:115], a[88:91], a[68:71], v[112:115]
    ds_read_b128 a[12:15], v23 offset:6144
    s_waitcnt vmcnt(9)
    s_add_u32 s81, s81, s84
    v_mfma_f32_16x16x32_bf16 v[116:119], a[92:95], a[52:55], v[116:119]
    v_lshlrev_b32 v60, 16, v50
    s_add_u32 m0, s85, 36864
    v_and_b32 v61, 0xffff0000, v50
    v_mfma_f32_16x16x32_bf16 v[120:123], a[92:95], a[56:59], v[120:123]
    ds_read_b128 a[16:19], v23 offset:8192
    v_mfma_f32_16x16x32_bf16 v[124:127], a[92:95], a[60:63], v[124:127]
    buffer_load_dwordx4 v11, s[40:43], s81 offen offset:0 lds
    v_mfma_f32_16x16x32_bf16 v[128:131], a[92:95], a[64:67], v[128:131]
    ds_read_b64_tr_b16 a[36:37], v27 offset:16384
    v_lshlrev_b32_e64 v62, 16, v51
    v_mfma_f32_16x16x32_bf16 v[132:135], a[92:95], a[68:71], v[132:135]
    ds_read_b64_tr_b16 a[38:39], v27 offset:16896
    v_and_b32 v63, 0xffff0000, v51
    v_mfma_f32_16x16x32_bf16 v[136:139], a[96:99], a[52:55], v[136:139]
    ds_read_b64_tr_b16 a[40:41], v28 offset:16384
    v_lshlrev_b32_e64 v64, 16, v52
    v_mfma_f32_16x16x32_bf16 v[140:143], a[96:99], a[56:59], v[140:143]
    buffer_load_dwordx4 v12, s[40:43], s81 offen offset:1024 lds
    v_mfma_f32_16x16x32_bf16 v[144:147], a[96:99], a[60:63], v[144:147]
    ds_read_b64_tr_b16 a[42:43], v28 offset:16896
    v_and_b32 v65, 0xffff0000, v52
    v_mfma_f32_16x16x32_bf16 v[148:151], a[96:99], a[64:67], v[148:151]
    ds_read_b64_tr_b16 a[44:45], v27 offset:24576
    v_lshlrev_b32_e64 v66, 16, v53
    v_mfma_f32_16x16x32_bf16 v[152:155], a[96:99], a[68:71], v[152:155]
    ds_read_b64_tr_b16 a[46:47], v27 offset:25088
    v_and_b32 v67, 0xffff0000, v53
    v_mfma_f32_16x16x32_bf16 v[156:159], a[100:103], a[52:55], v[156:159]
    ds_read_b64_tr_b16 a[48:49], v28 offset:24576
    v_lshlrev_b32_e64 v68, 16, v54
    v_mfma_f32_16x16x32_bf16 v[160:163], a[100:103], a[56:59], v[160:163]
    buffer_load_dwordx4 v13, s[40:43], s81 offen offset:2048 lds
    v_mfma_f32_16x16x32_bf16 v[164:167], a[100:103], a[60:63], v[164:167]
    ds_read_b64_tr_b16 a[50:51], v28 offset:25088
    v_and_b32 v69, 0xffff0000, v54
    v_mfma_f32_16x16x32_bf16 v[168:171], a[100:103], a[64:67], v[168:171]
    ds_read_b64_tr_b16 a[20:21], v27 offset:0
    v_lshlrev_b32_e64 v70, 16, v55
    v_mfma_f32_16x16x32_bf16 v[172:175], a[100:103], a[68:71], v[172:175]
    ds_read_b64_tr_b16 a[22:23], v27 offset:512
    v_mfma_f32_16x16x32_bf16 v[176:179], a[72:75], a[52:55], v[176:179]
    buffer_load_dwordx4 v14, s[40:43], s81 offen offset:3072 lds
    v_mfma_f32_16x16x32_bf16 v[180:183], a[72:75], a[56:59], v[180:183]
    ds_read_b64_tr_b16 a[24:25], v28 offset:0
    v_and_b32 v71, 0xffff0000, v55
    v_mfma_f32_16x16x32_bf16 v[184:187], a[72:75], a[60:63], v[184:187]
    ds_read_b64_tr_b16 a[26:27], v28 offset:512
    v_lshlrev_b32_e64 v72, 16, v56
    s_bfe_u32 s92, s78, 262164
    v_mfma_f32_16x16x32_bf16 v[188:191], a[72:75], a[64:67], v[188:191]
    ds_read_b64_tr_b16 a[28:29], v27 offset:8192
    v_and_b32 v73, 0xffff0000, v56
    v_mfma_f32_16x16x32_bf16 v[192:195], a[72:75], a[68:71], v[192:195]
    ds_read_b64_tr_b16 a[30:31], v27 offset:8704
    s_lshl_b32 s80, s92, 7
    v_lshlrev_b32 v74, 16, v57
    v_mfma_f32_16x16x32_bf16 v[196:199], a[76:79], a[52:55], v[196:199]
    ds_read_b64_tr_b16 a[32:33], v28 offset:8192
    s_add_u32 m0, s86, 139264
    v_and_b32 v75, 0xffff0000, v57
    v_mfma_f32_16x16x32_bf16 v[200:203], a[76:79], a[56:59], v[200:203]
    s_mov_b64 exec, s[90:91]
    buffer_load_dwordx4 v1, s[36:39], s80 offen offset:0 lds
    s_mov_b64 exec, -1
    v_mfma_f32_16x16x32_bf16 v[204:207], a[76:79], a[60:63], v[204:207]
    ds_read_b64_tr_b16 a[34:35], v28 offset:8704
    v_lshlrev_b32_e64 v76, 16, v58
    v_mfma_f32_16x16x32_bf16 v[208:211], a[76:79], a[64:67], v[208:211]
    v_and_b32 v77, 0xffff0000, v58
    v_mfma_f32_16x16x32_bf16 v[212:215], a[76:79], a[68:71], v[212:215]
    v_mfma_f32_16x16x32_bf16 v[216:219], a[80:83], a[52:55], v[216:219]
    v_lshlrev_b32_e64 v78, 16, v59
    v_mfma_f32_16x16x32_bf16 v[220:223], a[80:83], a[56:59], v[220:223]
    buffer_load_dwordx4 v2, s[36:39], s80 offen offset:1024 lds
    v_mfma_f32_16x16x32_bf16 v[224:227], a[80:83], a[60:63], v[224:227]
    v_and_b32 v79, 0xffff0000, v59
    v_mfma_f32_16x16x32_bf16 v[228:231], a[80:83], a[64:67], v[228:231]
    v_add_f32_e64 v50, v60, v61
    v_mfma_f32_16x16x32_bf16 v[232:235], a[80:83], a[68:71], v[232:235]
    v_add_f32_e64 v50, v50, v62
    v_mfma_f32_16x16x32_bf16 v[236:239], a[84:87], a[52:55], v[236:239]
    buffer_load_dwordx4 v3, s[36:39], s80 offen offset:2048 lds
    v_mfma_f32_16x16x32_bf16 v[240:243], a[84:87], a[56:59], v[240:243]
    v_add_f32_e64 v50, v50, v63
    v_mfma_f32_16x16x32_bf16 v[244:247], a[84:87], a[60:63], v[244:247]
    v_add_f32_e64 v50, v50, v64
    v_mfma_f32_16x16x32_bf16 v[248:251], a[84:87], a[64:67], v[248:251]
    v_add_f32_e64 v50, v50, v65
    v_mfma_f32_16x16x32_bf16 v[252:255], a[84:87], a[68:71], v[252:255]
    buffer_load_dwordx4 v4, s[36:39], s80 offen offset:3072 lds
    s_waitcnt lgkmcnt(0)
    v_mfma_f32_16x16x32_bf16 v[96:99], a[36:39], a[0:3], v[96:99]
    ds_read_b128 a[52:55], v24 offset:0
    v_add_f32 v50, v50, v66
    v_mfma_f32_16x16x32_bf16 v[100:103], a[36:39], a[4:7], v[100:103]
    ds_read_b128 a[56:59], v24 offset:2048
    v_add_f32_e64 v50, v50, v67
    v_mfma_f32_16x16x32_bf16 v[104:107], a[36:39], a[8:11], v[104:107]
L_pad2:
    s_cbranch_execz L_pad13
    s_nop 0
    ds_read_b128 a[60:63], v24 offset:4096
    s_add_u32 m0, s86, 143360
    v_mfma_f32_16x16x32_bf16 v[108:111], a[36:39], a[12:15], v[108:111]
    v_add_f32_e64 v50, v50, v68
    v_mfma_f32_16x16x32_bf16 v[112:115], a[36:39], a[16:19], v[112:115]
    ds_read_b128 a[64:67], v24 offset:6144
    v_add_f32_e64 v50, v50, v69
    v_mfma_f32_16x16x32_bf16 v[116:119], a[40:43], a[0:3], v[116:119]
    buffer_load_dwordx4 v5, s[36:39], s80 offen offset:0 lds
    v_mfma_f32_16x16x32_bf16 v[120:123], a[40:43], a[4:7], v[120:123]
    ds_read_b128 a[68:71], v24 offset:8192
    v_add_f32_e64 v50, v50, v70
    v_mfma_f32_16x16x32_bf16 v[124:127], a[40:43], a[8:11], v[124:127]
    ds_read_b64_tr_b16 a[88:89], v27 offset:20480
    v_add_f32_e64 v50, v50, v71
    v_mfma_f32_16x16x32_bf16 v[128:131], a[40:43], a[12:15], v[128:131]
    ds_read_b64_tr_b16 a[90:91], v27 offset:20992
    s_bfe_u32 s92, s78, 262164
    v_add_f32_e64 v50, v50, v72
    v_mfma_f32_16x16x32_bf16 v[132:135], a[40:43], a[16:19], v[132:135]
    ds_read_b64_tr_b16 a[92:93], v28 offset:20480
    s_mul_i32 s81, s92, s83
    v_mfma_f32_16x16x32_bf16 v[136:139], a[44:47], a[0:3], v[136:139]
    v_add_f32 v50, v50, v73
    s_add_u32 m0, s85, 65536
    v_mfma_f32_16x16x32_bf16 v[140:143], a[44:47], a[4:7], v[140:143]
    ds_read_b64_tr_b16 a[94:95], v28 offset:20992
    v_add_f32_e64 v50, v50, v74
    v_mfma_f32_16x16x32_bf16 v[144:147], a[44:47], a[8:11], v[144:147]
    buffer_load_dwordx4 v11, s[40:43], s81 offen offset:0 lds
    v_mfma_f32_16x16x32_bf16 v[148:151], a[44:47], a[12:15], v[148:151]
    ds_read_b64_tr_b16 a[96:97], v27 offset:28672
    v_add_f32_e64 v50, v50, v75
    v_mfma_f32_16x16x32_bf16 v[152:155], a[44:47], a[16:19], v[152:155]
    ds_read_b64_tr_b16 a[98:99], v27 offset:29184
    v_add_f32_e64 v50, v50, v76
    v_mfma_f32_16x16x32_bf16 v[156:159], a[48:51], a[0:3], v[156:159]
    ds_read_b64_tr_b16 a[100:101], v28 offset:28672
    v_mfma_f32_16x16x32_bf16 v[160:163], a[48:51], a[4:7], v[160:163]
    ds_read_b64_tr_b16 a[102:103], v28 offset:29184
    v_add_f32_e64 v50, v50, v77
    v_mfma_f32_16x16x32_bf16 v[164:167], a[48:51], a[8:11], v[164:167]
    buffer_load_dwordx4 v12, s[40:43], s81 offen offset:1024 lds
    v_mfma_f32_16x16x32_bf16 v[168:171], a[48:51], a[12:15], v[168:171]
    ds_read_b64_tr_b16 a[72:73], v27 offset:4096
    v_add_f32_e64 v50, v50, v78
    v_mfma_f32_16x16x32_bf16 v[172:175], a[48:51], a[16:19], v[172:175]
    ds_read_b64_tr_b16 a[74:75], v27 offset:4608
    v_add_f32_e64 v50, v50, v79
    v_mfma_f32_16x16x32_bf16 v[176:179], a[20:23], a[0:3], v[176:179]
    ds_read_b64_tr_b16 a[76:77], v28 offset:4096
    v_add_f32_dpp v50, v50, v50 quad_perm:[1,0,3,2] row_mask:0xf bank_mask:0xf
    v_mfma_f32_16x16x32_bf16 v[180:183], a[20:23], a[4:7], v[180:183]
    buffer_load_dwordx4 v13, s[40:43], s81 offen offset:2048 lds
    v_mfma_f32_16x16x32_bf16 v[184:187], a[20:23], a[8:11], v[184:187]
    ds_read_b64_tr_b16 a[78:79], v28 offset:4608
    v_add_f32_dpp v50, v50, v50 quad_perm:[2,3,0,1] row_mask:0xf bank_mask:0xf
    v_mfma_f32_16x16x32_bf16 v[188:191], a[20:23], a[12:15], v[188:191]
    ds_read_b64_tr_b16 a[80:81], v27 offset:12288
    v_add_f32_dpp v50, v50, v50 row_half_mirror row_mask:0xf bank_mask:0xf
    v_mfma_f32_16x16x32_bf16 v[192:195], a[20:23], a[16:19], v[192:195]
    ds_read_b64_tr_b16 a[82:83], v27 offset:12800
    v_add_f32_dpp v50, v50, v50 row_mirror row_mask:0xf bank_mask:0xf
    v_mfma_f32_16x16x32_bf16 v[196:199], a[24:27], a[0:3], v[196:199]
    buffer_load_dwordx4 v14, s[40:43], s81 offen offset:3072 lds
    v_mfma_f32_16x16x32_bf16 v[200:203], a[24:27], a[4:7], v[200:203]
    ds_read_b64_tr_b16 a[84:85], v28 offset:12288
    v_mov_b32_e64 v51, v50
    v_mfma_f32_16x16x32_bf16 v[204:207], a[24:27], a[8:11], v[204:207]
    ds_read_b64_tr_b16 a[86:87], v28 offset:12800
    v_permlane16_swap_b32 v50, v51
    v_mfma_f32_16x16x32_bf16 v[208:211], a[24:27], a[12:15], v[208:211]
    s_add_u32 s81, s81, s84
    v_add_f32_e64 v50, v50, v51
    v_mfma_f32_16x16x32_bf16 v[212:215], a[24:27], a[16:19], v[212:215]
    s_add_u32 m0, s85, 69632
    v_mfma_f32_16x16x32_bf16 v[216:219], a[28:31], a[0:3], v[216:219]
    v_mul_f32 v54, 0x3acccccd, v50
    v_mfma_f32_16x16x32_bf16 v[220:223], a[28:31], a[4:7], v[220:223]
    buffer_load_dwordx4 v11, s[40:43], s81 offen offset:0 lds
    v_mfma_f32_16x16x32_bf16 v[224:227], a[28:31], a[8:11], v[224:227]
    v_sub_f32_e64 v60, v60, v54
    v_mfma_f32_16x16x32_bf16 v[228:231], a[28:31], a[12:15], v[228:231]
    v_sub_f32_e64 v61, v61, v54
    v_mfma_f32_16x16x32_bf16 v[232:235], a[28:31], a[16:19], v[232:235]
    v_sub_f32_e64 v62, v62, v54
    v_mfma_f32_16x16x32_bf16 v[236:239], a[32:35], a[0:3], v[236:239]
    buffer_load_dwordx4 v12, s[40:43], s81 offen offset:1024 lds
    v_mfma_f32_16x16x32_bf16 v[240:243], a[32:35], a[4:7], v[240:243]
    v_sub_f32_e64 v63, v63, v54
    v_mfma_f32_16x16x32_bf16 v[244:247], a[32:35], a[8:11], v[244:247]
    v_sub_f32_e64 v64, v64, v54
    v_mfma_f32_16x16x32_bf16 v[248:251], a[32:35], a[12:15], v[248:251]
    v_mfma_f32_16x16x32_bf16 v[252:255], a[32:35], a[16:19], v[252:255]
    s_waitcnt vmcnt(11) lgkmcnt(0)
    s_barrier
    v_mfma_f32_16x16x32_bf16 v[96:99], a[88:91], a[52:55], v[96:99]
    ds_read_b128 a[0:3], v23 offset:20480
    v_sub_f32_e64 v65, v65, v54
    v_mfma_f32_16x16x32_bf16 v[100:103], a[88:91], a[56:59], v[100:103]
    buffer_load_dwordx4 v13, s[40:43], s81 offen offset:2048 lds
    v_mfma_f32_16x16x32_bf16 v[104:107], a[88:91], a[60:63], v[104:107]
    ds_read_b128 a[4:7], v23 offset:22528
    v_sub_f32_e64 v66, v66, v54
    v_mfma_f32_16x16x32_bf16 v[108:111], a[88:91], a[64:67], v[108:111]
    ds_read_b128 a[8:11], v23 offset:24576
    v_sub_f32_e64 v67, v67, v54
    v_mfma_f32_16x16x32_bf16 v[112:115], a[88:91], a[68:71], v[112:115]
    ds_read_b128 a[12:15], v23 offset:26624
    v_sub_f32_e64 v68, v68, v54
    v_mfma_f32_16x16x32_bf16 v[116:119], a[92:95], a[52:55], v[116:119]
    ds_read_b128 a[16:19], v23 offset:28672
    v_sub_f32_e64 v69, v69, v54
    v_mfma_f32_16x16x32_bf16 v[120:123], a[92:95], a[56:59], v[120:123]
    buffer_load_dwordx4 v14, s[40:43], s81 offen offset:3072 lds
    v_mfma_f32_16x16x32_bf16 v[124:127], a[92:95], a[60:63], v[124:127]
    ds_read_b64_tr_b16 a[36:37], v27 offset:49152
    v_sub_f32_e64 v70, v70, v54
    v_mfma_f32_16x16x32_bf16 v[128:131], a[92:95], a[64:67], v[128:131]
    ds_read_b64_tr_b16 a[38:39], v27 offset:49664
    v_sub_f32_e64 v71, v71, v54
    v_mfma_f32_16x16x32_bf16 v[132:135], a[92:95], a[68:71], v[132:135]
    ds_read_b64_tr_b16 a[40:41], v28 offset:49152
    v_sub_f32_e64 v72, v72, v54
    v_mfma_f32_16x16x32_bf16 v[136:139], a[96:99], a[52:55], v[136:139]
    ds_read_b64_tr_b16 a[42:43], v28 offset:49664
    v_mfma_f32_16x16x32_bf16 v[140:143], a[96:99], a[56:59], v[140:143]
    v_sub_f32_e64 v73, v73, v54
    v_mfma_f32_16x16x32_bf16 v[144:147], a[96:99], a[60:63], v[144:147]
    ds_read_b64_tr_b16 a[44:45], v27 offset:57344
    s_bfe_u32 s92, s78, 262168
    v_sub_f32_e64 v74, v74, v54
    v_mfma_f32_16x16x32_bf16 v[148:151], a[96:99], a[64:67], v[148:151]
    ds_read_b64_tr_b16 a[46:47], v27 offset:57856
    v_sub_f32 v75, v75, v54
    s_lshl_b32 s80, s92, 7
    v_mfma_f32_16x16x32_bf16 v[152:155], a[96:99], a[68:71], v[152:155]
    ds_read_b64_tr_b16 a[48:49], v28 offset:57344
    v_mfma_f32_16x16x32_bf16 v[156:159], a[100:103], a[52:55], v[156:159]
    v_sub_f32_e64 v76, v76, v54
    s_add_u32 m0, s86, 98304
    v_mfma_f32_16x16x32_bf16 v[160:163], a[100:103], a[56:59], v[160:163]
    ds_read_b64_tr_b16 a[50:51], v28 offset:57856
    v_sub_f32_e64 v77, v77, v54
    v_mfma_f32_16x16x32_bf16 v[164:167], a[100:103], a[60:63], v[164:167]
    ds_read_b64_tr_b16 a[20:21], v27 offset:32768
    v_sub_f32_e64 v78, v78, v54
    v_mfma_f32_16x16x32_bf16 v[168:171], a[100:103], a[64:67], v[168:171]
    s_mov_b64 exec, s[90:91]
    buffer_load_dwordx4 v1, s[36:39], s80 offen offset:0 lds
    s_mov_b64 exec, -1
    v_mfma_f32_16x16x32_bf16 v[172:175], a[100:103], a[68:71], v[172:175]
    ds_read_b64_tr_b16 a[22:23], v27 offset:33280
    v_sub_f32_e64 v79, v79, v54
    v_mfma_f32_16x16x32_bf16 v[176:179], a[72:75], a[52:55], v[176:179]
    ds_read_b64_tr_b16 a[24:25], v28 offset:32768
    v_mul_f32_e64 v50, v60, v60
    v_mfma_f32_16x16x32_bf16 v[180:183], a[72:75], a[56:59], v[180:183]
    ds_read_b64_tr_b16 a[26:27], v28 offset:33280
    v_mfma_f32_16x16x32_bf16 v[184:187], a[72:75], a[60:63], v[184:187]
    v_fmac_f32_e64 v50, v61, v61
    v_mfma_f32_16x16x32_bf16 v[188:191], a[72:75], a[64:67], v[188:191]
    ds_read_b64_tr_b16 a[28:29], v27 offset:40960
    v_fmac_f32_e64 v50, v62, v62
    v_mfma_f32_16x16x32_bf16 v[192:195], a[72:75], a[68:71], v[192:195]
    buffer_load_dwordx4 v2, s[36:39], s80 offen offset:1024 lds
    v_mfma_f32_16x16x32_bf16 v[196:199], a[76:79], a[52:55], v[196:199]
    ds_read_b64_tr_b16 a[30:31], v27 offset:41472
    v_fmac_f32_e64 v50, v63, v63
    v_mfma_f32_16x16x32_bf16 v[200:203], a[76:79], a[56:59], v[200:203]
    ds_read_b64_tr_b16 a[32:33], v28 offset:40960
    v_fmac_f32_e64 v50, v64, v64
    v_mfma_f32_16x16x32_bf16 v[204:207], a[76:79], a[60:63], v[204:207]
    ds_read_b64_tr_b16 a[34:35], v28 offset:41472
    v_fmac_f32_e64 v50, v65, v65
    v_mfma_f32_16x16x32_bf16 v[208:211], a[76:79], a[64:67], v[208:211]
    v_mfma_f32_16x16x32_bf16 v[212:215], a[76:79], a[68:71], v[212:215]
    v_fmac_f32_e64 v50, v66, v66
    v_mfma_f32_16x16x32_bf16 v[216:219], a[80:83], a[52:55], v[216:219]
    buffer_load_dwordx4 v3, s[36:39], s80 offen offset:2048 lds
    v_mfma_f32_16x16x32_bf16 v[220:223], a[80:83], a[56:59], v[220:223]
    v_fmac_f32 v50, v67, v67
    v_fmac_f32 v50, v68, v68
    v_mfma_f32_16x16x32_bf16 v[224:227], a[80:83], a[60:63], v[224:227]
    v_mfma_f32_16x16x32_bf16 v[228:231], a[80:83], a[64:67], v[228:231]
    v_fmac_f32_e64 v50, v69, v69
    v_mfma_f32_16x16x32_bf16 v[232:235], a[80:83], a[68:71], v[232:235]
    v_fmac_f32_e64 v50, v70, v70
    v_mfma_f32_16x16x32_bf16 v[236:239], a[84:87], a[52:55], v[236:239]
    buffer_load_dwordx4 v4, s[36:39], s80 offen offset:3072 lds
    v_mfma_f32_16x16x32_bf16 v[240:243], a[84:87], a[56:59], v[240:243]
    v_fmac_f32_e64 v50, v71, v71
    v_mfma_f32_16x16x32_bf16 v[244:247], a[84:87], a[60:63], v[244:247]
    v_fmac_f32_e64 v50, v72, v72
    v_mfma_f32_16x16x32_bf16 v[248:251], a[84:87], a[64:67], v[248:251]
    v_fmac_f32_e64 v50, v73, v73
    v_mfma_f32_16x16x32_bf16 v[252:255], a[84:87], a[68:71], v[252:255]
    s_waitcnt lgkmcnt(0)
    v_mfma_f32_16x16x32_bf16 v[96:99], a[36:39], a[0:3], v[96:99]
    ds_read_b128 a[52:55], v24 offset:20480
    v_fmac_f32 v50, v74, v74
    v_mfma_f32_16x16x32_bf16 v[100:103], a[36:39], a[4:7], v[100:103]
    ds_read_b128 a[56:59], v24 offset:22528
    v_fmac_f32_e64 v50, v75, v75
    s_add_u32 m0, s86, 102400
    v_mfma_f32_16x16x32_bf16 v[104:107], a[36:39], a[8:11], v[104:107]
    ds_read_b128 a[60:63], v24 offset:24576
    v_fmac_f32_e64 v50, v76, v76
    v_mfma_f32_16x16x32_bf16 v[108:111], a[36:39], a[12:15], v[108:111]
    buffer_load_dwordx4 v5, s[36:39], s80 offen offset:0 lds
    v_mfma_f32_16x16x32_bf16 v[112:115], a[36:39], a[16:19], v[112:115]
    ds_read_b128 a[64:67], v24 offset:26624
    v_fmac_f32_e64 v50, v77, v77
    v_mfma_f32_16x16x32_bf16 v[116:119], a[40:43], a[0:3], v[116:119]
    ds_read_b128 a[68:71], v24 offset:28672
    v_fmac_f32_e64 v50, v78, v78
    v_mfma_f32_16x16x32_bf16 v[120:123], a[40:43], a[4:7], v[120:123]
    ds_read_b64_tr_b16 a[88:89], v27 offset:53248
    v_mfma_f32_16x16x32_bf16 v[124:127], a[40:43], a[8:11], v[124:127]
    v_fmac_f32_e64 v50, v79, v79
    v_mfma_f32_16x16x32_bf16 v[128:131], a[40:43], a[12:15], v[128:131]
    ds_read_b64_tr_b16 a[90:91], v27 offset:53760
    v_add_f32_dpp v50, v50, v50 quad_perm:[1,0,3,2] row_mask:0xf bank_mask:0xf
    v_mfma_f32_16x16x32_bf16 v[132:135], a[40:43], a[16:19], v[132:135]
    ds_read_b64_tr_b16 a[92:93], v28 offset:53248
    s_bfe_u32 s92, s78, 262168
    v_add_f32_dpp v50, v50, v50 quad_perm:[2,3,0,1] row_mask:0xf bank_mask:0xf
    v_mfma_f32_16x16x32_bf16 v[136:139], a[44:47], a[0:3], v[136:139]
    ds_read_b64_tr_b16 a[94:95], v28 offset:53760
    v_mfma_f32_16x16x32_bf16 v[140:143], a[44:47], a[4:7], v[140:143]
    v_add_f32_dpp v50, v50, v50 row_half_mirror row_mask:0xf bank_mask:0xf
    s_mul_i32 s81, s92, s83
    v_mfma_f32_16x16x32_bf16 v[144:147], a[44:47], a[8:11], v[144:147]
    ds_read_b64_tr_b16 a[96:97], v27 offset:61440
    v_add_f32_dpp v50, v50, v50 row_mirror row_mask:0xf bank_mask:0xf
    v_mfma_f32_16x16x32_bf16 v[148:151], a[44:47], a[12:15], v[148:151]
    s_add_u32 m0, s85, 0
    ds_read_b64_tr_b16 a[98:99], v27 offset:61952
    v_mov_b32_e64 v51, v50
    v_mfma_f32_16x16x32_bf16 v[152:155], a[44:47], a[16:19], v[152:155]
    ds_read_b64_tr_b16 a[100:101], v28 offset:61440
    v_mfma_f32_16x16x32_bf16 v[156:159], a[48:51], a[0:3], v[156:159]
    buffer_load_dwordx4 v11, s[40:43], s81 offen offset:0 lds
    v_mfma_f32_16x16x32_bf16 v[160:163], a[48:51], a[4:7], v[160:163]
    v_permlane16_swap_b32 v50, v51
    v_add_f32 v50, v50, v51
    v_mfma_f32_16x16x32_bf16 v[164:167], a[48:51], a[8:11], v[164:167]
    ds_read_b64_tr_b16 a[102:103], v28 offset:61952
    v_mfma_f32_16x16x32_bf16 v[168:171], a[48:51], a[12:15], v[168:171]
    ds_read_b64_tr_b16 a[72:73], v27 offset:36864
    v_mul_f32 v50, 0x3acccccd, v50
    v_mfma_f32_16x16x32_bf16 v[172:175], a[48:51], a[16:19], v[172:175]
    ds_read_b64_tr_b16 a[74:75], v27 offset:37376
    v_cvt_pk_bf16_f32 v50, v50, v50
    v_mfma_f32_16x16x32_bf16 v[176:179], a[20:23], a[0:3], v[176:179]
    ds_read_b64_tr_b16 a[76:77], v28 offset:36864
    v_lshlrev_b32_e64 v50, 16, v50
    v_mfma_f32_16x16x32_bf16 v[180:183], a[20:23], a[4:7], v[180:183]
    buffer_load_dwordx4 v12, s[40:43], s81 offen offset:1024 lds
    v_mfma_f32_16x16x32_bf16 v[184:187], a[20:23], a[8:11], v[184:187]
    ds_read_b64_tr_b16 a[78:79], v28 offset:37376
    v_add_f32 v50, 0x3727c5ac, v50
    v_mfma_f32_16x16x32_bf16 v[188:191], a[20:23], a[12:15], v[188:191]
    ds_read_b64_tr_b16 a[80:81], v27 offset:45056
    v_cvt_pk_bf16_f32 v50, v50, v50
    v_mfma_f32_16x16x32_bf16 v[192:195], a[20:23], a[16:19], v[192:195]
    ds_read_b64_tr_b16 a[82:83], v27 offset:45568
    v_mfma_f32_16x16x32_bf16 v[196:199], a[24:27], a[0:3], v[196:199]
    v_lshlrev_b32_e64 v50, 16, v50
    v_mfma_f32_16x16x32_bf16 v[200:203], a[24:27], a[4:7], v[200:203]
    ds_read_b64_tr_b16 a[84:85], v28 offset:45056
    v_mfma_f32_16x16x32_bf16 v[204:207], a[24:27], a[8:11], v[204:207]
    v_sqrt_f32_e64 v50, v50
    v_mfma_f32_16x16x32_bf16 v[208:211], a[24:27], a[12:15], v[208:211]
    ds_read_b64_tr_b16 a[86:87], v28 offset:45568
    v_lshlrev_b32_e64 v52, 3, v94
    v_mfma_f32_16x16x32_bf16 v[212:215], a[24:27], a[16:19], v[212:215]
    buffer_load_dwordx4 v13, s[40:43], s81 offen offset:2048 lds
    v_mfma_f32_16x16x32_bf16 v[216:219], a[28:31], a[0:3], v[216:219]
    v_mov_b32 v57, s72
    v_lshlrev_b32 v94, 2, v0
    v_mfma_f32_16x16x32_bf16 v[220:223], a[28:31], a[4:7], v[220:223]
    v_cvt_pk_bf16_f32 v56, v54, v50
    v_mfma_f32_16x16x32_bf16 v[224:227], a[28:31], a[8:11], v[224:227]
    buffer_load_dwordx4 v14, s[40:43], s81 offen offset:3072 lds
    v_mfma_f32_16x16x32_bf16 v[228:231], a[28:31], a[12:15], v[228:231]
    s_movk_i32 s93, 4096
    s_mov_b32 s94, 1
    v_mfma_f32_16x16x32_bf16 v[232:235], a[28:31], a[16:19], v[232:235]
    s_mov_b32 s95, 1
    v_mfma_f32_16x16x32_bf16 v[236:239], a[32:35], a[0:3], v[236:239]
    s_mov_b64 exec, s[94:95]
    buffer_store_dwordx2 v[56:57], v52, s[44:47], s93 offen sc1
    s_mov_b64 exec, -1
    v_mfma_f32_16x16x32_bf16 v[240:243], a[32:35], a[4:7], v[240:243]
    v_mfma_f32_16x16x32_bf16 v[244:247], a[32:35], a[8:11], v[244:247]
    v_mfma_f32_16x16x32_bf16 v[248:251], a[32:35], a[12:15], v[248:251]
    v_mfma_f32_16x16x32_bf16 v[252:255], a[32:35], a[16:19], v[252:255]
    s_waitcnt vmcnt(10) lgkmcnt(0)
    s_barrier
    v_mfma_f32_16x16x32_bf16 v[96:99], a[88:91], a[52:55], v[96:99]
    ds_read_b128 a[0:3], v23 offset:40960
    s_add_u32 s81, s81, s84
    v_mfma_f32_16x16x32_bf16 v[100:103], a[88:91], a[56:59], v[100:103]
    ds_read_b128 a[4:7], v23 offset:43008
    s_add_u32 m0, s85, 4096
    v_mfma_f32_16x16x32_bf16 v[104:107], a[88:91], a[60:63], v[104:107]
    ds_read_b128 a[8:11], v23 offset:45056
    v_mfma_f32_16x16x32_bf16 v[108:111], a[88:91], a[64:67], v[108:111]
    buffer_load_dwordx4 v11, s[40:43], s81 offen offset:0 lds
    v_mfma_f32_16x16x32_bf16 v[112:115], a[88:91], a[68:71], v[112:115]
    ds_read_b128 a[12:15], v23 offset:47104
    v_mfma_f32_16x16x32_bf16 v[116:119], a[92:95], a[52:55], v[116:119]
    ds_read_b128 a[16:19], v23 offset:49152
    v_mfma_f32_16x16x32_bf16 v[120:123], a[92:95], a[56:59], v[120:123]
    ds_read_b64_tr_b16 a[36:37], v86 offset:16384
    v_mfma_f32_16x16x32_bf16 v[124:127], a[92:95], a[60:63], v[124:127]
    v_mfma_f32_16x16x32_bf16 v[128:131], a[92:95], a[64:67], v[128:131]
    ds_read_b64_tr_b16 a[38:39], v86 offset:16896
    v_mfma_f32_16x16x32_bf16 v[132:135], a[92:95], a[68:71], v[132:135]
    buffer_load_dwordx4 v12, s[40:43], s81 offen offset:1024 lds
    v_mfma_f32_16x16x32_bf16 v[136:139], a[96:99], a[52:55], v[136:139]
    ds_read_b64_tr_b16 a[40:41], v87 offset:16384
    v_mfma_f32_16x16x32_bf16 v[140:143], a[96:99], a[56:59], v[140:143]
    ds_read_b64_tr_b16 a[42:43], v87 offset:16896
    v_mfma_f32_16x16x32_bf16 v[144:147], a[96:99], a[60:63], v[144:147]
    ds_read_b64_tr_b16 a[44:45], v86 offset:24576
    v_mfma_f32_16x16x32_bf16 v[148:151], a[96:99], a[64:67], v[148:151]
    buffer_load_dwordx4 v13, s[40:43], s81 offen offset:2048 lds
    v_mfma_f32_16x16x32_bf16 v[152:155], a[96:99], a[68:71], v[152:155]
    ds_read_b64_tr_b16 a[46:47], v86 offset:25088
    v_mfma_f32_16x16x32_bf16 v[156:159], a[100:103], a[52:55], v[156:159]
    ds_read_b64_tr_b16 a[48:49], v87 offset:24576
    v_mfma_f32_16x16x32_bf16 v[160:163], a[100:103], a[56:59], v[160:163]
    ds_read_b64_tr_b16 a[50:51], v87 offset:25088
    v_mfma_f32_16x16x32_bf16 v[164:167], a[100:103], a[60:63], v[164:167]
    ds_read_b64_tr_b16 a[20:21], v86 offset:0
    v_mfma_f32_16x16x32_bf16 v[168:171], a[100:103], a[64:67], v[168:171]
    buffer_load_dwordx4 v14, s[40:43], s81 offen offset:3072 lds
    v_mfma_f32_16x16x32_bf16 v[172:175], a[100:103], a[68:71], v[172:175]
    ds_read_b64_tr_b16 a[22:23], v86 offset:512
    v_mfma_f32_16x16x32_bf16 v[176:179], a[72:75], a[52:55], v[176:179]
    ds_read_b64_tr_b16 a[24:25], v87 offset:0
    v_mfma_f32_16x16x32_bf16 v[180:183], a[72:75], a[56:59], v[180:183]
    ds_read_b64_tr_b16 a[26:27], v87 offset:512
    v_mfma_f32_16x16x32_bf16 v[184:187], a[72:75], a[60:63], v[184:187]
    ds_read_b64_tr_b16 a[28:29], v86 offset:8192
    v_mfma_f32_16x16x32_bf16 v[188:191], a[72:75], a[64:67], v[188:191]
    s_bfe_u32 s92, s78, 262172
    v_mfma_f32_16x16x32_bf16 v[192:195], a[72:75], a[68:71], v[192:195]
    ds_read_b64_tr_b16 a[30:31], v86 offset:8704
    s_lshl_b32 s80, s92, 7
    v_mfma_f32_16x16x32_bf16 v[196:199], a[76:79], a[52:55], v[196:199]
    ds_read_b64_tr_b16 a[32:33], v87 offset:8192
    v_mfma_f32_16x16x32_bf16 v[200:203], a[76:79], a[56:59], v[200:203]
    s_add_u32 m0, s86, 118784
    ds_read_b64_tr_b16 a[34:35], v87 offset:8704
    v_mfma_f32_16x16x32_bf16 v[204:207], a[76:79], a[60:63], v[204:207]
    s_mov_b64 exec, s[90:91]
    buffer_load_dwordx4 v1, s[36:39], s80 offen offset:0 lds
    s_mov_b64 exec, -1
    v_mfma_f32_16x16x32_bf16 v[208:211], a[76:79], a[64:67], v[208:211]
    v_mfma_f32_16x16x32_bf16 v[212:215], a[76:79], a[68:71], v[212:215]
    v_mfma_f32_16x16x32_bf16 v[216:219], a[80:83], a[52:55], v[216:219]
    v_mfma_f32_16x16x32_bf16 v[220:223], a[80:83], a[56:59], v[220:223]
    v_mfma_f32_16x16x32_bf16 v[224:227], a[80:83], a[60:63], v[224:227]
    buffer_load_dwordx4 v2, s[36:39], s80 offen offset:1024 lds
    v_mfma_f32_16x16x32_bf16 v[228:231], a[80:83], a[64:67], v[228:231]
    v_mfma_f32_16x16x32_bf16 v[232:235], a[80:83], a[68:71], v[232:235]
    v_mfma_f32_16x16x32_bf16 v[236:239], a[84:87], a[52:55], v[236:239]
    v_mfma_f32_16x16x32_bf16 v[240:243], a[84:87], a[56:59], v[240:243]
    v_mfma_f32_16x16x32_bf16 v[244:247], a[84:87], a[60:63], v[244:247]
    buffer_load_dwordx4 v3, s[36:39], s80 offen offset:2048 lds
    v_mfma_f32_16x16x32_bf16 v[248:251], a[84:87], a[64:67], v[248:251]
    v_mfma_f32_16x16x32_bf16 v[252:255], a[84:87], a[68:71], v[252:255]
    s_waitcnt lgkmcnt(0)
    v_mfma_f32_16x16x32_bf16 v[96:99], a[36:39], a[0:3], v[96:99]
    ds_read_b128 a[52:55], v24 offset:40960
    v_mfma_f32_16x16x32_bf16 v[100:103], a[36:39], a[4:7], v[100:103]
    ds_read_b128 a[56:59], v24 offset:43008
    v_mfma_f32_16x16x32_bf16 v[104:107], a[36:39], a[8:11], v[104:107]
    ds_read_b128 a[60:63], v24 offset:45056
    v_mfma_f32_16x16x32_bf16 v[108:111], a[36:39], a[12:15], v[108:111]
    buffer_load_dwordx4 v4, s[36:39], s80 offen offset:3072 lds
    v_mfma_f32_16x16x32_bf16 v[112:115], a[36:39], a[16:19], v[112:115]
    ds_read_b128 a[64:67], v24 offset:47104
    v_mfma_f32_16x16x32_bf16 v[116:119], a[40:43], a[0:3], v[116:119]
    ds_read_b128 a[68:71], v24 offset:49152
    v_mfma_f32_16x16x32_bf16 v[120:123], a[40:43], a[4:7], v[120:123]
    ds_read_b64_tr_b16 a[88:89], v86 offset:20480
    v_mfma_f32_16x16x32_bf16 v[124:127], a[40:43], a[8:11], v[124:127]
    s_add_u32 m0, s86, 122880
    v_mfma_f32_16x16x32_bf16 v[128:131], a[40:43], a[12:15], v[128:131]
    ds_read_b64_tr_b16 a[90:91], v86 offset:20992
    v_mfma_f32_16x16x32_bf16 v[132:135], a[40:43], a[16:19], v[132:135]
    buffer_load_dwordx4 v5, s[36:39], s80 offen offset:0 lds
    v_mfma_f32_16x16x32_bf16 v[136:139], a[44:47], a[0:3], v[136:139]
    ds_read_b64_tr_b16 a[92:93], v87 offset:20480
    v_mfma_f32_16x16x32_bf16 v[140:143], a[44:47], a[4:7], v[140:143]
    ds_read_b64_tr_b16 a[94:95], v87 offset:20992
    v_mfma_f32_16x16x32_bf16 v[144:147], a[44:47], a[8:11], v[144:147]
    ds_read_b64_tr_b16 a[96:97], v86 offset:28672
    v_mfma_f32_16x16x32_bf16 v[148:151], a[44:47], a[12:15], v[148:151]
    ds_read_b64_tr_b16 a[98:99], v86 offset:29184
    v_mfma_f32_16x16x32_bf16 v[152:155], a[44:47], a[16:19], v[152:155]
    s_bfe_u32 s92, s78, 262172
    ds_read_b64_tr_b16 a[100:101], v87 offset:28672
    v_mfma_f32_16x16x32_bf16 v[156:159], a[48:51], a[0:3], v[156:159]
    s_mul_i32 s81, s92, s83
    v_mfma_f32_16x16x32_bf16 v[160:163], a[48:51], a[4:7], v[160:163]
    ds_read_b64_tr_b16 a[102:103], v87 offset:29184
    v_mfma_f32_16x16x32_bf16 v[164:167], a[48:51], a[8:11], v[164:167]
    ds_read_b64_tr_b16 a[72:73], v86 offset:4096
    s_add_u32 m0, s85, 32768
    v_mfma_f32_16x16x32_bf16 v[168:171], a[48:51], a[12:15], v[168:171]
    ds_read_b64_tr_b16 a[74:75], v86 offset:4608
    v_mfma_f32_16x16x32_bf16 v[172:175], a[48:51], a[16:19], v[172:175]
    buffer_load_dwordx4 v11, s[40:43], s81 offen offset:0 lds
    v_mfma_f32_16x16x32_bf16 v[176:179], a[20:23], a[0:3], v[176:179]
    ds_read_b64_tr_b16 a[76:77], v87 offset:4096
    v_mfma_f32_16x16x32_bf16 v[180:183], a[20:23], a[4:7], v[180:183]
    ds_read_b64_tr_b16 a[78:79], v87 offset:4608
    v_mfma_f32_16x16x32_bf16 v[184:187], a[20:23], a[8:11], v[184:187]
    ds_read_b64_tr_b16 a[80:81], v86 offset:12288
    v_mfma_f32_16x16x32_bf16 v[188:191], a[20:23], a[12:15], v[188:191]
    buffer_load_dwordx4 v12, s[40:43], s81 offen offset:1024 lds
    v_mfma_f32_16x16x32_bf16 v[192:195], a[20:23], a[16:19], v[192:195]
    ds_read_b64_tr_b16 a[82:83], v86 offset:12800
    v_mfma_f32_16x16x32_bf16 v[196:199], a[24:27], a[0:3], v[196:199]
    ds_read_b64_tr_b16 a[84:85], v87 offset:12288
    v_mfma_f32_16x16x32_bf16 v[200:203], a[24:27], a[4:7], v[200:203]
    ds_read_b64_tr_b16 a[86:87], v87 offset:12800
    v_mfma_f32_16x16x32_bf16 v[204:207], a[24:27], a[8:11], v[204:207]
    v_mfma_f32_16x16x32_bf16 v[208:211], a[24:27], a[12:15], v[208:211]
    buffer_load_dwordx4 v13, s[40:43], s81 offen offset:2048 lds
    v_mfma_f32_16x16x32_bf16 v[212:215], a[24:27], a[16:19], v[212:215]
    v_mfma_f32_16x16x32_bf16 v[216:219], a[28:31], a[0:3], v[216:219]
    v_mfma_f32_16x16x32_bf16 v[220:223], a[28:31], a[4:7], v[220:223]
    v_mfma_f32_16x16x32_bf16 v[224:227], a[28:31], a[8:11], v[224:227]
    v_mfma_f32_16x16x32_bf16 v[228:231], a[28:31], a[12:15], v[228:231]
    buffer_load_dwordx4 v14, s[40:43], s81 offen offset:3072 lds
    v_mfma_f32_16x16x32_bf16 v[232:235], a[28:31], a[16:19], v[232:235]
    v_mfma_f32_16x16x32_bf16 v[236:239], a[32:35], a[0:3], v[236:239]
    v_mfma_f32_16x16x32_bf16 v[240:243], a[32:35], a[4:7], v[240:243]
    v_mfma_f32_16x16x32_bf16 v[244:247], a[32:35], a[8:11], v[244:247]
    v_mfma_f32_16x16x32_bf16 v[248:251], a[32:35], a[12:15], v[248:251]
    v_mfma_f32_16x16x32_bf16 v[252:255], a[32:35], a[16:19], v[252:255]
    s_waitcnt vmcnt(9) lgkmcnt(0)
    s_barrier
    v_mfma_f32_16x16x32_bf16 v[96:99], a[88:91], a[52:55], v[96:99]
    ds_read_b128 a[0:3], v23 offset:0
    s_add_u32 s81, s81, s84
    v_mfma_f32_16x16x32_bf16 v[100:103], a[88:91], a[56:59], v[100:103]
    s_add_u32 m0, s85, 36864
    ds_read_b128 a[4:7], v23 offset:2048
    v_mfma_f32_16x16x32_bf16 v[104:107], a[88:91], a[60:63], v[104:107]
    buffer_load_dwordx4 v11, s[40:43], s81 offen offset:0 lds
    v_mfma_f32_16x16x32_bf16 v[108:111], a[88:91], a[64:67], v[108:111]
    ds_read_b128 a[8:11], v23 offset:4096
    v_mfma_f32_16x16x32_bf16 v[112:115], a[88:91], a[68:71], v[112:115]
    ds_read_b128 a[12:15], v23 offset:6144
    v_mfma_f32_16x16x32_bf16 v[116:119], a[92:95], a[52:55], v[116:119]
    ds_read_b128 a[16:19], v23 offset:8192
    v_mfma_f32_16x16x32_bf16 v[120:123], a[92:95], a[56:59], v[120:123]
    buffer_load_dwordx4 v12, s[40:43], s81 offen offset:1024 lds
    v_mfma_f32_16x16x32_bf16 v[124:127], a[92:95], a[60:63], v[124:127]
    ds_read_b64_tr_b16 a[36:37], v27 offset:16384
    v_mfma_f32_16x16x32_bf16 v[128:131], a[92:95], a[64:67], v[128:131]
    ds_read_b64_tr_b16 a[38:39], v27 offset:16896
    v_mfma_f32_16x16x32_bf16 v[132:135], a[92:95], a[68:71], v[132:135]
    ds_read_b64_tr_b16 a[40:41], v28 offset:16384
    v_mfma_f32_16x16x32_bf16 v[136:139], a[96:99], a[52:55], v[136:139]
    buffer_load_dwordx4 v13, s[40:43], s81 offen offset:2048 lds
    v_mfma_f32_16x16x32_bf16 v[140:143], a[96:99], a[56:59], v[140:143]
    ds_read_b64_tr_b16 a[42:43], v28 offset:16896
    v_mfma_f32_16x16x32_bf16 v[144:147], a[96:99], a[60:63], v[144:147]
    ds_read_b64_tr_b16 a[44:45], v27 offset:24576
    v_mfma_f32_16x16x32_bf16 v[148:151], a[96:99], a[64:67], v[148:151]
    ds_read_b64_tr_b16 a[46:47], v27 offset:25088
    v_mfma_f32_16x16x32_bf16 v[152:155], a[96:99], a[68:71], v[152:155]
    buffer_load_dwordx4 v14, s[40:43], s81 offen offset:3072 lds
    v_mfma_f32_16x16x32_bf16 v[156:159], a[100:103], a[52:55], v[156:159]
    ds_read_b64_tr_b16 a[48:49], v28 offset:24576
    v_mfma_f32_16x16x32_bf16 v[160:163], a[100:103], a[56:59], v[160:163]
    ds_read_b64_tr_b16 a[50:51], v28 offset:25088
    v_mfma_f32_16x16x32_bf16 v[164:167], a[100:103], a[60:63], v[164:167]
    ds_read_b64_tr_b16 a[20:21], v27 offset:0
    s_bfe_u32 s92, s79, 262144
    v_mfma_f32_16x16x32_bf16 v[168:171], a[100:103], a[64:67], v[168:171]
    ds_read_b64_tr_b16 a[22:23], v27 offset:512
    v_mfma_f32_16x16x32_bf16 v[172:175], a[100:103], a[68:71], v[172:175]
    s_lshl_b32 s80, s92, 7
    v_mfma_f32_16x16x32_bf16 v[176:179], a[72:75], a[52:55], v[176:179]
    ds_read_b64_tr_b16 a[24:25], v28 offset:0
    s_add_u32 m0, s86, 139264
    v_mfma_f32_16x16x32_bf16 v[180:183], a[72:75], a[56:59], v[180:183]
    ds_read_b64_tr_b16 a[26:27], v28 offset:512
    v_mfma_f32_16x16x32_bf16 v[184:187], a[72:75], a[60:63], v[184:187]
    s_mov_b64 exec, s[90:91]
    buffer_load_dwordx4 v1, s[36:39], s80 offen offset:0 lds
    s_mov_b64 exec, -1
    v_mfma_f32_16x16x32_bf16 v[188:191], a[72:75], a[64:67], v[188:191]
    ds_read_b64_tr_b16 a[28:29], v27 offset:8192
    v_mfma_f32_16x16x32_bf16 v[192:195], a[72:75], a[68:71], v[192:195]
    ds_read_b64_tr_b16 a[30:31], v27 offset:8704
    v_mfma_f32_16x16x32_bf16 v[196:199], a[76:79], a[52:55], v[196:199]
    buffer_load_dwordx4 v2, s[36:39], s80 offen offset:1024 lds
    v_mfma_f32_16x16x32_bf16 v[200:203], a[76:79], a[56:59], v[200:203]
    ds_read_b64_tr_b16 a[32:33], v28 offset:8192
    v_mfma_f32_16x16x32_bf16 v[204:207], a[76:79], a[60:63], v[204:207]
    ds_read_b64_tr_b16 a[34:35], v28 offset:8704
    v_mfma_f32_16x16x32_bf16 v[208:211], a[76:79], a[64:67], v[208:211]
    v_mfma_f32_16x16x32_bf16 v[212:215], a[76:79], a[68:71], v[212:215]
    buffer_load_dwordx4 v3, s[36:39], s80 offen offset:2048 lds
    v_mfma_f32_16x16x32_bf16 v[216:219], a[80:83], a[52:55], v[216:219]
    v_mfma_f32_16x16x32_bf16 v[220:223], a[80:83], a[56:59], v[220:223]
    v_mfma_f32_16x16x32_bf16 v[224:227], a[80:83], a[60:63], v[224:227]
    v_mfma_f32_16x16x32_bf16 v[228:231], a[80:83], a[64:67], v[228:231]
    buffer_load_dwordx4 v4, s[36:39], s80 offen offset:3072 lds
    v_mfma_f32_16x16x32_bf16 v[232:235], a[80:83], a[68:71], v[232:235]
    v_mfma_f32_16x16x32_bf16 v[236:239], a[84:87], a[52:55], v[236:239]
    v_mfma_f32_16x16x32_bf16 v[240:243], a[84:87], a[56:59], v[240:243]
    s_add_u32 m0, s86, 143360
    v_mfma_f32_16x16x32_bf16 v[244:247], a[84:87], a[60:63], v[244:247]
    v_mfma_f32_16x16x32_bf16 v[248:251], a[84:87], a[64:67], v[248:251]
    buffer_load_dwordx4 v5, s[36:39], s80 offen offset:0 lds
    v_mfma_f32_16x16x32_bf16 v[252:255], a[84:87], a[68:71], v[252:255]
    s_waitcnt lgkmcnt(0)
    v_mfma_f32_16x16x32_bf16 v[96:99], a[36:39], a[0:3], v[96:99]
    ds_read_b128 a[52:55], v24 offset:0
    v_mfma_f32_16x16x32_bf16 v[100:103], a[36:39], a[4:7], v[100:103]
L_pad3:
    s_cbranch_execz L_pad14
    s_nop 0
    ds_read_b128 a[56:59], v24 offset:2048
    v_mfma_f32_16x16x32_bf16 v[104:107], a[36:39], a[8:11], v[104:107]
    s_bfe_u32 s92, s79, 262144
    ds_read_b128 a[60:63], v24 offset:4096
    v_mfma_f32_16x16x32_bf16 v[108:111], a[36:39], a[12:15], v[108:111]
    s_mul_i32 s81, s92, s83
    v_mfma_f32_16x16x32_bf16 v[112:115], a[36:39], a[16:19], v[112:115]
    ds_read_b128 a[64:67], v24 offset:6144
    s_add_u32 m0, s85, 65536
    v_mfma_f32_16x16x32_bf16 v[116:119], a[40:43], a[0:3], v[116:119]
    ds_read_b128 a[68:71], v24 offset:8192
    v_mfma_f32_16x16x32_bf16 v[120:123], a[40:43], a[4:7], v[120:123]
    buffer_load_dwordx4 v11, s[40:43], s81 offen offset:0 lds
    v_mfma_f32_16x16x32_bf16 v[124:127], a[40:43], a[8:11], v[124:127]
    ds_read_b64_tr_b16 a[88:89], v27 offset:20480
    v_mfma_f32_16x16x32_bf16 v[128:131], a[40:43], a[12:15], v[128:131]
    ds_read_b64_tr_b16 a[90:91], v27 offset:20992
    v_mfma_f32_16x16x32_bf16 v[132:135], a[40:43], a[16:19], v[132:135]
    ds_read_b64_tr_b16 a[92:93], v28 offset:20480
    v_mfma_f32_16x16x32_bf16 v[136:139], a[44:47], a[0:3], v[136:139]
    buffer_load_dwordx4 v12, s[40:43], s81 offen offset:1024 lds
    v_mfma_f32_16x16x32_bf16 v[140:143], a[44:47], a[4:7], v[140:143]
    ds_read_b64_tr_b16 a[94:95], v28 offset:20992
    v_mfma_f32_16x16x32_bf16 v[144:147], a[44:47], a[8:11], v[144:147]
    ds_read_b64_tr_b16 a[96:97], v27 offset:28672
    v_mfma_f32_16x16x32_bf16 v[148:151], a[44:47], a[12:15], v[148:151]
    buffer_load_dwordx4 v13, s[40:43], s81 offen offset:2048 lds
    v_mfma_f32_16x16x32_bf16 v[152:155], a[44:47], a[16:19], v[152:155]
    ds_read_b64_tr_b16 a[98:99], v27 offset:29184
    v_mfma_f32_16x16x32_bf16 v[156:159], a[48:51], a[0:3], v[156:159]
    ds_read_b64_tr_b16 a[100:101], v28 offset:28672
    v_mfma_f32_16x16x32_bf16 v[160:163], a[48:51], a[4:7], v[160:163]
    ds_read_b64_tr_b16 a[102:103], v28 offset:29184
    v_mfma_f32_16x16x32_bf16 v[164:167], a[48:51], a[8:11], v[164:167]
    buffer_load_dwordx4 v14, s[40:43], s81 offen offset:3072 lds
    v_mfma_f32_16x16x32_bf16 v[168:171], a[48:51], a[12:15], v[168:171]
    ds_read_b64_tr_b16 a[72:73], v27 offset:4096
    v_mfma_f32_16x16x32_bf16 v[172:175], a[48:51], a[16:19], v[172:175]
    ds_read_b64_tr_b16 a[74:75], v27 offset:4608
    v_mfma_f32_16x16x32_bf16 v[176:179], a[20:23], a[0:3], v[176:179]
    ds_read_b64_tr_b16 a[76:77], v28 offset:4096
    v_mfma_f32_16x16x32_bf16 v[180:183], a[20:23], a[4:7], v[180:183]
    s_add_u32 s81, s81, s84
    ds_read_b64_tr_b16 a[78:79], v28 offset:4608
    v_mfma_f32_16x16x32_bf16 v[184:187], a[20:23], a[8:11], v[184:187]
    s_add_u32 m0, s85, 69632
    ds_read_b64_tr_b16 a[80:81], v27 offset:12288
    v_mfma_f32_16x16x32_bf16 v[188:191], a[20:23], a[12:15], v[188:191]
    buffer_load_dwordx4 v11, s[40:43], s81 offen offset:0 lds
    v_mfma_f32_16x16x32_bf16 v[192:195], a[20:23], a[16:19], v[192:195]
    ds_read_b64_tr_b16 a[82:83], v27 offset:12800
    v_mfma_f32_16x16x32_bf16 v[196:199], a[24:27], a[0:3], v[196:199]
    ds_read_b64_tr_b16 a[84:85], v28 offset:12288
    v_mfma_f32_16x16x32_bf16 v[200:203], a[24:27], a[4:7], v[200:203]
    ds_read_b64_tr_b16 a[86:87], v28 offset:12800
    v_mfma_f32_16x16x32_bf16 v[204:207], a[24:27], a[8:11], v[204:207]
    buffer_load_dwordx4 v12, s[40:43], s81 offen offset:1024 lds
    v_mfma_f32_16x16x32_bf16 v[208:211], a[24:27], a[12:15], v[208:211]
    v_mfma_f32_16x16x32_bf16 v[212:215], a[24:27], a[16:19], v[212:215]
    v_mfma_f32_16x16x32_bf16 v[216:219], a[28:31], a[0:3], v[216:219]
    v_mfma_f32_16x16x32_bf16 v[220:223], a[28:31], a[4:7], v[220:223]
    buffer_load_dwordx4 v13, s[40:43], s81 offen offset:2048 lds
    v_mfma_f32_16x16x32_bf16 v[224:227], a[28:31], a[8:11], v[224:227]
    v_mfma_f32_16x16x32_bf16 v[228:231], a[28:31], a[12:15], v[228:231]
    v_mfma_f32_16x16x32_bf16 v[232:235], a[28:31], a[16:19], v[232:235]
    v_mfma_f32_16x16x32_bf16 v[236:239], a[32:35], a[0:3], v[236:239]
    buffer_load_dwordx4 v14, s[40:43], s81 offen offset:3072 lds
    v_mfma_f32_16x16x32_bf16 v[240:243], a[32:35], a[4:7], v[240:243]
    v_mfma_f32_16x16x32_bf16 v[244:247], a[32:35], a[8:11], v[244:247]
    v_mfma_f32_16x16x32_bf16 v[248:251], a[32:35], a[12:15], v[248:251]
    v_mfma_f32_16x16x32_bf16 v[252:255], a[32:35], a[16:19], v[252:255]
L_kjoin:
    s_waitcnt vmcnt(13) lgkmcnt(0)
    s_barrier
    v_mfma_f32_16x16x32_bf16 v[96:99], a[88:91], a[52:55], v[96:99]
    ds_read_b128 a[0:3], v23 offset:20480
    s_bfe_u32 s92, s79, 262148
    v_and_b32_e64 v55, 15, v0
    v_mfma_f32_16x16x32_bf16 v[100:103], a[88:91], a[56:59], v[100:103]
    ds_read_b128 a[4:7], v23 offset:22528
    s_lshl_b32 s80, s92, 7
    v_mfma_f32_16x16x32_bf16 v[104:107], a[88:91], a[60:63], v[104:107]
    ds_read_b128 a[8:11], v23 offset:24576
    s_add_u32 m0, s86, 98304
    s_lshl_b32 s88, s71, 7
    v_mfma_f32_16x16x32_bf16 v[108:111], a[88:91], a[64:67], v[108:111]
    v_lshl_add_u32 v54, v55, 3, s88
    v_mfma_f32_16x16x32_bf16 v[112:115], a[88:91], a[68:71], v[112:115]
    ds_read_b128 a[12:15], v23 offset:26624
    v_mfma_f32_16x16x32_bf16 v[116:119], a[92:95], a[52:55], v[116:119]
    s_mov_b64 exec, s[90:91]
    buffer_load_dwordx4 v1, s[36:39], s80 offen offset:0 lds
    s_mov_b64 exec, -1
    v_mfma_f32_16x16x32_bf16 v[120:123], a[92:95], a[56:59], v[120:123]
    ds_read_b128 a[16:19], v23 offset:28672
    v_mul_u32_u24_e64 v55, 20, v95
    v_mfma_f32_16x16x32_bf16 v[124:127], a[92:95], a[60:63], v[124:127]
    ds_read_b64_tr_b16 a[36:37], v27 offset:49152
    v_mfma_f32_16x16x32_bf16 v[128:131], a[92:95], a[64:67], v[128:131]
    ds_read_b64_tr_b16 a[38:39], v27 offset:49664
    v_mfma_f32_16x16x32_bf16 v[132:135], a[92:95], a[68:71], v[132:135]
    buffer_load_dwordx4 v2, s[36:39], s80 offen offset:1024 lds
    v_mfma_f32_16x16x32_bf16 v[136:139], a[96:99], a[52:55], v[136:139]
    ds_read_b64_tr_b16 a[40:41], v28 offset:49152
    s_mul_i32 s88, s70, 79
    s_add_u32 s88, s88, s64
    v_mfma_f32_16x16x32_bf16 v[140:143], a[96:99], a[56:59], v[140:143]
    ds_read_b64_tr_b16 a[42:43], v28 offset:49664
    v_mov_b32 v56, v55
    v_mfma_f32_16x16x32_bf16 v[144:147], a[96:99], a[60:63], v[144:147]
    ds_read_b64_tr_b16 a[44:45], v27 offset:57344
    v_mfma_f32_16x16x32_bf16 v[148:151], a[96:99], a[64:67], v[148:151]
    buffer_load_dwordx4 v3, s[36:39], s80 offen offset:2048 lds
    v_mfma_f32_16x16x32_bf16 v[152:155], a[96:99], a[68:71], v[152:155]
    ds_read_b64_tr_b16 a[46:47], v27 offset:57856
    v_add_u32_e64 v55, s88, v55
    v_mfma_f32_16x16x32_bf16 v[156:159], a[100:103], a[52:55], v[156:159]
    ds_read_b64_tr_b16 a[48:49], v28 offset:57344
    v_mfma_f32_16x16x32_bf16 v[160:163], a[100:103], a[56:59], v[160:163]
    ds_read_b64_tr_b16 a[50:51], v28 offset:57856
    s_lshl_b32 s88, s82, 2
    v_mfma_f32_16x16x32_bf16 v[164:167], a[100:103], a[60:63], v[164:167]
    ds_read_b64_tr_b16 a[20:21], v27 offset:32768
    s_add_u32 s88, s88, s64
    v_mfma_f32_16x16x32_bf16 v[168:171], a[100:103], a[64:67], v[168:171]
    buffer_load_dwordx4 v4, s[36:39], s80 offen offset:3072 lds
    v_mfma_f32_16x16x32_bf16 v[172:175], a[100:103], a[68:71], v[172:175]
    s_add_u32 s88, s88, 1975
    ds_read_b64_tr_b16 a[22:23], v27 offset:33280
    v_add_u32_e64 v56, s88, v56
    v_mfma_f32_16x16x32_bf16 v[176:179], a[72:75], a[52:55], v[176:179]
    ds_read_b64_tr_b16 a[24:25], v28 offset:32768
    v_mfma_f32_16x16x32_bf16 v[180:183], a[72:75], a[56:59], v[180:183]
    ds_read_b64_tr_b16 a[26:27], v28 offset:33280
    s_add_u32 m0, s86, 102400
    v_mfma_f32_16x16x32_bf16 v[184:187], a[72:75], a[60:63], v[184:187]
    v_mov_b32 v57, 1280
    v_mfma_f32_16x16x32_bf16 v[188:191], a[72:75], a[64:67], v[188:191]
    ds_read_b64_tr_b16 a[28:29], v27 offset:40960
    v_mfma_f32_16x16x32_bf16 v[192:195], a[72:75], a[68:71], v[192:195]
    buffer_load_dwordx4 v5, s[36:39], s80 offen offset:0 lds
    v_mfma_f32_16x16x32_bf16 v[196:199], a[76:79], a[52:55], v[196:199]
    ds_read_b64_tr_b16 a[30:31], v27 offset:41472
    v_mad_u32_u24 v50, v55, v57, v54
    v_mfma_f32_16x16x32_bf16 v[200:203], a[76:79], a[56:59], v[200:203]
    ds_read_b64_tr_b16 a[32:33], v28 offset:40960
    v_mfma_f32_16x16x32_bf16 v[204:207], a[76:79], a[60:63], v[204:207]
    ds_read_b64_tr_b16 a[34:35], v28 offset:41472
    s_bfe_u32 s92, s79, 262148
    v_mad_u32_u24 v51, v56, v57, v54
    v_mfma_f32_16x16x32_bf16 v[208:211], a[76:79], a[64:67], v[208:211]
    s_mul_i32 s81, s92, s83
    v_mfma_f32_16x16x32_bf16 v[212:215], a[76:79], a[68:71], v[212:215]
    v_mfma_f32_16x16x32_bf16 v[216:219], a[80:83], a[52:55], v[216:219]
    s_add_u32 m0, s85, 0
    s_movk_i32 s88, 4088
    v_mfma_f32_16x16x32_bf16 v[220:223], a[80:83], a[56:59], v[220:223]
    v_lshl_add_u32 v52, v55, 3, s88
    v_mfma_f32_16x16x32_bf16 v[224:227], a[80:83], a[60:63], v[224:227]
    buffer_load_dwordx4 v11, s[40:43], s81 offen offset:0 lds
    v_mfma_f32_16x16x32_bf16 v[228:231], a[80:83], a[64:67], v[228:231]
    v_mfma_f32_16x16x32_bf16 v[232:235], a[80:83], a[68:71], v[232:235]
    v_lshl_add_u32 v53, v56, 3, s88
    v_mfma_f32_16x16x32_bf16 v[236:239], a[84:87], a[52:55], v[236:239]
    v_mfma_f32_16x16x32_bf16 v[240:243], a[84:87], a[56:59], v[240:243]
    buffer_load_dwordx4 v12, s[40:43], s81 offen offset:1024 lds
    v_mfma_f32_16x16x32_bf16 v[244:247], a[84:87], a[60:63], v[244:247]
    v_max_u32 v55, v57, v50
    v_mfma_f32_16x16x32_bf16 v[248:251], a[84:87], a[64:67], v[248:251]
    v_mfma_f32_16x16x32_bf16 v[252:255], a[84:87], a[68:71], v[252:255]
    v_min_u32 v53, 20472, v53
    s_waitcnt lgkmcnt(0)
    v_mfma_f32_16x16x32_bf16 v[96:99], a[36:39], a[0:3], v[96:99]
    ds_read_b128 a[52:55], v24 offset:20480
    v_mfma_f32_16x16x32_bf16 v[100:103], a[36:39], a[4:7], v[100:103]
    buffer_load_dwordx4 v13, s[40:43], s81 offen offset:2048 lds
    v_mfma_f32_16x16x32_bf16 v[104:107], a[36:39], a[8:11], v[104:107]
    ds_read_b128 a[56:59], v24 offset:22528
    v_max_u32 v56, 4096, v52
    v_mfma_f32_16x16x32_bf16 v[108:111], a[36:39], a[12:15], v[108:111]
    ds_read_b128 a[60:63], v24 offset:24576
    v_mfma_f32_16x16x32_bf16 v[112:115], a[36:39], a[16:19], v[112:115]
    ds_read_b128 a[64:67], v24 offset:26624
    v_mfma_f32_16x16x32_bf16 v[116:119], a[40:43], a[0:3], v[116:119]
    buffer_load_dwordx4 v14, s[40:43], s81 offen offset:3072 lds
    v_mfma_f32_16x16x32_bf16 v[120:123], a[40:43], a[4:7], v[120:123]
    ds_read_b128 a[68:71], v24 offset:28672
    v_accvgpr_write_b32 a250, v52
    v_mfma_f32_16x16x32_bf16 v[124:127], a[40:43], a[8:11], v[124:127]
    ds_read_b64_tr_b16 a[88:89], v27 offset:53248
    v_mfma_f32_16x16x32_bf16 v[128:131], a[40:43], a[12:15], v[128:131]
    ds_read_b64_tr_b16 a[90:91], v27 offset:53760
    v_accvgpr_write_b32 a251, v53
    v_mfma_f32_16x16x32_bf16 v[132:135], a[40:43], a[16:19], v[132:135]
    ds_read_b64_tr_b16 a[92:93], v28 offset:53248
    s_add_u32 s81, s81, s84
    v_mfma_f32_16x16x32_bf16 v[136:139], a[44:47], a[0:3], v[136:139]
    ds_read_b64_tr_b16 a[94:95], v28 offset:53760
    s_add_u32 m0, s85, 4096
    v_mfma_f32_16x16x32_bf16 v[140:143], a[44:47], a[4:7], v[140:143]
    v_accvgpr_write_b32 a252, v56
    v_mfma_f32_16x16x32_bf16 v[144:147], a[44:47], a[8:11], v[144:147]
    ds_read_b64_tr_b16 a[96:97], v27 offset:61440
    v_mfma_f32_16x16x32_bf16 v[148:151], a[44:47], a[12:15], v[148:151]
    buffer_load_dwordx4 v11, s[40:43], s81 offen offset:0 lds
    v_mfma_f32_16x16x32_bf16 v[152:155], a[44:47], a[16:19], v[152:155]
    ds_read_b64_tr_b16 a[98:99], v27 offset:61952
    v_mfma_f32_16x16x32_bf16 v[156:159], a[48:51], a[0:3], v[156:159]
    buffer_load_dwordx2 a[248:249], v54, s[56:59], 0 offen
    v_mfma_f32_16x16x32_bf16 v[160:163], a[48:51], a[4:7], v[160:163]
    ds_read_b64_tr_b16 a[100:101], v28 offset:61440
    s_movk_i32 s88, 0
    v_mfma_f32_16x16x32_bf16 v[164:167], a[48:51], a[8:11], v[164:167]
    ds_read_b64_tr_b16 a[102:103], v28 offset:61952
    v_mfma_f32_16x16x32_bf16 v[168:171], a[48:51], a[12:15], v[168:171]
    buffer_load_dwordx4 v12, s[40:43], s81 offen offset:1024 lds
    v_mfma_f32_16x16x32_bf16 v[172:175], a[48:51], a[16:19], v[172:175]
    ds_read_b64_tr_b16 a[72:73], v27 offset:36864
    v_mfma_f32_16x16x32_bf16 v[176:179], a[20:23], a[0:3], v[176:179]
    buffer_load_dwordx2 a[104:105], v55, s[60:63], s88 offen
    v_mfma_f32_16x16x32_bf16 v[180:183], a[20:23], a[4:7], v[180:183]
    ds_read_b64_tr_b16 a[74:75], v27 offset:37376
    s_movk_i32 s88, 5120
    v_mfma_f32_16x16x32_bf16 v[184:187], a[20:23], a[8:11], v[184:187]
    ds_read_b64_tr_b16 a[76:77], v28 offset:36864
    v_mfma_f32_16x16x32_bf16 v[188:191], a[20:23], a[12:15], v[188:191]
    buffer_load_dwordx4 v13, s[40:43], s81 offen offset:2048 lds
    v_mfma_f32_16x16x32_bf16 v[192:195], a[20:23], a[16:19], v[192:195]
    ds_read_b64_tr_b16 a[78:79], v28 offset:37376
    v_mfma_f32_16x16x32_bf16 v[196:199], a[24:27], a[0:3], v[196:199]
    buffer_load_dwordx2 a[106:107], v50, s[60:63], s88 offen
    v_mfma_f32_16x16x32_bf16 v[200:203], a[24:27], a[4:7], v[200:203]
    ds_read_b64_tr_b16 a[80:81], v27 offset:45056
    s_movk_i32 s88, 10240
    v_mfma_f32_16x16x32_bf16 v[204:207], a[24:27], a[8:11], v[204:207]
    ds_read_b64_tr_b16 a[82:83], v27 offset:45568
    v_mfma_f32_16x16x32_bf16 v[208:211], a[24:27], a[12:15], v[208:211]
    buffer_load_dwordx2 a[108:109], v50, s[60:63], s88 offen
    v_mfma_f32_16x16x32_bf16 v[212:215], a[24:27], a[16:19], v[212:215]
    ds_read_b64_tr_b16 a[84:85], v28 offset:45056
    s_movk_i32 s88, 15360
    v_mfma_f32_16x16x32_bf16 v[216:219], a[28:31], a[0:3], v[216:219]
    buffer_load_dwordx4 v14, s[40:43], s81 offen offset:3072 lds
    v_mfma_f32_16x16x32_bf16 v[220:223], a[28:31], a[4:7], v[220:223]
    ds_read_b64_tr_b16 a[86:87], v28 offset:45568
    v_mfma_f32_16x16x32_bf16 v[224:227], a[28:31], a[8:11], v[224:227]
    buffer_load_dwordx2 a[110:111], v50, s[60:63], s88 offen
    v_mfma_f32_16x16x32_bf16 v[228:231], a[28:31], a[12:15], v[228:231]
    s_movk_i32 s88, 20480
    v_mfma_f32_16x16x32_bf16 v[232:235], a[28:31], a[16:19], v[232:235]
    buffer_load_dwordx2 a[112:113], v50, s[60:63], s88 offen
    v_mfma_f32_16x16x32_bf16 v[236:239], a[32:35], a[0:3], v[236:239]
    s_movk_i32 s88, 0
    v_mfma_f32_16x16x32_bf16 v[240:243], a[32:35], a[4:7], v[240:243]
    buffer_load_dwordx2 a[114:115], v51, s[60:63], s88 offen
    v_mfma_f32_16x16x32_bf16 v[244:247], a[32:35], a[8:11], v[244:247]
    v_mfma_f32_16x16x32_bf16 v[248:251], a[32:35], a[12:15], v[248:251]
    v_mfma_f32_16x16x32_bf16 v[252:255], a[32:35], a[16:19], v[252:255]
    s_waitcnt vmcnt(20) lgkmcnt(0)
    s_barrier
    v_mfma_f32_16x16x32_bf16 v[96:99], a[88:91], a[52:55], v[96:99]
    ds_read_b128 a[0:3], v23 offset:40960
    v_readlane_b32 s81, v90, 0
    v_mfma_f32_16x16x32_bf16 v[100:103], a[88:91], a[56:59], v[100:103]
    ds_read_b128 a[4:7], v23 offset:43008
    v_mfma_f32_16x16x32_bf16 v[104:107], a[88:91], a[60:63], v[104:107]
    ds_read_b128 a[8:11], v23 offset:45056
    v_mfma_f32_16x16x32_bf16 v[108:111], a[88:91], a[64:67], v[108:111]
    s_add_u32 m0, s85, 32768
    v_mfma_f32_16x16x32_bf16 v[112:115], a[88:91], a[68:71], v[112:115]
    ds_read_b128 a[12:15], v23 offset:47104
    v_mfma_f32_16x16x32_bf16 v[116:119], a[92:95], a[52:55], v[116:119]
    buffer_load_dwordx4 v15, s[96:99], s81 offen offset:0 lds
    v_mfma_f32_16x16x32_bf16 v[120:123], a[92:95], a[56:59], v[120:123]
    ds_read_b128 a[16:19], v23 offset:49152
    v_mfma_f32_16x16x32_bf16 v[124:127], a[92:95], a[60:63], v[124:127]
    ds_read_b64_tr_b16 a[36:37], v86 offset:16384
    v_mfma_f32_16x16x32_bf16 v[128:131], a[92:95], a[64:67], v[128:131]
    buffer_load_dwordx4 v16, s[96:99], s81 offen offset:1024 lds
    v_mfma_f32_16x16x32_bf16 v[132:135], a[92:95], a[68:71], v[132:135]
    ds_read_b64_tr_b16 a[38:39], v86 offset:16896
    v_mfma_f32_16x16x32_bf16 v[136:139], a[96:99], a[52:55], v[136:139]
    ds_read_b64_tr_b16 a[40:41], v87 offset:16384
    v_mfma_f32_16x16x32_bf16 v[140:143], a[96:99], a[56:59], v[140:143]
    ds_read_b64_tr_b16 a[42:43], v87 offset:16896
    v_mfma_f32_16x16x32_bf16 v[144:147], a[96:99], a[60:63], v[144:147]
    buffer_load_dwordx4 v17, s[96:99], s81 offen offset:2048 lds
    v_mfma_f32_16x16x32_bf16 v[148:151], a[96:99], a[64:67], v[148:151]
    ds_read_b64_tr_b16 a[44:45], v86 offset:24576
    v_mfma_f32_16x16x32_bf16 v[152:155], a[96:99], a[68:71], v[152:155]
    ds_read_b64_tr_b16 a[46:47], v86 offset:25088
    v_mfma_f32_16x16x32_bf16 v[156:159], a[100:103], a[52:55], v[156:159]
    buffer_load_dwordx4 v18, s[96:99], s81 offen offset:3072 lds
    v_mfma_f32_16x16x32_bf16 v[160:163], a[100:103], a[56:59], v[160:163]
    ds_read_b64_tr_b16 a[48:49], v87 offset:24576
    v_mfma_f32_16x16x32_bf16 v[164:167], a[100:103], a[60:63], v[164:167]
    ds_read_b64_tr_b16 a[50:51], v87 offset:25088
    v_readlane_b32 s81, v90, 16
    v_mfma_f32_16x16x32_bf16 v[168:171], a[100:103], a[64:67], v[168:171]
    ds_read_b64_tr_b16 a[20:21], v86 offset:0
    v_mfma_f32_16x16x32_bf16 v[172:175], a[100:103], a[68:71], v[172:175]
    ds_read_b64_tr_b16 a[22:23], v86 offset:512
    v_mfma_f32_16x16x32_bf16 v[176:179], a[72:75], a[52:55], v[176:179]
    ds_read_b64_tr_b16 a[24:25], v87 offset:0
    v_mfma_f32_16x16x32_bf16 v[180:183], a[72:75], a[56:59], v[180:183]
    s_add_u32 m0, s85, 36864
    ds_read_b64_tr_b16 a[26:27], v87 offset:512
    v_mfma_f32_16x16x32_bf16 v[184:187], a[72:75], a[60:63], v[184:187]
    buffer_load_dwordx4 v15, s[96:99], s81 offen offset:0 lds
    v_mfma_f32_16x16x32_bf16 v[188:191], a[72:75], a[64:67], v[188:191]
    ds_read_b64_tr_b16 a[28:29], v86 offset:8192
    v_mfma_f32_16x16x32_bf16 v[192:195], a[72:75], a[68:71], v[192:195]
    ds_read_b64_tr_b16 a[30:31], v86 offset:8704
    v_mfma_f32_16x16x32_bf16 v[196:199], a[76:79], a[52:55], v[196:199]
    ds_read_b64_tr_b16 a[32:33], v87 offset:8192
    v_mfma_f32_16x16x32_bf16 v[200:203], a[76:79], a[56:59], v[200:203]
    buffer_load_dwordx4 v16, s[96:99], s81 offen offset:1024 lds
    v_mfma_f32_16x16x32_bf16 v[204:207], a[76:79], a[60:63], v[204:207]
    ds_read_b64_tr_b16 a[34:35], v87 offset:8704
    v_mfma_f32_16x16x32_bf16 v[208:211], a[76:79], a[64:67], v[208:211]
    v_mfma_f32_16x16x32_bf16 v[212:215], a[76:79], a[68:71], v[212:215]
    buffer_load_dwordx4 v17, s[96:99], s81 offen offset:2048 lds
    v_mfma_f32_16x16x32_bf16 v[216:219], a[80:83], a[52:55], v[216:219]
    v_mfma_f32_16x16x32_bf16 v[220:223], a[80:83], a[56:59], v[220:223]
    v_mfma_f32_16x16x32_bf16 v[224:227], a[80:83], a[60:63], v[224:227]
    buffer_load_dwordx4 v18, s[96:99], s81 offen offset:3072 lds
    v_mfma_f32_16x16x32_bf16 v[228:231], a[80:83], a[64:67], v[228:231]
    v_mfma_f32_16x16x32_bf16 v[232:235], a[80:83], a[68:71], v[232:235]
    v_mfma_f32_16x16x32_bf16 v[236:239], a[84:87], a[52:55], v[236:239]
    s_movk_i32 s87, 4096
    v_mfma_f32_16x16x32_bf16 v[240:243], a[84:87], a[56:59], v[240:243]
    buffer_load_dwordx2 v[30:31], v33, s[44:47], s87 offen sc1
    v_mfma_f32_16x16x32_bf16 v[244:247], a[84:87], a[60:63], v[244:247]
    v_mfma_f32_16x16x32_bf16 v[248:251], a[84:87], a[64:67], v[248:251]
    v_mfma_f32_16x16x32_bf16 v[252:255], a[84:87], a[68:71], v[252:255]
    s_waitcnt lgkmcnt(0)
    v_mfma_f32_16x16x32_bf16 v[96:99], a[36:39], a[0:3], v[96:99]
    ds_read_b128 a[52:55], v24 offset:40960
    v_mfma_f32_16x16x32_bf16 v[100:103], a[36:39], a[4:7], v[100:103]
    buffer_load_dwordx2 v[34:35], v37, s[44:47], s87 offen sc1
    v_mfma_f32_16x16x32_bf16 v[104:107], a[36:39], a[8:11], v[104:107]
    ds_read_b128 a[56:59], v24 offset:43008
    v_mfma_f32_16x16x32_bf16 v[108:111], a[36:39], a[12:15], v[108:111]
    ds_read_b128 a[60:63], v24 offset:45056
    v_mfma_f32_16x16x32_bf16 v[112:115], a[36:39], a[16:19], v[112:115]
    buffer_load_dwordx2 v[38:39], v41, s[44:47], s87 offen sc1
    v_mfma_f32_16x16x32_bf16 v[116:119], a[40:43], a[0:3], v[116:119]
    ds_read_b128 a[64:67], v24 offset:47104
    v_mfma_f32_16x16x32_bf16 v[120:123], a[40:43], a[4:7], v[120:123]
    ds_read_b128 a[68:71], v24 offset:49152
    v_mfma_f32_16x16x32_bf16 v[124:127], a[40:43], a[8:11], v[124:127]
    ds_read_b64_tr_b16 a[88:89], v86 offset:20480
    v_mfma_f32_16x16x32_bf16 v[128:131], a[40:43], a[12:15], v[128:131]
    buffer_load_dwordx2 v[42:43], v45, s[44:47], s87 offen sc1
    v_mfma_f32_16x16x32_bf16 v[132:135], a[40:43], a[16:19], v[132:135]
    ds_read_b64_tr_b16 a[90:91], v86 offset:20992
    v_mfma_f32_16x16x32_bf16 v[136:139], a[44:47], a[0:3], v[136:139]
    ds_read_b64_tr_b16 a[92:93], v87 offset:20480
    v_mfma_f32_16x16x32_bf16 v[140:143], a[44:47], a[4:7], v[140:143]
    buffer_load_dwordx2 v[46:47], v49, s[44:47], s87 offen sc1
    v_mfma_f32_16x16x32_bf16 v[144:147], a[44:47], a[8:11], v[144:147]
    ds_read_b64_tr_b16 a[94:95], v87 offset:20992
    v_mfma_f32_16x16x32_bf16 v[148:151], a[44:47], a[12:15], v[148:151]
    ds_read_b64_tr_b16 a[96:97], v86 offset:28672
    v_mfma_f32_16x16x32_bf16 v[152:155], a[44:47], a[16:19], v[152:155]
    ds_read_b64_tr_b16 a[98:99], v86 offset:29184
    v_mfma_f32_16x16x32_bf16 v[156:159], a[48:51], a[0:3], v[156:159]
    buffer_load_dwordx2 a[116:117], v56, s[44:47], 0 offen offset:0 sc1
    v_mfma_f32_16x16x32_bf16 v[160:163], a[48:51], a[4:7], v[160:163]
    ds_read_b64_tr_b16 a[100:101], v87 offset:28672
    v_mfma_f32_16x16x32_bf16 v[164:167], a[48:51], a[8:11], v[164:167]
    ds_read_b64_tr_b16 a[102:103], v87 offset:29184
    v_mfma_f32_16x16x32_bf16 v[168:171], a[48:51], a[12:15], v[168:171]
    buffer_load_dwordx2 a[118:119], v52, s[44:47], 0 offen offset:32 sc1
    v_mfma_f32_16x16x32_bf16 v[172:175], a[48:51], a[16:19], v[172:175]
    ds_read_b64_tr_b16 a[72:73], v86 offset:4096
    v_mfma_f32_16x16x32_bf16 v[176:179], a[20:23], a[0:3], v[176:179]
    ds_read_b64_tr_b16 a[74:75], v86 offset:4608
    v_mfma_f32_16x16x32_bf16 v[180:183], a[20:23], a[4:7], v[180:183]
    ds_read_b64_tr_b16 a[76:77], v87 offset:4096
    v_mfma_f32_16x16x32_bf16 v[184:187], a[20:23], a[8:11], v[184:187]
    buffer_load_dwordx2 a[120:121], v52, s[44:47], 0 offen offset:64 sc1
    v_mfma_f32_16x16x32_bf16 v[188:191], a[20:23], a[12:15], v[188:191]
    ds_read_b64_tr_b16 a[78:79], v87 offset:4608
    v_mfma_f32_16x16x32_bf16 v[192:195], a[20:23], a[16:19], v[192:195]
    ds_read_b64_tr_b16 a[80:81], v86 offset:12288
    v_mfma_f32_16x16x32_bf16 v[196:199], a[24:27], a[0:3], v[196:199]
    buffer_load_dwordx2 a[122:123], v52, s[44:47], 0 offen offset:96 sc1
    v_mfma_f32_16x16x32_bf16 v[200:203], a[24:27], a[4:7], v[200:203]
    ds_read_b64_tr_b16 a[82:83], v86 offset:12800
    v_mfma_f32_16x16x32_bf16 v[204:207], a[24:27], a[8:11], v[204:207]
    ds_read_b64_tr_b16 a[84:85], v87 offset:12288
    v_mfma_f32_16x16x32_bf16 v[208:211], a[24:27], a[12:15], v[208:211]
    ds_read_b64_tr_b16 a[86:87], v87 offset:12800
    v_mfma_f32_16x16x32_bf16 v[212:215], a[24:27], a[16:19], v[212:215]
    buffer_load_dwordx2 a[124:125], v52, s[44:47], 0 offen offset:128 sc1
    v_mfma_f32_16x16x32_bf16 v[216:219], a[28:31], a[0:3], v[216:219]
    buffer_load_dwordx2 a[126:127], v53, s[44:47], 0 offen offset:0 sc1
    v_mfma_f32_16x16x32_bf16 v[220:223], a[28:31], a[4:7], v[220:223]
    v_mfma_f32_16x16x32_bf16 v[224:227], a[28:31], a[8:11], v[224:227]
    v_mfma_f32_16x16x32_bf16 v[228:231], a[28:31], a[12:15], v[228:231]
    s_mov_b64 s[60:61], s[48:49]
    v_mfma_f32_16x16x32_bf16 v[232:235], a[28:31], a[16:19], v[232:235]
    s_cmp_lt_u32 s68, 18
    s_cselect_b32 s88, s73, 0
    v_mfma_f32_16x16x32_bf16 v[236:239], a[32:35], a[0:3], v[236:239]
    s_mul_i32 s62, s88, 12513280
    v_mfma_f32_16x16x32_bf16 v[240:243], a[32:35], a[4:7], v[240:243]
    s_cmp_eq_u32 s88, 1
    s_cselect_b32 s77, s77, 1024
    v_mfma_f32_16x16x32_bf16 v[244:247], a[32:35], a[8:11], v[244:247]
    s_cmp_eq_u32 s73, 1
    s_cselect_b32 s76, s76, 1024
    v_mfma_f32_16x16x32_bf16 v[248:251], a[32:35], a[12:15], v[248:251]
    v_mfma_f32_16x16x32_bf16 v[252:255], a[32:35], a[16:19], v[252:255]
    s_waitcnt vmcnt(22) lgkmcnt(0)
    s_barrier
    v_mfma_f32_16x16x32_bf16 v[96:99], a[88:91], a[52:55], v[96:99]
    ds_read_b128 a[0:3], v23 offset:0
    v_readlane_b32 s81, v90, 1
    v_mfma_f32_16x16x32_bf16 v[100:103], a[88:91], a[56:59], v[100:103]
    ds_read_b128 a[4:7], v23 offset:2048
    v_mfma_f32_16x16x32_bf16 v[104:107], a[88:91], a[60:63], v[104:107]
    ds_read_b128 a[8:11], v23 offset:4096
    v_mfma_f32_16x16x32_bf16 v[108:111], a[88:91], a[64:67], v[108:111]
    s_add_u32 m0, s85, 65536
    v_mfma_f32_16x16x32_bf16 v[112:115], a[88:91], a[68:71], v[112:115]
    ds_read_b128 a[12:15], v23 offset:6144
    v_mfma_f32_16x16x32_bf16 v[116:119], a[92:95], a[52:55], v[116:119]
    buffer_load_dwordx4 v15, s[96:99], s81 offen offset:0 lds
    v_mfma_f32_16x16x32_bf16 v[120:123], a[92:95], a[56:59], v[120:123]
    ds_read_b128 a[16:19], v23 offset:8192
    v_mfma_f32_16x16x32_bf16 v[124:127], a[92:95], a[60:63], v[124:127]
    ds_read_b64_tr_b16 a[36:37], v27 offset:16384
    v_mfma_f32_16x16x32_bf16 v[128:131], a[92:95], a[64:67], v[128:131]
    ds_read_b64_tr_b16 a[38:39], v27 offset:16896
    s_add_u32 s89, s85, 32768
    v_add_u32 v78, s89, v92
    v_mfma_f32_16x16x32_bf16 v[132:135], a[92:95], a[68:71], v[132:135]
    buffer_load_dwordx4 v16, s[96:99], s81 offen offset:1024 lds
    v_mfma_f32_16x16x32_bf16 v[136:139], a[96:99], a[52:55], v[136:139]
    ds_read_b64_tr_b16 a[40:41], v28 offset:16384
    v_mfma_f32_16x16x32_bf16 v[140:143], a[96:99], a[56:59], v[140:143]
    ds_read_b64_tr_b16 a[42:43], v28 offset:16896
    v_xor_b32_e64 v79, 32, v78
    v_mfma_f32_16x16x32_bf16 v[144:147], a[96:99], a[60:63], v[144:147]
    ds_read_b64_tr_b16 a[44:45], v27 offset:24576
    v_mfma_f32_16x16x32_bf16 v[148:151], a[96:99], a[64:67], v[148:151]
    buffer_load_dwordx4 v17, s[96:99], s81 offen offset:2048 lds
    v_mfma_f32_16x16x32_bf16 v[152:155], a[96:99], a[68:71], v[152:155]
    ds_read_b64_tr_b16 a[46:47], v27 offset:25088
    v_xor_b32_e64 v80, 64, v78
    v_mfma_f32_16x16x32_bf16 v[156:159], a[100:103], a[52:55], v[156:159]
    ds_read_b64_tr_b16 a[48:49], v28 offset:24576
    v_mfma_f32_16x16x32_bf16 v[160:163], a[100:103], a[56:59], v[160:163]
    ds_read_b64_tr_b16 a[50:51], v28 offset:25088
    v_mfma_f32_16x16x32_bf16 v[164:167], a[100:103], a[60:63], v[164:167]
    buffer_load_dwordx4 v18, s[96:99], s81 offen offset:3072 lds
    v_mfma_f32_16x16x32_bf16 v[168:171], a[100:103], a[64:67], v[168:171]
    ds_read_b64_tr_b16 a[20:21], v27 offset:0
    v_xor_b32 v81, 96, v78
    v_mfma_f32_16x16x32_bf16 v[172:175], a[100:103], a[68:71], v[172:175]
    ds_read_b64_tr_b16 a[22:23], v27 offset:512
    v_readlane_b32 s81, v90, 17
    v_mfma_f32_16x16x32_bf16 v[176:179], a[72:75], a[52:55], v[176:179]
    ds_read_b64_tr_b16 a[24:25], v28 offset:0
    s_waitcnt vmcnt(19)
    v_mfma_f32_16x16x32_bf16 v[180:183], a[72:75], a[56:59], v[180:183]
    ds_read_b64_tr_b16 a[26:27], v28 offset:512
    v_mfma_f32_16x16x32_bf16 v[184:187], a[72:75], a[60:63], v[184:187]
    ds_read_b64_tr_b16 a[128:129], v78 offset:0
    v_mfma_f32_16x16x32_bf16 v[188:191], a[72:75], a[64:67], v[188:191]
    ds_read_b64_tr_b16 a[28:29], v27 offset:8192
    s_add_u32 m0, s85, 69632
    v_mfma_f32_16x16x32_bf16 v[192:195], a[72:75], a[68:71], v[192:195]
    ds_read_b64_tr_b16 a[30:31], v27 offset:8704
    v_mfma_f32_16x16x32_bf16 v[196:199], a[76:79], a[52:55], v[196:199]
    buffer_load_dwordx4 v15, s[96:99], s81 offen offset:0 lds
    v_mfma_f32_16x16x32_bf16 v[200:203], a[76:79], a[56:59], v[200:203]
    ds_read_b64_tr_b16 a[130:131], v78 offset:2048
    v_mfma_f32_16x16x32_bf16 v[204:207], a[76:79], a[60:63], v[204:207]
    ds_read_b64_tr_b16 a[32:33], v28 offset:8192
    v_mfma_f32_16x16x32_bf16 v[208:211], a[76:79], a[64:67], v[208:211]
    ds_read_b64_tr_b16 a[34:35], v28 offset:8704
    v_mfma_f32_16x16x32_bf16 v[212:215], a[76:79], a[68:71], v[212:215]
    ds_read_b64_tr_b16 a[132:133], v79 offset:0
    v_mfma_f32_16x16x32_bf16 v[216:219], a[80:83], a[52:55], v[216:219]
    buffer_load_dwordx4 v16, s[96:99], s81 offen offset:1024 lds
    v_mfma_f32_16x16x32_bf16 v[220:223], a[80:83], a[56:59], v[220:223]
    s_waitcnt vmcnt(12)
    ds_read_b64_tr_b16 a[134:135], v79 offset:2048
    v_mfma_f32_16x16x32_bf16 v[224:227], a[80:83], a[60:63], v[224:227]
    v_xor_b32_e64 v66, v31, v29
    v_mfma_f32_16x16x32_bf16 v[228:231], a[80:83], a[64:67], v[228:231]
    buffer_load_dwordx4 v17, s[96:99], s81 offen offset:2048 lds
    v_mfma_f32_16x16x32_bf16 v[232:235], a[80:83], a[68:71], v[232:235]
    ds_read_b64_tr_b16 a[136:137], v80 offset:0
    v_mfma_f32_16x16x32_bf16 v[236:239], a[84:87], a[52:55], v[236:239]
    buffer_load_dwordx4 v18, s[96:99], s81 offen offset:3072 lds
    v_mfma_f32_16x16x32_bf16 v[240:243], a[84:87], a[56:59], v[240:243]
    ds_read_b64_tr_b16 a[138:139], v80 offset:2048
    v_mfma_f32_16x16x32_bf16 v[244:247], a[84:87], a[60:63], v[244:247]
    v_mfma_f32_16x16x32_bf16 v[248:251], a[84:87], a[64:67], v[248:251]
    v_bitop3_b32 v66, v35, v29, v66 bitop3:0xbe
    v_mfma_f32_16x16x32_bf16 v[252:255], a[84:87], a[68:71], v[252:255]
    ds_read_b64_tr_b16 a[140:141], v81 offset:0
    v_readlane_b32 s81, v90, 2
    s_waitcnt lgkmcnt(5)
    v_mfma_f32_16x16x32_bf16 v[96:99], a[36:39], a[0:3], v[96:99]
    ds_read_b128 a[52:55], v24 offset:0
    v_mfma_f32_16x16x32_bf16 v[100:103], a[36:39], a[4:7], v[100:103]
    ds_read_b128 a[56:59], v24 offset:2048
    v_mfma_f32_16x16x32_bf16 v[104:107], a[36:39], a[8:11], v[104:107]
    ds_read_b64_tr_b16 a[142:143], v81 offset:2048
    v_mfma_f32_16x16x32_bf16 v[108:111], a[36:39], a[12:15], v[108:111]
    ds_read_b128 a[60:63], v24 offset:4096
    s_add_u32 m0, s85, 131072
    v_mfma_f32_16x16x32_bf16 v[112:115], a[36:39], a[16:19], v[112:115]
    ds_read_b128 a[64:67], v24 offset:6144
    v_mfma_f32_16x16x32_bf16 v[116:119], a[40:43], a[0:3], v[116:119]
    buffer_load_dwordx4 v15, s[96:99], s81 offen offset:0 lds
    v_mfma_f32_16x16x32_bf16 v[120:123], a[40:43], a[4:7], v[120:123]
    ds_read_b128 a[68:71], v24 offset:8192
    v_bitop3_b32 v66, v39, v29, v66 bitop3:0xbe
    v_mfma_f32_16x16x32_bf16 v[124:127], a[40:43], a[8:11], v[124:127]
    ds_read_b64_tr_b16 a[144:145], v78 offset:4096
    v_mfma_f32_16x16x32_bf16 v[128:131], a[40:43], a[12:15], v[128:131]
    ds_read_b64_tr_b16 a[88:89], v27 offset:20480
    v_mfma_f32_16x16x32_bf16 v[132:135], a[40:43], a[16:19], v[132:135]
    ds_read_b64_tr_b16 a[90:91], v27 offset:20992
    v_mfma_f32_16x16x32_bf16 v[136:139], a[44:47], a[0:3], v[136:139]
    buffer_load_dwordx4 v16, s[96:99], s81 offen offset:1024 lds
    v_mfma_f32_16x16x32_bf16 v[140:143], a[44:47], a[4:7], v[140:143]
L_pad4:
    s_cbranch_execz L_pad15
    s_nop 0
    ds_read_b64_tr_b16 a[146:147], v78 offset:6144
    v_mfma_f32_16x16x32_bf16 v[144:147], a[44:47], a[8:11], v[144:147]
    ds_read_b64_tr_b16 a[92:93], v28 offset:20480
    v_bitop3_b32 v66, v43, v29, v66 bitop3:0xbe
    v_mfma_f32_16x16x32_bf16 v[148:151], a[44:47], a[12:15], v[148:151]
    ds_read_b64_tr_b16 a[94:95], v28 offset:20992
    v_mfma_f32_16x16x32_bf16 v[152:155], a[44:47], a[16:19], v[152:155]
    buffer_load_dwordx4 v17, s[96:99], s81 offen offset:2048 lds
    v_mfma_f32_16x16x32_bf16 v[156:159], a[48:51], a[0:3], v[156:159]
    ds_read_b64_tr_b16 a[96:97], v27 offset:28672
    v_mfma_f32_16x16x32_bf16 v[160:163], a[48:51], a[4:7], v[160:163]
    ds_read_b64_tr_b16 a[148:149], v79 offset:4096
    v_mfma_f32_16x16x32_bf16 v[164:167], a[48:51], a[8:11], v[164:167]
    ds_read_b64_tr_b16 a[98:99], v27 offset:29184
    v_mfma_f32_16x16x32_bf16 v[168:171], a[48:51], a[12:15], v[168:171]
    ds_read_b64_tr_b16 a[100:101], v28 offset:28672
    v_bitop3_b32 v66, v47, v29, v66 bitop3:0xbe
    v_mfma_f32_16x16x32_bf16 v[172:175], a[48:51], a[16:19], v[172:175]
    ds_read_b64_tr_b16 a[150:151], v79 offset:6144
    v_mfma_f32_16x16x32_bf16 v[176:179], a[20:23], a[0:3], v[176:179]
    buffer_load_dwordx4 v18, s[96:99], s81 offen offset:3072 lds
    v_mfma_f32_16x16x32_bf16 v[180:183], a[20:23], a[4:7], v[180:183]
    ds_read_b64_tr_b16 a[102:103], v28 offset:29184
    v_readlane_b32 s81, v90, 18
    v_mfma_f32_16x16x32_bf16 v[184:187], a[20:23], a[8:11], v[184:187]
    ds_read_b64_tr_b16 a[72:73], v27 offset:4096
    s_add_u32 m0, s85, 135168
    v_mfma_f32_16x16x32_bf16 v[188:191], a[20:23], a[12:15], v[188:191]
    ds_read_b64_tr_b16 a[152:153], v80 offset:4096
    v_mfma_f32_16x16x32_bf16 v[192:195], a[20:23], a[16:19], v[192:195]
    ds_read_b64_tr_b16 a[74:75], v27 offset:4608
    v_mfma_f32_16x16x32_bf16 v[196:199], a[24:27], a[0:3], v[196:199]
    ds_read_b64_tr_b16 a[76:77], v28 offset:4096
    v_cmp_ne_u32 vcc, 0, v66
    v_mfma_f32_16x16x32_bf16 v[200:203], a[24:27], a[4:7], v[200:203]
    ds_read_b64_tr_b16 a[154:155], v80 offset:6144
    v_mfma_f32_16x16x32_bf16 v[204:207], a[24:27], a[8:11], v[204:207]
    ds_read_b64_tr_b16 a[78:79], v28 offset:4608
    v_mfma_f32_16x16x32_bf16 v[208:211], a[24:27], a[12:15], v[208:211]
    ds_read_b64_tr_b16 a[80:81], v27 offset:12288
    v_mfma_f32_16x16x32_bf16 v[212:215], a[24:27], a[16:19], v[212:215]
    ds_read_b64_tr_b16 a[82:83], v27 offset:12800
    v_mfma_f32_16x16x32_bf16 v[216:219], a[28:31], a[0:3], v[216:219]
    ds_read_b64_tr_b16 a[156:157], v81 offset:4096
    v_mfma_f32_16x16x32_bf16 v[220:223], a[28:31], a[4:7], v[220:223]
    buffer_load_dwordx4 v15, s[96:99], s81 offen offset:0 lds
    v_mfma_f32_16x16x32_bf16 v[224:227], a[28:31], a[8:11], v[224:227]
    ds_read_b64_tr_b16 a[84:85], v28 offset:12288
    s_cmp_eq_u32 s73, 1
    s_cselect_b64 vcc, vcc, 0
    v_mfma_f32_16x16x32_bf16 v[228:231], a[28:31], a[12:15], v[228:231]
    ds_read_b64_tr_b16 a[86:87], v28 offset:12800
    v_mfma_f32_16x16x32_bf16 v[232:235], a[28:31], a[16:19], v[232:235]
    ds_read_b64_tr_b16 a[158:159], v81 offset:6144
    s_cbranch_vccnz L_sp_statF
L_ok_statF:
    v_mfma_f32_16x16x32_bf16 v[236:239], a[32:35], a[0:3], v[236:239]
    buffer_load_dwordx4 v16, s[96:99], s81 offen offset:1024 lds
    v_mfma_f32_16x16x32_bf16 v[240:243], a[32:35], a[4:7], v[240:243]
    buffer_load_dwordx4 v17, s[96:99], s81 offen offset:2048 lds
    v_mfma_f32_16x16x32_bf16 v[244:247], a[32:35], a[8:11], v[244:247]
    buffer_load_dwordx4 v18, s[96:99], s81 offen offset:3072 lds
    v_mfma_f32_16x16x32_bf16 v[248:251], a[32:35], a[12:15], v[248:251]
    v_mfma_f32_16x16x32_bf16 v[252:255], a[32:35], a[16:19], v[252:255]
    s_waitcnt lgkmcnt(0)
    s_barrier
    v_mfma_f32_16x16x32_bf16 v[96:99], a[88:91], a[52:55], v[96:99]
    v_readlane_b32 s81, v90, 3
    v_and_b32 v32, 0xffff0000, v30
    v_mfma_f32_16x16x32_bf16 v[100:103], a[88:91], a[56:59], v[100:103]
    s_add_u32 s89, s85, 65536
    v_add_u32 v78, s89, v92
    v_lshlrev_b32_e64 v30, 16, v30
    v_mfma_f32_16x16x32_bf16 v[104:107], a[88:91], a[60:63], v[104:107]
    v_xor_b32_e64 v79, 32, v78
    v_mfma_f32_16x16x32_bf16 v[108:111], a[88:91], a[64:67], v[108:111]
    v_rcp_f32_e64 v33, v32
    v_mfma_f32_16x16x32_bf16 v[112:115], a[88:91], a[68:71], v[112:115]
    v_xor_b32 v30, 0x80000000, v30
    v_xor_b32_e64 v80, 64, v78
    s_add_u32 m0, s85, 32768
    v_mfma_f32_16x16x32_bf16 v[116:119], a[92:95], a[52:55], v[116:119]
    v_mul_f32_e64 v32, v32, v32
    v_mfma_f32_16x16x32_bf16 v[120:123], a[92:95], a[56:59], v[120:123]
    buffer_load_dwordx4 v15, s[96:99], s81 offen offset:0 lds
    v_mfma_f32_16x16x32_bf16 v[124:127], a[92:95], a[60:63], v[124:127]
    v_xor_b32 v81, 96, v78
    v_mul_f32 v31, 0xbfb8aa3b, v33
    s_waitcnt vmcnt(13)
    v_mfma_f32_16x16x32_bf16 v[128:131], a[92:95], a[64:67], v[128:131]
    v_and_b32 v36, 0xffff0000, v34
    v_lshlrev_b32 v34, 16, v34
    v_mfma_f32_16x16x32_bf16 v[132:135], a[92:95], a[68:71], v[132:135]
    ds_read_b64_tr_b16 a[160:161], v78 offset:0
    v_mfma_f32_16x16x32_bf16 v[136:139], a[96:99], a[52:55], v[136:139]
    buffer_load_dwordx4 v16, s[96:99], s81 offen offset:1024 lds
    v_mfma_f32_16x16x32_bf16 v[140:143], a[96:99], a[56:59], v[140:143]
    v_rcp_f32_e64 v37, v36
    v_mfma_f32_16x16x32_bf16 v[144:147], a[96:99], a[60:63], v[144:147]
    ds_read_b64_tr_b16 a[162:163], v78 offset:2048
    v_xor_b32 v34, 0x80000000, v34
    v_mfma_f32_16x16x32_bf16 v[148:151], a[96:99], a[64:67], v[148:151]
    ds_read_b64_tr_b16 a[164:165], v79 offset:0
    v_mul_f32_e64 v36, v36, v36
    v_mfma_f32_16x16x32_bf16 v[152:155], a[96:99], a[68:71], v[152:155]
    buffer_load_dwordx4 v17, s[96:99], s81 offen offset:2048 lds
    v_mfma_f32_16x16x32_bf16 v[156:159], a[100:103], a[52:55], v[156:159]
    ds_read_b64_tr_b16 a[166:167], v79 offset:2048
    v_mul_f32 v35, 0xbfb8aa3b, v37
    v_mfma_f32_16x16x32_bf16 v[160:163], a[100:103], a[56:59], v[160:163]
    v_and_b32 v40, 0xffff0000, v38
    v_lshlrev_b32_e64 v38, 16, v38
    v_mfma_f32_16x16x32_bf16 v[164:167], a[100:103], a[60:63], v[164:167]
    buffer_load_dwordx4 v18, s[96:99], s81 offen offset:3072 lds
    v_mfma_f32_16x16x32_bf16 v[168:171], a[100:103], a[64:67], v[168:171]
    ds_read_b64_tr_b16 a[168:169], v80 offset:0
    v_mfma_f32_16x16x32_bf16 v[172:175], a[100:103], a[68:71], v[172:175]
    ds_read_b64_tr_b16 a[170:171], v80 offset:2048
    v_readlane_b32 s81, v90, 19
    v_mfma_f32_16x16x32_bf16 v[176:179], a[72:75], a[52:55], v[176:179]
    v_rcp_f32_e64 v41, v40
    v_mfma_f32_16x16x32_bf16 v[180:183], a[72:75], a[56:59], v[180:183]
    v_xor_b32 v38, 0x80000000, v38
    v_mul_f32_e64 v40, v40, v40
    v_mfma_f32_16x16x32_bf16 v[184:187], a[72:75], a[60:63], v[184:187]
    ds_read_b64_tr_b16 a[172:173], v81 offset:0
    v_mul_f32 v39, 0xbfb8aa3b, v41
    v_mfma_f32_16x16x32_bf16 v[188:191], a[72:75], a[64:67], v[188:191]
    ds_read_b64_tr_b16 a[174:175], v81 offset:2048
    v_and_b32 v44, 0xffff0000, v42
    s_waitcnt vmcnt(12)
    v_mfma_f32_16x16x32_bf16 v[192:195], a[72:75], a[68:71], v[192:195]
    s_add_u32 m0, s85, 36864
    ds_read_b64_tr_b16 a[176:177], v78 offset:4096
    v_lshlrev_b32 v42, 16, v42
    v_mfma_f32_16x16x32_bf16 v[196:199], a[76:79], a[52:55], v[196:199]
    buffer_load_dwordx4 v15, s[96:99], s81 offen offset:0 lds
    v_mfma_f32_16x16x32_bf16 v[200:203], a[76:79], a[56:59], v[200:203]
    ds_read_b64_tr_b16 a[178:179], v78 offset:6144
    v_mfma_f32_16x16x32_bf16 v[204:207], a[76:79], a[60:63], v[204:207]
    v_rcp_f32_e64 v45, v44
    v_mfma_f32_16x16x32_bf16 v[208:211], a[76:79], a[64:67], v[208:211]
    v_xor_b32 v42, 0x80000000, v42
    v_mul_f32_e64 v44, v44, v44
    v_mfma_f32_16x16x32_bf16 v[212:215], a[76:79], a[68:71], v[212:215]
    ds_read_b64_tr_b16 a[180:181], v79 offset:4096
    v_mul_f32 v43, 0xbfb8aa3b, v45
    v_mfma_f32_16x16x32_bf16 v[216:219], a[80:83], a[52:55], v[216:219]
    buffer_load_dwordx4 v16, s[96:99], s81 offen offset:1024 lds
    v_mfma_f32_16x16x32_bf16 v[220:223], a[80:83], a[56:59], v[220:223]
    ds_read_b64_tr_b16 a[182:183], v79 offset:6144
    v_and_b32 v48, 0xffff0000, v46
    v_mfma_f32_16x16x32_bf16 v[224:227], a[80:83], a[60:63], v[224:227]
    ds_read_b64_tr_b16 a[184:185], v80 offset:4096
    v_lshlrev_b32_e64 v46, 16, v46
    v_mfma_f32_16x16x32_bf16 v[228:231], a[80:83], a[64:67], v[228:231]
    buffer_load_dwordx4 v17, s[96:99], s81 offen offset:2048 lds
    v_mfma_f32_16x16x32_bf16 v[232:235], a[80:83], a[68:71], v[232:235]
    ds_read_b64_tr_b16 a[186:187], v80 offset:6144
    v_mfma_f32_16x16x32_bf16 v[236:239], a[84:87], a[52:55], v[236:239]
    v_rcp_f32_e64 v49, v48
    v_mfma_f32_16x16x32_bf16 v[240:243], a[84:87], a[56:59], v[240:243]
    v_xor_b32 v46, 0x80000000, v46
    v_mul_f32_e64 v48, v48, v48
    v_mfma_f32_16x16x32_bf16 v[244:247], a[84:87], a[60:63], v[244:247]
    ds_read_b64_tr_b16 a[188:189], v81 offset:4096
    v_mul_f32 v47, 0xbfb8aa3b, v49
    v_mfma_f32_16x16x32_bf16 v[248:251], a[84:87], a[64:67], v[248:251]
    buffer_load_dwordx4 v18, s[96:99], s81 offen offset:3072 lds
    v_mfma_f32_16x16x32_bf16 v[252:255], a[84:87], a[68:71], v[252:255]
    ds_read_b64_tr_b16 a[190:191], v81 offset:6144
    v_mov_b32_dpp v50, v96 row_newbcast:0 row_mask:0xf bank_mask:0xf
    v_mov_b32_dpp v51, v97 row_newbcast:0 row_mask:0xf bank_mask:0xf
    v_mov_b32_dpp v52, v98 row_newbcast:0 row_mask:0xf bank_mask:0xf
    v_readlane_b32 s81, v90, 4
    s_add_u32 m0, s85, 0
    s_nop 3
    buffer_load_dwordx4 v15, s[96:99], s81 offen offset:0 lds
    v_mov_b32_dpp v53, v99 row_newbcast:0 row_mask:0xf bank_mask:0xf
    v_mov_b32_dpp v54, v116 row_newbcast:0 row_mask:0xf bank_mask:0xf
    v_mov_b32_dpp v55, v117 row_newbcast:0 row_mask:0xf bank_mask:0xf
    v_mov_b32_dpp v56, v118 row_newbcast:0 row_mask:0xf bank_mask:0xf
    v_mov_b32_dpp v57, v119 row_newbcast:0 row_mask:0xf bank_mask:0xf
    v_mov_b32_dpp v58, v136 row_newbcast:0 row_mask:0xf bank_mask:0xf
    v_mov_b32_dpp v59, v137 row_newbcast:0 row_mask:0xf bank_mask:0xf
    v_mov_b32_dpp v60, v138 row_newbcast:0 row_mask:0xf bank_mask:0xf
    v_mov_b32_dpp v61, v139 row_newbcast:0 row_mask:0xf bank_mask:0xf
    v_mov_b32_dpp v62, v156 row_newbcast:0 row_mask:0xf bank_mask:0xf
    v_mov_b32_dpp v63, v157 row_newbcast:0 row_mask:0xf bank_mask:0xf
    v_mov_b32_dpp v64, v158 row_newbcast:0 row_mask:0xf bank_mask:0xf
    v_mov_b32_dpp v65, v159 row_newbcast:0 row_mask:0xf bank_mask:0xf
    v_pk_fma_f32 v[96:97], v[50:51], v[30:31], v[96:97] op_sel_hi:[1,0,1]
    v_pk_fma_f32 v[98:99], v[52:53], v[30:31], v[98:99] op_sel_hi:[1,0,1]
    v_pk_fma_f32 v[116:117], v[54:55], v[30:31], v[116:117] op_sel_hi:[1,0,1]
    v_pk_fma_f32 v[118:119], v[56:57], v[30:31], v[118:119] op_sel_hi:[1,0,1]
    v_pk_mul_f32 v[66:67], v[96:97], v[30:31] op_sel:[0,1] op_sel_hi:[1,1]
    buffer_load_dwordx4 v16, s[96:99], s81 offen offset:1024 lds
    v_pk_mul_f32 v[68:69], v[98:99], v[30:31] op_sel:[0,1] op_sel_hi:[1,1]
    v_pk_mul_f32 v[70:71], v[116:117], v[30:31] op_sel:[0,1] op_sel_hi:[1,1]
    v_pk_mul_f32 v[72:73], v[118:119], v[30:31] op_sel:[0,1] op_sel_hi:[1,1]
    v_exp_f32 v66, v66
    v_exp_f32 v67, v67
    v_pk_fma_f32 v[136:137], v[58:59], v[30:31], v[136:137] op_sel_hi:[1,0,1]
    v_exp_f32 v68, v68
    v_exp_f32 v69, v69
    v_pk_fma_f32 v[138:139], v[60:61], v[30:31], v[138:139] op_sel_hi:[1,0,1]
    v_exp_f32 v70, v70
    v_exp_f32 v71, v71
    v_pk_fma_f32 v[156:157], v[62:63], v[30:31], v[156:157] op_sel_hi:[1,0,1]
    v_exp_f32 v72, v72
    v_exp_f32 v73, v73
    v_pk_fma_f32 v[158:159], v[64:65], v[30:31], v[158:159] op_sel_hi:[1,0,1]
    v_pk_fma_f32 v[66:67], v[66:67], v[32:33], v[32:33] op_sel_hi:[1,0,0]
    v_pk_fma_f32 v[68:69], v[68:69], v[32:33], v[32:33] op_sel_hi:[1,0,0]
    v_pk_fma_f32 v[70:71], v[70:71], v[32:33], v[32:33] op_sel_hi:[1,0,0]
    buffer_load_dwordx4 v17, s[96:99], s81 offen offset:2048 lds
    v_pk_fma_f32 v[72:73], v[72:73], v[32:33], v[32:33] op_sel_hi:[1,0,0]
    v_rcp_f32 v66, v66
    v_rcp_f32 v67, v67
    v_pk_mul_f32 v[96:97], v[96:97], v[136:137]
    v_rcp_f32 v68, v68
    v_rcp_f32 v69, v69
    v_pk_mul_f32 v[98:99], v[98:99], v[138:139]
    v_rcp_f32 v70, v70
    v_rcp_f32 v71, v71
    v_pk_mul_f32 v[116:117], v[116:117], v[156:157]
    v_rcp_f32 v72, v72
    v_rcp_f32 v73, v73
    v_pk_mul_f32 v[118:119], v[118:119], v[158:159]
    v_pk_mul_f32 v[96:97], v[96:97], v[66:67]
    v_pk_mul_f32 v[98:99], v[98:99], v[68:69]
    v_pk_mul_f32 v[116:117], v[116:117], v[70:71]
    v_pk_mul_f32 v[118:119], v[118:119], v[72:73]
    v_cvt_pk_bf16_f32 v96, v96, v97
    buffer_load_dwordx4 v18, s[96:99], s81 offen offset:3072 lds
    v_cvt_pk_bf16_f32 v97, v98, v99
    v_cvt_pk_bf16_f32 v98, v116, v117
    v_cvt_pk_bf16_f32 v99, v118, v119
    buffer_store_dwordx4 v[96:99], v6, s[60:63], s101 offen sc1
    v_pk_fma_f32 v[100:101], v[50:51], v[34:35], v[100:101] op_sel_hi:[1,0,1]
    v_pk_fma_f32 v[102:103], v[52:53], v[34:35], v[102:103] op_sel_hi:[1,0,1]
    v_pk_fma_f32 v[120:121], v[54:55], v[34:35], v[120:121] op_sel_hi:[1,0,1]
    v_pk_fma_f32 v[122:123], v[56:57], v[34:35], v[122:123] op_sel_hi:[1,0,1]
    v_pk_mul_f32 v[66:67], v[100:101], v[34:35] op_sel:[0,1] op_sel_hi:[1,1]
    v_pk_mul_f32 v[68:69], v[102:103], v[34:35] op_sel:[0,1] op_sel_hi:[1,1]
    v_pk_mul_f32 v[70:71], v[120:121], v[34:35] op_sel:[0,1] op_sel_hi:[1,1]
    v_pk_mul_f32 v[72:73], v[122:123], v[34:35] op_sel:[0,1] op_sel_hi:[1,1]
    v_exp_f32 v66, v66
    v_exp_f32 v67, v67
    v_pk_fma_f32 v[140:141], v[58:59], v[34:35], v[140:141] op_sel_hi:[1,0,1]
    v_exp_f32 v68, v68
    v_exp_f32 v69, v69
    v_readlane_b32 s81, v90, 20
    s_add_u32 m0, s85, 4096
    s_nop 3
    buffer_load_dwordx4 v15, s[96:99], s81 offen offset:0 lds
    v_pk_fma_f32 v[142:143], v[60:61], v[34:35], v[142:143] op_sel_hi:[1,0,1]
    v_exp_f32 v70, v70
    v_exp_f32_e64 v71, v71
    v_pk_fma_f32 v[160:161], v[62:63], v[34:35], v[160:161] op_sel_hi:[1,0,1]
    v_exp_f32 v72, v72
    v_exp_f32 v73, v73
    v_pk_fma_f32 v[162:163], v[64:65], v[34:35], v[162:163] op_sel_hi:[1,0,1]
    v_pk_fma_f32 v[66:67], v[66:67], v[36:37], v[36:37] op_sel_hi:[1,0,0]
    v_pk_fma_f32 v[68:69], v[68:69], v[36:37], v[36:37] op_sel_hi:[1,0,0]
    v_pk_fma_f32 v[70:71], v[70:71], v[36:37], v[36:37] op_sel_hi:[1,0,0]
    v_pk_fma_f32 v[72:73], v[72:73], v[36:37], v[36:37] op_sel_hi:[1,0,0]
    v_rcp_f32 v66, v66
    v_rcp_f32 v67, v67
    v_pk_mul_f32 v[100:101], v[100:101], v[140:141]
    v_rcp_f32 v68, v68
    v_rcp_f32 v69, v69
    v_pk_mul_f32 v[102:103], v[102:103], v[142:143]
    v_rcp_f32_e64 v70, v70
    buffer_load_dwordx4 v16, s[96:99], s81 offen offset:1024 lds
    v_rcp_f32_e64 v71, v71
    v_pk_mul_f32 v[120:121], v[120:121], v[160:161]
    v_rcp_f32 v72, v72
    v_rcp_f32 v73, v73
    v_pk_mul_f32 v[122:123], v[122:123], v[162:163]
    v_pk_mul_f32 v[100:101], v[100:101], v[66:67]
    v_pk_mul_f32 v[102:103], v[102:103], v[68:69]
    v_pk_mul_f32 v[120:121], v[120:121], v[70:71]
    v_pk_mul_f32 v[122:123], v[122:123], v[72:73]
    v_cvt_pk_bf16_f32 v100, v100, v101
    v_cvt_pk_bf16_f32 v101, v102, v103
    v_cvt_pk_bf16_f32 v102, v120, v121
    v_cvt_pk_bf16_f32 v103, v122, v123
    buffer_store_dwordx4 v[100:103], v7, s[60:63], s101 offen sc1
    v_pk_fma_f32 v[104:105], v[50:51], v[38:39], v[104:105] op_sel_hi:[1,0,1]
    v_pk_fma_f32 v[106:107], v[52:53], v[38:39], v[106:107] op_sel_hi:[1,0,1]
    v_pk_fma_f32 v[124:125], v[54:55], v[38:39], v[124:125] op_sel_hi:[1,0,1]
    buffer_load_dwordx4 v17, s[96:99], s81 offen offset:2048 lds
    v_pk_fma_f32 v[126:127], v[56:57], v[38:39], v[126:127] op_sel_hi:[1,0,1]
    v_pk_mul_f32 v[66:67], v[104:105], v[38:39] op_sel:[0,1] op_sel_hi:[1,1]
    v_pk_mul_f32 v[68:69], v[106:107], v[38:39] op_sel:[0,1] op_sel_hi:[1,1]
    v_pk_mul_f32 v[70:71], v[124:125], v[38:39] op_sel:[0,1] op_sel_hi:[1,1]
    v_pk_mul_f32 v[72:73], v[126:127], v[38:39] op_sel:[0,1] op_sel_hi:[1,1]
    v_exp_f32 v66, v66
    v_exp_f32 v67, v67
    v_pk_fma_f32 v[144:145], v[58:59], v[38:39], v[144:145] op_sel_hi:[1,0,1]
    v_exp_f32 v68, v68
    v_exp_f32 v69, v69
    v_pk_fma_f32 v[146:147], v[60:61], v[38:39], v[146:147] op_sel_hi:[1,0,1]
    v_exp_f32 v70, v70
    v_exp_f32 v71, v71
    v_pk_fma_f32 v[164:165], v[62:63], v[38:39], v[164:165] op_sel_hi:[1,0,1]
    v_exp_f32 v72, v72
    v_exp_f32 v73, v73
    v_pk_fma_f32 v[166:167], v[64:65], v[38:39], v[166:167] op_sel_hi:[1,0,1]
    v_pk_fma_f32 v[66:67], v[66:67], v[40:41], v[40:41] op_sel_hi:[1,0,0]
    buffer_load_dwordx4 v18, s[96:99], s81 offen offset:3072 lds
    v_pk_fma_f32 v[68:69], v[68:69], v[40:41], v[40:41] op_sel_hi:[1,0,0]
    v_pk_fma_f32 v[70:71], v[70:71], v[40:41], v[40:41] op_sel_hi:[1,0,0]
    v_pk_fma_f32 v[72:73], v[72:73], v[40:41], v[40:41] op_sel_hi:[1,0,0]
    v_rcp_f32 v66, v66
    v_rcp_f32 v67, v67
    v_pk_mul_f32 v[104:105], v[104:105], v[144:145]
    v_rcp_f32 v68, v68
    v_rcp_f32 v69, v69
    v_pk_mul_f32 v[106:107], v[106:107], v[146:147]
    v_rcp_f32 v70, v70
    v_rcp_f32 v71, v71
    v_pk_mul_f32 v[124:125], v[124:125], v[164:165]
    v_rcp_f32 v72, v72
    v_rcp_f32 v73, v73
    v_pk_mul_f32 v[126:127], v[126:127], v[166:167]
    v_pk_mul_f32 v[104:105], v[104:105], v[66:67]
    v_pk_mul_f32 v[106:107], v[106:107], v[68:69]
    v_pk_mul_f32 v[124:125], v[124:125], v[70:71]
    v_readlane_b32 s81, v90, 5
    s_waitcnt lgkmcnt(8)
    s_add_u32 m0, s85, 65536
    s_nop 2
    buffer_load_dwordx4 v15, s[96:99], s81 offen offset:0 lds
    v_pk_mul_f32 v[126:127], v[126:127], v[72:73]
    v_cvt_pk_bf16_f32 v104, v104, v105
    v_cvt_pk_bf16_f32 v105, v106, v107
    v_cvt_pk_bf16_f32 v106, v124, v125
    v_cvt_pk_bf16_f32 v107, v126, v127
    buffer_store_dwordx4 v[104:107], v8, s[60:63], s101 offen sc1
    v_pk_fma_f32 v[108:109], v[50:51], v[42:43], v[108:109] op_sel_hi:[1,0,1]
    v_pk_fma_f32 v[110:111], v[52:53], v[42:43], v[110:111] op_sel_hi:[1,0,1]
    v_pk_fma_f32 v[128:129], v[54:55], v[42:43], v[128:129] op_sel_hi:[1,0,1]
    v_pk_fma_f32 v[130:131], v[56:57], v[42:43], v[130:131] op_sel_hi:[1,0,1]
    v_pk_mul_f32 v[66:67], v[108:109], v[42:43] op_sel:[0,1] op_sel_hi:[1,1]
    v_pk_mul_f32 v[68:69], v[110:111], v[42:43] op_sel:[0,1] op_sel_hi:[1,1]
    v_pk_mul_f32 v[70:71], v[128:129], v[42:43] op_sel:[0,1] op_sel_hi:[1,1]
    v_pk_mul_f32 v[72:73], v[130:131], v[42:43] op_sel:[0,1] op_sel_hi:[1,1]
    v_exp_f32 v66, v66
    v_exp_f32 v67, v67
    v_pk_fma_f32 v[148:149], v[58:59], v[42:43], v[148:149] op_sel_hi:[1,0,1]
    buffer_load_dwordx4 v16, s[96:99], s81 offen offset:1024 lds
    v_exp_f32 v68, v68
    v_exp_f32 v69, v69
    v_pk_fma_f32 v[150:151], v[60:61], v[42:43], v[150:151] op_sel_hi:[1,0,1]
    v_exp_f32 v70, v70
    v_exp_f32 v71, v71
    v_pk_fma_f32 v[168:169], v[62:63], v[42:43], v[168:169] op_sel_hi:[1,0,1]
    v_exp_f32 v72, v72
    v_exp_f32 v73, v73
    v_pk_fma_f32 v[170:171], v[64:65], v[42:43], v[170:171] op_sel_hi:[1,0,1]
    v_pk_fma_f32 v[66:67], v[66:67], v[44:45], v[44:45] op_sel_hi:[1,0,0]
    v_pk_fma_f32 v[68:69], v[68:69], v[44:45], v[44:45] op_sel_hi:[1,0,0]
    v_pk_fma_f32 v[70:71], v[70:71], v[44:45], v[44:45] op_sel_hi:[1,0,0]
    v_pk_fma_f32 v[72:73], v[72:73], v[44:45], v[44:45] op_sel_hi:[1,0,0]
    v_rcp_f32 v66, v66
    v_rcp_f32 v67, v67
    v_pk_mul_f32 v[108:109], v[108:109], v[148:149]
    v_rcp_f32 v68, v68
    v_rcp_f32 v69, v69
    buffer_load_dwordx4 v17, s[96:99], s81 offen offset:2048 lds
    v_pk_mul_f32 v[110:111], v[110:111], v[150:151]
    v_rcp_f32 v70, v70
    v_rcp_f32 v71, v71
    v_pk_mul_f32 v[128:129], v[128:129], v[168:169]
    v_rcp_f32 v72, v72
    v_rcp_f32 v73, v73
    v_pk_mul_f32 v[130:131], v[130:131], v[170:171]
    v_pk_mul_f32 v[108:109], v[108:109], v[66:67]
    v_pk_mul_f32 v[110:111], v[110:111], v[68:69]
    v_pk_mul_f32 v[128:129], v[128:129], v[70:71]
    v_pk_mul_f32 v[130:131], v[130:131], v[72:73]
    v_cvt_pk_bf16_f32 v108, v108, v109
    v_cvt_pk_bf16_f32 v109, v110, v111
    v_cvt_pk_bf16_f32 v110, v128, v129
    v_cvt_pk_bf16_f32 v111, v130, v131
    buffer_store_dwordx4 v[108:111], v9, s[60:63], s101 offen sc1
    v_pk_fma_f32 v[112:113], v[50:51], v[46:47], v[112:113] op_sel_hi:[1,0,1]
    buffer_load_dwordx4 v18, s[96:99], s81 offen offset:3072 lds
    v_pk_fma_f32 v[114:115], v[52:53], v[46:47], v[114:115] op_sel_hi:[1,0,1]
    v_pk_fma_f32 v[132:133], v[54:55], v[46:47], v[132:133] op_sel_hi:[1,0,1]
    v_pk_fma_f32 v[134:135], v[56:57], v[46:47], v[134:135] op_sel_hi:[1,0,1]
    v_pk_mul_f32 v[66:67], v[112:113], v[46:47] op_sel:[0,1] op_sel_hi:[1,1]
    v_pk_mul_f32 v[68:69], v[114:115], v[46:47] op_sel:[0,1] op_sel_hi:[1,1]
    v_pk_mul_f32 v[70:71], v[132:133], v[46:47] op_sel:[0,1] op_sel_hi:[1,1]
    v_pk_mul_f32 v[72:73], v[134:135], v[46:47] op_sel:[0,1] op_sel_hi:[1,1]
    v_exp_f32 v66, v66
    v_exp_f32 v67, v67
    v_pk_fma_f32 v[152:153], v[58:59], v[46:47], v[152:153] op_sel_hi:[1,0,1]
    v_exp_f32 v68, v68
    v_exp_f32 v69, v69
    v_pk_fma_f32 v[154:155], v[60:61], v[46:47], v[154:155] op_sel_hi:[1,0,1]
    v_exp_f32 v70, v70
    v_exp_f32 v71, v71
    v_pk_fma_f32 v[172:173], v[62:63], v[46:47], v[172:173] op_sel_hi:[1,0,1]
    v_exp_f32 v72, v72
    v_exp_f32 v73, v73
    v_readlane_b32 s81, v90, 21
    s_waitcnt lgkmcnt(0)
    s_add_u32 m0, s85, 69632
    s_nop 2
    buffer_load_dwordx4 v15, s[96:99], s81 offen offset:0 lds
    v_pk_fma_f32 v[174:175], v[64:65], v[46:47], v[174:175] op_sel_hi:[1,0,1]
    v_pk_fma_f32 v[66:67], v[66:67], v[48:49], v[48:49] op_sel_hi:[1,0,0]
    v_pk_fma_f32 v[68:69], v[68:69], v[48:49], v[48:49] op_sel_hi:[1,0,0]
    v_pk_fma_f32 v[70:71], v[70:71], v[48:49], v[48:49] op_sel_hi:[1,0,0]
    v_pk_fma_f32 v[72:73], v[72:73], v[48:49], v[48:49] op_sel_hi:[1,0,0]
    v_rcp_f32 v66, v66
    v_rcp_f32 v67, v67
    v_pk_mul_f32 v[112:113], v[112:113], v[152:153]
    v_rcp_f32 v68, v68
    v_rcp_f32 v69, v69
    v_pk_mul_f32 v[114:115], v[114:115], v[154:155]
    v_rcp_f32 v70, v70
    v_rcp_f32 v71, v71
    v_pk_mul_f32 v[132:133], v[132:133], v[172:173]
    v_rcp_f32 v72, v72
    v_rcp_f32 v73, v73
    v_pk_mul_f32 v[134:135], v[134:135], v[174:175]
    v_pk_mul_f32 v[112:113], v[112:113], v[66:67]
    buffer_load_dwordx4 v16, s[96:99], s81 offen offset:1024 lds
    v_pk_mul_f32 v[114:115], v[114:115], v[68:69]
    v_pk_mul_f32 v[132:133], v[132:133], v[70:71]
    v_pk_mul_f32 v[134:135], v[134:135], v[72:73]
    v_cvt_pk_bf16_f32 v112, v112, v113
    v_cvt_pk_bf16_f32 v113, v114, v115
    v_cvt_pk_bf16_f32 v114, v132, v133
    v_cvt_pk_bf16_f32 v115, v134, v135
    buffer_store_dwordx4 v[112:115], v10, s[60:63], s101 offen sc1
    s_mul_i32 s62, s73, 12513280
    v_mov_b32_dpp v50, v176 row_newbcast:0 row_mask:0xf bank_mask:0xf
    v_mov_b32_dpp v51, v177 row_newbcast:0 row_mask:0xf bank_mask:0xf
    v_mov_b32_dpp v52, v178 row_newbcast:0 row_mask:0xf bank_mask:0xf
    buffer_load_dwordx4 v17, s[96:99], s81 offen offset:2048 lds
    v_mov_b32_dpp v53, v179 row_newbcast:0 row_mask:0xf bank_mask:0xf
    v_mov_b32_dpp v54, v196 row_newbcast:0 row_mask:0xf bank_mask:0xf
    v_mov_b32_dpp v55, v197 row_newbcast:0 row_mask:0xf bank_mask:0xf
    v_mov_b32_dpp v56, v198 row_newbcast:0 row_mask:0xf bank_mask:0xf
    v_mov_b32_dpp v57, v199 row_newbcast:0 row_mask:0xf bank_mask:0xf
    v_mov_b32_dpp v58, v216 row_newbcast:0 row_mask:0xf bank_mask:0xf
    v_mov_b32_dpp v59, v217 row_newbcast:0 row_mask:0xf bank_mask:0xf
    v_mov_b32_dpp v60, v218 row_newbcast:0 row_mask:0xf bank_mask:0xf
    v_mov_b32_dpp v61, v219 row_newbcast:0 row_mask:0xf bank_mask:0xf
    v_mov_b32_dpp v62, v236 row_newbcast:0 row_mask:0xf bank_mask:0xf
    v_mov_b32_dpp v63, v237 row_newbcast:0 row_mask:0xf bank_mask:0xf
    v_mov_b32_dpp v64, v238 row_newbcast:0 row_mask:0xf bank_mask:0xf
    v_mov_b32_dpp v65, v239 row_newbcast:0 row_mask:0xf bank_mask:0xf
    v_pk_fma_f32 v[176:177], v[50:51], v[30:31], v[176:177] op_sel_hi:[1,0,1]
    v_pk_fma_f32 v[178:179], v[52:53], v[30:31], v[178:179] op_sel_hi:[1,0,1]
    v_pk_fma_f32 v[196:197], v[54:55], v[30:31], v[196:197] op_sel_hi:[1,0,1]
    v_pk_fma_f32 v[198:199], v[56:57], v[30:31], v[198:199] op_sel_hi:[1,0,1]
    v_pk_mul_f32 v[66:67], v[176:177], v[30:31] op_sel:[0,1] op_sel_hi:[1,1]
    buffer_load_dwordx4 v18, s[96:99], s81 offen offset:3072 lds
    v_pk_mul_f32 v[68:69], v[178:179], v[30:31] op_sel:[0,1] op_sel_hi:[1,1]
    v_pk_mul_f32 v[70:71], v[196:197], v[30:31] op_sel:[0,1] op_sel_hi:[1,1]
    v_pk_mul_f32 v[72:73], v[198:199], v[30:31] op_sel:[0,1] op_sel_hi:[1,1]
    v_exp_f32 v66, v66
    v_exp_f32 v67, v67
    v_pk_fma_f32 v[216:217], v[58:59], v[30:31], v[216:217] op_sel_hi:[1,0,1]
    v_exp_f32 v68, v68
    v_exp_f32 v69, v69
    v_pk_fma_f32 v[218:219], v[60:61], v[30:31], v[218:219] op_sel_hi:[1,0,1]
    v_exp_f32 v70, v70
    v_exp_f32 v71, v71
    v_pk_fma_f32 v[236:237], v[62:63], v[30:31], v[236:237] op_sel_hi:[1,0,1]
    v_exp_f32 v72, v72
    v_exp_f32 v73, v73
    v_pk_fma_f32 v[238:239], v[64:65], v[30:31], v[238:239] op_sel_hi:[1,0,1]
    v_pk_fma_f32 v[66:67], v[66:67], v[32:33], v[32:33] op_sel_hi:[1,0,0]
    v_pk_fma_f32 v[68:69], v[68:69], v[32:33], v[32:33] op_sel_hi:[1,0,0]
    v_pk_fma_f32 v[70:71], v[70:71], v[32:33], v[32:33] op_sel_hi:[1,0,0]
    v_readlane_b32 s81, v90, 6
    s_add_u32 m0, s85, 98304
    s_nop 3
    buffer_load_dwordx4 v15, s[96:99], s81 offen offset:0 lds
    v_pk_fma_f32 v[72:73], v[72:73], v[32:33], v[32:33] op_sel_hi:[1,0,0]
    v_rcp_f32 v66, v66
    v_rcp_f32_e64 v67, v67
    v_pk_mul_f32 v[176:177], v[176:177], v[216:217]
    v_rcp_f32 v68, v68
    v_rcp_f32 v69, v69
    v_pk_mul_f32 v[178:179], v[178:179], v[218:219]
    v_rcp_f32 v70, v70
    v_rcp_f32 v71, v71
    v_pk_mul_f32 v[196:197], v[196:197], v[236:237]
    v_rcp_f32 v72, v72
    v_rcp_f32 v73, v73
    v_pk_mul_f32 v[198:199], v[198:199], v[238:239]
    v_pk_mul_f32 v[176:177], v[176:177], v[66:67]
    v_pk_mul_f32 v[178:179], v[178:179], v[68:69]
    v_pk_mul_f32 v[196:197], v[196:197], v[70:71]
    v_pk_mul_f32 v[198:199], v[198:199], v[72:73]
    v_cvt_pk_bf16_f32 v176, v176, v177
    buffer_load_dwordx4 v16, s[96:99], s81 offen offset:1024 lds
    v_cvt_pk_bf16_f32 v177, v178, v179
    v_cvt_pk_bf16_f32 v178, v196, v197
    v_cvt_pk_bf16_f32 v179, v198, v199
    buffer_store_dwordx4 v[176:179], v6, s[60:63], s100 offen sc1
    v_pk_fma_f32 v[180:181], v[50:51], v[34:35], v[180:181] op_sel_hi:[1,0,1]
    v_pk_fma_f32 v[182:183], v[52:53], v[34:35], v[182:183] op_sel_hi:[1,0,1]
    v_pk_fma_f32 v[200:201], v[54:55], v[34:35], v[200:201] op_sel_hi:[1,0,1]
    v_pk_fma_f32 v[202:203], v[56:57], v[34:35], v[202:203] op_sel_hi:[1,0,1]
    v_pk_mul_f32 v[66:67], v[180:181], v[34:35] op_sel:[0,1] op_sel_hi:[1,1]
    v_pk_mul_f32 v[68:69], v[182:183], v[34:35] op_sel:[0,1] op_sel_hi:[1,1]
    v_pk_mul_f32 v[70:71], v[200:201], v[34:35] op_sel:[0,1] op_sel_hi:[1,1]
    v_pk_mul_f32 v[72:73], v[202:203], v[34:35] op_sel:[0,1] op_sel_hi:[1,1]
    v_exp_f32 v66, v66
    v_exp_f32 v67, v67
    v_pk_fma_f32 v[220:221], v[58:59], v[34:35], v[220:221] op_sel_hi:[1,0,1]
    v_exp_f32 v68, v68
    v_exp_f32 v69, v69
    buffer_load_dwordx4 v17, s[96:99], s81 offen offset:2048 lds
    v_pk_fma_f32 v[222:223], v[60:61], v[34:35], v[222:223] op_sel_hi:[1,0,1]
    v_exp_f32 v70, v70
    v_exp_f32 v71, v71
    v_pk_fma_f32 v[240:241], v[62:63], v[34:35], v[240:241] op_sel_hi:[1,0,1]
    v_exp_f32 v72, v72
    v_exp_f32 v73, v73
    v_pk_fma_f32 v[242:243], v[64:65], v[34:35], v[242:243] op_sel_hi:[1,0,1]
    v_pk_fma_f32 v[66:67], v[66:67], v[36:37], v[36:37] op_sel_hi:[1,0,0]
    v_pk_fma_f32 v[68:69], v[68:69], v[36:37], v[36:37] op_sel_hi:[1,0,0]
    v_pk_fma_f32 v[70:71], v[70:71], v[36:37], v[36:37] op_sel_hi:[1,0,0]
    v_pk_fma_f32 v[72:73], v[72:73], v[36:37], v[36:37] op_sel_hi:[1,0,0]
    v_rcp_f32 v66, v66
    v_rcp_f32 v67, v67
    v_pk_mul_f32 v[180:181], v[180:181], v[220:221]
    v_rcp_f32 v68, v68
    v_rcp_f32 v69, v69
    v_pk_mul_f32 v[182:183], v[182:183], v[222:223]
    v_rcp_f32_e64 v70, v70
    buffer_load_dwordx4 v18, s[96:99], s81 offen offset:3072 lds
    v_rcp_f32_e64 v71, v71
    v_pk_mul_f32 v[200:201], v[200:201], v[240:241]
    v_rcp_f32 v72, v72
    v_rcp_f32 v73, v73
    v_pk_mul_f32 v[202:203], v[202:203], v[242:243]
    v_pk_mul_f32 v[180:181], v[180:181], v[66:67]
    v_pk_mul_f32 v[182:183], v[182:183], v[68:69]
    v_pk_mul_f32 v[200:201], v[200:201], v[70:71]
    v_pk_mul_f32 v[202:203], v[202:203], v[72:73]
    v_cvt_pk_bf16_f32 v180, v180, v181
    v_cvt_pk_bf16_f32 v181, v182, v183
    v_cvt_pk_bf16_f32 v182, v200, v201
    v_cvt_pk_bf16_f32 v183, v202, v203
    buffer_store_dwordx4 v[180:183], v7, s[60:63], s100 offen sc1
    v_pk_fma_f32 v[184:185], v[50:51], v[38:39], v[184:185] op_sel_hi:[1,0,1]
    v_pk_fma_f32 v[186:187], v[52:53], v[38:39], v[186:187] op_sel_hi:[1,0,1]
    v_pk_fma_f32 v[204:205], v[54:55], v[38:39], v[204:205] op_sel_hi:[1,0,1]
    v_readlane_b32 s81, v90, 22
    s_add_u32 m0, s85, 102400
    s_nop 3
    buffer_load_dwordx4 v15, s[96:99], s81 offen offset:0 lds
    s_add_u32 s89, s85, 131072
    v_add_u32 v11, s89, v92
    v_xor_b32 v12, 32, v11
    v_xor_b32 v13, 64, v11
    v_xor_b32 v14, 96, v11
    s_waitcnt vmcnt(40)
    s_nop 0
    ds_read_b64_tr_b16 a[192:193], v11 offset:0
    ds_read_b64_tr_b16 a[194:195], v11 offset:2048
    ds_read_b64_tr_b16 a[196:197], v12 offset:0
    ds_read_b64_tr_b16 a[198:199], v12 offset:2048
    ds_read_b64_tr_b16 a[200:201], v13 offset:0
    ds_read_b64_tr_b16 a[202:203], v13 offset:2048
L_pad5:
    s_cbranch_execz L_hopend
    s_nop 0
    ds_read_b64_tr_b16 a[204:205], v14 offset:0
    ds_read_b64_tr_b16 a[206:207], v14 offset:2048
    s_waitcnt vmcnt(36)
    s_nop 0
    ds_read_b64_tr_b16 a[208:209], v11 offset:4096
    ds_read_b64_tr_b16 a[210:211], v11 offset:6144
    ds_read_b64_tr_b16 a[212:213], v12 offset:4096
    ds_read_b64_tr_b16 a[214:215], v12 offset:6144
    ds_read_b64_tr_b16 a[216:217], v13 offset:4096
    ds_read_b64_tr_b16 a[218:219], v13 offset:6144
    ds_read_b64_tr_b16 a[220:221], v14 offset:4096
    ds_read_b64_tr_b16 a[222:223], v14 offset:6144
    v_pk_fma_f32 v[206:207], v[56:57], v[38:39], v[206:207] op_sel_hi:[1,0,1]
    v_pk_mul_f32 v[66:67], v[184:185], v[38:39] op_sel:[0,1] op_sel_hi:[1,1]
    v_pk_mul_f32 v[68:69], v[186:187], v[38:39] op_sel:[0,1] op_sel_hi:[1,1]
    v_pk_mul_f32 v[70:71], v[204:205], v[38:39] op_sel:[0,1] op_sel_hi:[1,1]
    v_pk_mul_f32 v[72:73], v[206:207], v[38:39] op_sel:[0,1] op_sel_hi:[1,1]
    v_exp_f32 v66, v66
    v_exp_f32 v67, v67
    v_pk_fma_f32 v[224:225], v[58:59], v[38:39], v[224:225] op_sel_hi:[1,0,1]
    v_exp_f32 v68, v68
    v_exp_f32 v69, v69
    v_pk_fma_f32 v[226:227], v[60:61], v[38:39], v[226:227] op_sel_hi:[1,0,1]
    v_exp_f32 v70, v70
    v_exp_f32 v71, v71
    v_pk_fma_f32 v[244:245], v[62:63], v[38:39], v[244:245] op_sel_hi:[1,0,1]
    v_exp_f32 v72, v72
    v_exp_f32 v73, v73
    v_pk_fma_f32 v[246:247], v[64:65], v[38:39], v[246:247] op_sel_hi:[1,0,1]
    v_pk_fma_f32 v[66:67], v[66:67], v[40:41], v[40:41] op_sel_hi:[1,0,0]
    buffer_load_dwordx4 v16, s[96:99], s81 offen offset:1024 lds
    v_pk_fma_f32 v[68:69], v[68:69], v[40:41], v[40:41] op_sel_hi:[1,0,0]
    v_pk_fma_f32 v[70:71], v[70:71], v[40:41], v[40:41] op_sel_hi:[1,0,0]
    v_pk_fma_f32 v[72:73], v[72:73], v[40:41], v[40:41] op_sel_hi:[1,0,0]
    v_rcp_f32 v66, v66
    v_rcp_f32 v67, v67
    v_pk_mul_f32 v[184:185], v[184:185], v[224:225]
    v_rcp_f32 v68, v68
    v_rcp_f32 v69, v69
    v_pk_mul_f32 v[186:187], v[186:187], v[226:227]
    v_rcp_f32 v70, v70
    v_rcp_f32 v71, v71
    v_pk_mul_f32 v[204:205], v[204:205], v[244:245]
    v_rcp_f32 v72, v72
    v_rcp_f32 v73, v73
    v_pk_mul_f32 v[206:207], v[206:207], v[246:247]
    v_pk_mul_f32 v[184:185], v[184:185], v[66:67]
    v_pk_mul_f32 v[186:187], v[186:187], v[68:69]
    v_pk_mul_f32 v[204:205], v[204:205], v[70:71]
    buffer_load_dwordx4 v17, s[96:99], s81 offen offset:2048 lds
    v_pk_mul_f32 v[206:207], v[206:207], v[72:73]
    v_cvt_pk_bf16_f32 v184, v184, v185
    v_cvt_pk_bf16_f32 v185, v186, v187
    v_cvt_pk_bf16_f32 v186, v204, v205
    v_cvt_pk_bf16_f32 v187, v206, v207
    buffer_store_dwordx4 v[184:187], v8, s[60:63], s100 offen sc1
    v_pk_fma_f32 v[188:189], v[50:51], v[42:43], v[188:189] op_sel_hi:[1,0,1]
    v_pk_fma_f32 v[190:191], v[52:53], v[42:43], v[190:191] op_sel_hi:[1,0,1]
    v_pk_fma_f32 v[208:209], v[54:55], v[42:43], v[208:209] op_sel_hi:[1,0,1]
    v_pk_fma_f32 v[210:211], v[56:57], v[42:43], v[210:211] op_sel_hi:[1,0,1]
    v_pk_mul_f32 v[66:67], v[188:189], v[42:43] op_sel:[0,1] op_sel_hi:[1,1]
    v_pk_mul_f32 v[68:69], v[190:191], v[42:43] op_sel:[0,1] op_sel_hi:[1,1]
    v_pk_mul_f32 v[70:71], v[208:209], v[42:43] op_sel:[0,1] op_sel_hi:[1,1]
    v_pk_mul_f32 v[72:73], v[210:211], v[42:43] op_sel:[0,1] op_sel_hi:[1,1]
    v_exp_f32 v66, v66
    v_exp_f32 v67, v67
    v_pk_fma_f32 v[228:229], v[58:59], v[42:43], v[228:229] op_sel_hi:[1,0,1]
    buffer_load_dwordx4 v18, s[96:99], s81 offen offset:3072 lds
    v_exp_f32 v68, v68
    v_exp_f32 v69, v69
    v_pk_fma_f32 v[230:231], v[60:61], v[42:43], v[230:231] op_sel_hi:[1,0,1]
    v_exp_f32 v70, v70
    v_exp_f32 v71, v71
    v_pk_fma_f32 v[248:249], v[62:63], v[42:43], v[248:249] op_sel_hi:[1,0,1]
    v_exp_f32 v72, v72
    v_exp_f32 v73, v73
    v_pk_fma_f32 v[250:251], v[64:65], v[42:43], v[250:251] op_sel_hi:[1,0,1]
    v_pk_fma_f32 v[66:67], v[66:67], v[44:45], v[44:45] op_sel_hi:[1,0,0]
    v_pk_fma_f32 v[68:69], v[68:69], v[44:45], v[44:45] op_sel_hi:[1,0,0]
    v_pk_fma_f32 v[70:71], v[70:71], v[44:45], v[44:45] op_sel_hi:[1,0,0]
    v_pk_fma_f32 v[72:73], v[72:73], v[44:45], v[44:45] op_sel_hi:[1,0,0]
    v_rcp_f32 v66, v66
    v_rcp_f32 v67, v67
    v_pk_mul_f32 v[188:189], v[188:189], v[228:229]
    v_rcp_f32 v68, v68
    v_rcp_f32 v69, v69
    v_readlane_b32 s81, v90, 7
    s_waitcnt lgkmcnt(8)
    s_add_u32 m0, s85, 131072
    s_nop 2
    buffer_load_dwordx4 v19, s[52:55], s81 offen offset:0 lds
    v_pk_mul_f32 v[190:191], v[190:191], v[230:231]
    v_rcp_f32 v70, v70
    v_rcp_f32 v71, v71
    v_pk_mul_f32 v[208:209], v[208:209], v[248:249]
    v_rcp_f32 v72, v72
    v_rcp_f32 v73, v73
    v_pk_mul_f32 v[210:211], v[210:211], v[250:251]
    v_pk_mul_f32 v[188:189], v[188:189], v[66:67]
    v_pk_mul_f32 v[190:191], v[190:191], v[68:69]
    v_pk_mul_f32 v[208:209], v[208:209], v[70:71]
    v_pk_mul_f32 v[210:211], v[210:211], v[72:73]
    v_cvt_pk_bf16_f32 v188, v188, v189
    v_cvt_pk_bf16_f32 v189, v190, v191
    v_cvt_pk_bf16_f32 v190, v208, v209
    v_cvt_pk_bf16_f32 v191, v210, v211
    buffer_store_dwordx4 v[188:191], v9, s[60:63], s100 offen sc1
    s_waitcnt vmcnt(15)
    s_mov_b32 exec_hi, 0
    buffer_store_dword v29, v94, s[44:47], s77 offen sc1
    s_mov_b32 exec_hi, -1
    s_nop 0
    v_pk_fma_f32 v[192:193], v[50:51], v[46:47], v[192:193] op_sel_hi:[1,0,1]
    buffer_load_dwordx4 v20, s[52:55], s81 offen offset:1024 lds
    v_pk_fma_f32 v[194:195], v[52:53], v[46:47], v[194:195] op_sel_hi:[1,0,1]
    v_pk_fma_f32 v[212:213], v[54:55], v[46:47], v[212:213] op_sel_hi:[1,0,1]
    v_pk_fma_f32 v[214:215], v[56:57], v[46:47], v[214:215] op_sel_hi:[1,0,1]
    v_pk_mul_f32 v[66:67], v[192:193], v[46:47] op_sel:[0,1] op_sel_hi:[1,1]
    v_pk_mul_f32 v[68:69], v[194:195], v[46:47] op_sel:[0,1] op_sel_hi:[1,1]
    v_pk_mul_f32 v[70:71], v[212:213], v[46:47] op_sel:[0,1] op_sel_hi:[1,1]
    v_pk_mul_f32 v[72:73], v[214:215], v[46:47] op_sel:[0,1] op_sel_hi:[1,1]
    v_exp_f32 v66, v66
    v_exp_f32 v67, v67
    v_pk_fma_f32 v[232:233], v[58:59], v[46:47], v[232:233] op_sel_hi:[1,0,1]
    v_exp_f32 v68, v68
    v_exp_f32 v69, v69
    v_pk_fma_f32 v[234:235], v[60:61], v[46:47], v[234:235] op_sel_hi:[1,0,1]
    v_exp_f32 v70, v70
    v_exp_f32 v71, v71
    v_pk_fma_f32 v[252:253], v[62:63], v[46:47], v[252:253] op_sel_hi:[1,0,1]
    v_exp_f32 v72, v72
    v_exp_f32 v73, v73
    buffer_load_dwordx4 v21, s[52:55], s81 offen offset:2048 lds
    v_pk_fma_f32 v[254:255], v[64:65], v[46:47], v[254:255] op_sel_hi:[1,0,1]
    v_pk_fma_f32 v[66:67], v[66:67], v[48:49], v[48:49] op_sel_hi:[1,0,0]
    v_pk_fma_f32 v[68:69], v[68:69], v[48:49], v[48:49] op_sel_hi:[1,0,0]
    v_pk_fma_f32 v[70:71], v[70:71], v[48:49], v[48:49] op_sel_hi:[1,0,0]
    v_pk_fma_f32 v[72:73], v[72:73], v[48:49], v[48:49] op_sel_hi:[1,0,0]
    v_rcp_f32 v66, v66
    v_rcp_f32 v67, v67
    v_pk_mul_f32 v[192:193], v[192:193], v[232:233]
    v_rcp_f32 v68, v68
    v_rcp_f32 v69, v69
    v_pk_mul_f32 v[194:195], v[194:195], v[234:235]
    v_rcp_f32 v70, v70
    v_rcp_f32 v71, v71
    v_pk_mul_f32 v[212:213], v[212:213], v[252:253]
    v_rcp_f32 v72, v72
    v_rcp_f32 v73, v73
    v_pk_mul_f32 v[214:215], v[214:215], v[254:255]
    v_pk_mul_f32 v[192:193], v[192:193], v[66:67]
    buffer_load_dwordx4 v22, s[52:55], s81 offen offset:3072 lds
    v_pk_mul_f32 v[194:195], v[194:195], v[68:69]
    v_pk_mul_f32 v[212:213], v[212:213], v[70:71]
    v_pk_mul_f32 v[214:215], v[214:215], v[72:73]
    v_cvt_pk_bf16_f32 v192, v192, v193
    v_cvt_pk_bf16_f32 v193, v194, v195
    v_cvt_pk_bf16_f32 v194, v212, v213
    v_cvt_pk_bf16_f32 v195, v214, v215
    buffer_store_dwordx4 v[192:195], v10, s[60:63], s100 offen sc1
    v_readlane_b32 s81, v90, 23
    s_waitcnt lgkmcnt(0)
    s_add_u32 m0, s85, 135168
    s_nop 2
    buffer_load_dwordx4 v19, s[52:55], s81 offen offset:0 lds
    s_add_u32 s89, s85, 32768
    v_add_u32 v11, s89, v92
    v_xor_b32 v12, 32, v11
    v_xor_b32_e64 v13, 64, v11
    v_xor_b32 v14, 96, v11
    ds_read_b64_tr_b16 a[0:1], v11 offset:0
    ds_read_b64_tr_b16 a[2:3], v11 offset:2048
    ds_read_b64_tr_b16 a[4:5], v12 offset:0
    ds_read_b64_tr_b16 a[6:7], v12 offset:2048
    ds_read_b64_tr_b16 a[8:9], v13 offset:0
    ds_read_b64_tr_b16 a[10:11], v13 offset:2048
    ds_read_b64_tr_b16 a[12:13], v14 offset:0
    ds_read_b64_tr_b16 a[14:15], v14 offset:2048
    ds_read_b64_tr_b16 a[16:17], v11 offset:4096
    ds_read_b64_tr_b16 a[18:19], v11 offset:6144
    ds_read_b64_tr_b16 a[20:21], v12 offset:4096
    ds_read_b64_tr_b16 a[22:23], v12 offset:6144
    ds_read_b64_tr_b16 a[24:25], v13 offset:4096
    ds_read_b64_tr_b16 a[26:27], v13 offset:6144
    ds_read_b64_tr_b16 a[28:29], v14 offset:4096
    ds_read_b64_tr_b16 a[30:31], v14 offset:6144
    buffer_load_dwordx4 v20, s[52:55], s81 offen offset:1024 lds
    buffer_load_dwordx4 v21, s[52:55], s81 offen offset:2048 lds
    buffer_load_dwordx4 v22, s[52:55], s81 offen offset:3072 lds
    v_readlane_b32 s81, v90, 8
    s_waitcnt lgkmcnt(8)
    s_add_u32 m0, s85, 32768
    s_nop 2
    buffer_load_dwordx4 v19, s[52:55], s81 offen offset:0 lds
    buffer_load_dwordx4 v20, s[52:55], s81 offen offset:1024 lds
    v_mov_b32 v26, v95
    v_mov_b32 v27, v93
    v_mov_b32 v39, v94
    v_mov_b32 v28, v91
    s_mul_i32 s93, s70, 481280
    v_lshl_add_u32 v30, v0, 4, s93
    v_add_u32 v31, 4096, v30
    s_lshl_b32 s93, s82, 10
    s_add_u32 s93, s93, 12032000
    s_cmp_lt_u32 s82, 5
    s_cselect_b32 s93, s93, 0x40000000
    v_lshl_add_u32 v32, v0, 4, s93
    v_and_b32 v44, 15, v0
    v_cmp_gt_u32_e64 vcc, 16, v0
    s_mul_i32 s93, s70, 12288
    s_cselect_b32 s94, 307200, s93
    v_mov_b32 v46, s93
    v_mov_b32 v45, s94
    v_min_u32 v47, 13, v44
    v_cndmask_b32 v45, v45, v46, vcc
    v_lshl_add_u32 v33, v47, 7, v45
    s_lshl_b32 s93, s71, 8
    v_lshl_add_u32 v47, v44, 4, s93
    v_mul_u32_u24 v44, 20, v95
    s_mul_i32 s93, s70, 79
    s_add_u32 s93, s93, s64
    s_sub_u32 s93, s93, 1
    s_lshl_b32 s94, s82, 2
    s_add_u32 s94, s94, s64
    s_add_u32 s94, s94, 1974
    v_add_u32 v45, s94, v44
    v_add_u32 v44, s93, v44
    v_mov_b32 v46, 2560
    v_mad_i32_i24 v37, v44, v46, v47
    v_mad_i32_i24 v25, v45, v46, v47
    v_accvgpr_read_b32 v74, a117
    v_accvgpr_read_b32 v75, a119
    buffer_load_dwordx4 v21, s[52:55], s81 offen offset:2048 lds
    v_accvgpr_read_b32 v76, a121
    v_accvgpr_read_b32 v77, a123
    v_accvgpr_read_b32 v78, a125
    v_accvgpr_read_b32 v79, a127
    v_xor_b32_e64 v74, v74, v29
    v_bitop3_b32 v74, v75, v29, v74 bitop3:0xbe
    v_bitop3_b32 v74, v76, v29, v74 bitop3:0xbe
    v_bitop3_b32 v74, v77, v29, v74 bitop3:0xbe
    v_bitop3_b32 v74, v78, v29, v74 bitop3:0xbe
    v_bitop3_b32 v74, v79, v29, v74 bitop3:0xbe
    v_cmp_ne_u32_e64 vcc, 0, v74
    s_nop 4
    s_cbranch_vccnz L_sp_resF
L_ok_resF:
    v_accvgpr_read_b32 v75, a248
    v_accvgpr_read_b32 v77, a249
    v_lshlrev_b32_e64 v74, 16, v75
    v_and_b32 v75, 0xffff0000, v75
    v_lshlrev_b32_e64 v76, 16, v77
    v_and_b32 v77, 0xffff0000, v77
    buffer_load_dwordx4 v22, s[52:55], s81 offen offset:3072 lds
    v_accvgpr_read_b32 v78, a116
    v_accvgpr_read_b32 v41, a104
    v_accvgpr_read_b32 v43, a105
    v_and_b32 v79, 0xffff0000, v78
    v_lshlrev_b32 v78, 16, v78
    v_rcp_f32 v79, v79
    v_lshlrev_b32_e64 v40, 16, v41
    v_and_b32 v41, 0xffff0000, v41
    v_lshlrev_b32_e64 v42, 16, v43
    v_and_b32 v43, 0xffff0000, v43
    v_pk_add_f32 v[80:81], v[40:41], v[78:79] op_sel_hi:[1,0] neg_lo:[0,1] neg_hi:[0,1]
    v_pk_mul_f32 v[82:83], v[74:75], v[78:79] op_sel:[0,1] op_sel_hi:[1,1]
    v_pk_fma_f32 v[40:41], v[80:81], v[82:83], v[40:41]
    v_pk_add_f32 v[80:81], v[42:43], v[78:79] op_sel_hi:[1,0] neg_lo:[0,1] neg_hi:[0,1]
    v_pk_mul_f32 v[82:83], v[76:77], v[78:79] op_sel:[0,1] op_sel_hi:[1,1]
    v_pk_fma_f32 v[42:43], v[80:81], v[82:83], v[42:43]
    v_accvgpr_read_b32 v78, a118
    v_accvgpr_read_b32 v45, a106
    v_readlane_b32 s81, v90, 24
    s_waitcnt lgkmcnt(0)
    s_add_u32 m0, s85, 36864
    s_nop 2
    buffer_load_dwordx4 v19, s[52:55], s81 offen offset:0 lds
    s_add_u32 s89, s85, 0
    v_add_u32 v11, s89, v92
    v_xor_b32 v12, 32, v11
    v_xor_b32 v13, 64, v11
    v_xor_b32 v14, 96, v11
    ds_read_b64_tr_b16 a[32:33], v11 offset:0
    ds_read_b64_tr_b16 a[34:35], v11 offset:2048
    ds_read_b64_tr_b16 a[36:37], v12 offset:0
    ds_read_b64_tr_b16 a[38:39], v12 offset:2048
    ds_read_b64_tr_b16 a[40:41], v13 offset:0
    ds_read_b64_tr_b16 a[42:43], v13 offset:2048
    ds_read_b64_tr_b16 a[44:45], v14 offset:0
    ds_read_b64_tr_b16 a[46:47], v14 offset:2048
    ds_read_b64_tr_b16 a[48:49], v11 offset:4096
    ds_read_b64_tr_b16 a[50:51], v11 offset:6144
    ds_read_b64_tr_b16 a[52:53], v12 offset:4096
    ds_read_b64_tr_b16 a[54:55], v12 offset:6144
    ds_read_b64_tr_b16 a[56:57], v13 offset:4096
    ds_read_b64_tr_b16 a[58:59], v13 offset:6144
    ds_read_b64_tr_b16 a[60:61], v14 offset:4096
    ds_read_b64_tr_b16 a[62:63], v14 offset:6144
    v_accvgpr_read_b32 v47, a107
    v_and_b32 v79, 0xffff0000, v78
    v_lshlrev_b32 v78, 16, v78
    v_rcp_f32 v79, v79
    v_lshlrev_b32_e64 v44, 16, v45
    v_and_b32 v45, 0xffff0000, v45
    v_lshlrev_b32_e64 v46, 16, v47
    v_and_b32 v47, 0xffff0000, v47
    v_pk_add_f32 v[80:81], v[44:45], v[78:79] op_sel_hi:[1,0] neg_lo:[0,1] neg_hi:[0,1]
    v_pk_mul_f32 v[82:83], v[74:75], v[78:79] op_sel:[0,1] op_sel_hi:[1,1]
    v_pk_fma_f32 v[44:45], v[80:81], v[82:83], v[44:45]
    v_pk_add_f32 v[80:81], v[46:47], v[78:79] op_sel_hi:[1,0] neg_lo:[0,1] neg_hi:[0,1]
    v_pk_mul_f32 v[82:83], v[76:77], v[78:79] op_sel:[0,1] op_sel_hi:[1,1]
    v_pk_fma_f32 v[46:47], v[80:81], v[82:83], v[46:47]
    v_accvgpr_read_b32 v78, a120
    v_accvgpr_read_b32 v49, a108
    v_accvgpr_read_b32 v51, a109
    v_and_b32 v79, 0xffff0000, v78
    buffer_load_dwordx4 v20, s[52:55], s81 offen offset:1024 lds
    v_lshlrev_b32 v78, 16, v78
    v_rcp_f32 v79, v79
    v_lshlrev_b32_e64 v48, 16, v49
    v_and_b32 v49, 0xffff0000, v49
    v_lshlrev_b32_e64 v50, 16, v51
    v_and_b32 v51, 0xffff0000, v51
    v_pk_add_f32 v[80:81], v[48:49], v[78:79] op_sel_hi:[1,0] neg_lo:[0,1] neg_hi:[0,1]
    v_pk_mul_f32 v[82:83], v[74:75], v[78:79] op_sel:[0,1] op_sel_hi:[1,1]
    v_pk_fma_f32 v[48:49], v[80:81], v[82:83], v[48:49]
    v_pk_add_f32 v[80:81], v[50:51], v[78:79] op_sel_hi:[1,0] neg_lo:[0,1] neg_hi:[0,1]
    v_pk_mul_f32 v[82:83], v[76:77], v[78:79] op_sel:[0,1] op_sel_hi:[1,1]
    v_pk_fma_f32 v[50:51], v[80:81], v[82:83], v[50:51]
    v_accvgpr_read_b32 v78, a122
    v_accvgpr_read_b32 v53, a110
    v_accvgpr_read_b32 v55, a111
    v_and_b32 v79, 0xffff0000, v78
    v_lshlrev_b32 v78, 16, v78
    v_rcp_f32 v79, v79
    buffer_load_dwordx4 v21, s[52:55], s81 offen offset:2048 lds
    v_lshlrev_b32_e64 v52, 16, v53
    v_and_b32 v53, 0xffff0000, v53
    v_lshlrev_b32_e64 v54, 16, v55
    v_and_b32 v55, 0xffff0000, v55
    v_pk_add_f32 v[80:81], v[52:53], v[78:79] op_sel_hi:[1,0] neg_lo:[0,1] neg_hi:[0,1]
    v_pk_mul_f32 v[82:83], v[74:75], v[78:79] op_sel:[0,1] op_sel_hi:[1,1]
    v_pk_fma_f32 v[52:53], v[80:81], v[82:83], v[52:53]
    v_pk_add_f32 v[80:81], v[54:55], v[78:79] op_sel_hi:[1,0] neg_lo:[0,1] neg_hi:[0,1]
    v_pk_mul_f32 v[82:83], v[76:77], v[78:79] op_sel:[0,1] op_sel_hi:[1,1]
    v_pk_fma_f32 v[54:55], v[80:81], v[82:83], v[54:55]
    v_accvgpr_read_b32 v78, a124
    v_accvgpr_read_b32 v57, a112
    v_accvgpr_read_b32 v59, a113
    v_and_b32 v79, 0xffff0000, v78
    v_lshlrev_b32 v78, 16, v78
    v_rcp_f32 v79, v79
    v_lshlrev_b32_e64 v56, 16, v57
    v_and_b32 v57, 0xffff0000, v57
    buffer_load_dwordx4 v22, s[52:55], s81 offen offset:3072 lds
    v_lshlrev_b32_e64 v58, 16, v59
    v_and_b32 v59, 0xffff0000, v59
    v_pk_add_f32 v[80:81], v[56:57], v[78:79] op_sel_hi:[1,0] neg_lo:[0,1] neg_hi:[0,1]
    v_pk_mul_f32 v[82:83], v[74:75], v[78:79] op_sel:[0,1] op_sel_hi:[1,1]
    v_pk_fma_f32 v[56:57], v[80:81], v[82:83], v[56:57]
    v_pk_add_f32 v[80:81], v[58:59], v[78:79] op_sel_hi:[1,0] neg_lo:[0,1] neg_hi:[0,1]
    v_pk_mul_f32 v[82:83], v[76:77], v[78:79] op_sel:[0,1] op_sel_hi:[1,1]
    v_pk_fma_f32 v[58:59], v[80:81], v[82:83], v[58:59]
    v_accvgpr_read_b32 v78, a126
    v_accvgpr_read_b32 v61, a114
    v_accvgpr_read_b32 v63, a115
    v_and_b32 v79, 0xffff0000, v78
    v_lshlrev_b32 v78, 16, v78
    v_rcp_f32 v79, v79
    v_lshlrev_b32_e64 v60, 16, v61
    v_and_b32 v61, 0xffff0000, v61
    v_lshlrev_b32_e64 v62, 16, v63
    v_and_b32 v63, 0xffff0000, v63
    v_readlane_b32 s81, v90, 9
    s_waitcnt lgkmcnt(8)
    s_add_u32 m0, s85, 0
    s_nop 2
    s_nop 0
    buffer_load_dwordx4 v19, s[52:55], s81 offen offset:0 lds
    v_pk_add_f32 v[80:81], v[60:61], v[78:79] op_sel_hi:[1,0] neg_lo:[0,1] neg_hi:[0,1]
    v_pk_mul_f32 v[82:83], v[74:75], v[78:79] op_sel:[0,1] op_sel_hi:[1,1]
    v_pk_fma_f32 v[60:61], v[80:81], v[82:83], v[60:61]
    v_pk_add_f32 v[80:81], v[62:63], v[78:79] op_sel_hi:[1,0] neg_lo:[0,1] neg_hi:[0,1]
    v_pk_mul_f32 v[82:83], v[76:77], v[78:79] op_sel:[0,1] op_sel_hi:[1,1]
    v_pk_fma_f32 v[62:63], v[80:81], v[82:83], v[62:63]
    s_waitcnt vmcnt(13)
    s_mov_b32 exec_hi, 0
    buffer_store_dword v29, v94, s[44:47], s76 offen sc1
    s_mov_b32 exec_hi, -1
    buffer_load_dwordx4 v20, s[52:55], s81 offen offset:1024 lds
    buffer_load_dwordx4 v21, s[52:55], s81 offen offset:2048 lds
    buffer_load_dwordx4 v22, s[52:55], s81 offen offset:3072 lds
    v_readlane_b32 s81, v90, 25
    s_waitcnt lgkmcnt(0)
    s_add_u32 m0, s85, 4096
    s_nop 2
    buffer_load_dwordx4 v19, s[52:55], s81 offen offset:0 lds
    s_add_u32 s89, s85, 65536
    v_add_u32 v11, s89, v92
    v_xor_b32 v12, 32, v11
    v_xor_b32 v13, 64, v11
    v_xor_b32 v14, 96, v11
    ds_read_b64_tr_b16 a[64:65], v11 offset:0
    ds_read_b64_tr_b16 a[66:67], v11 offset:2048
    ds_read_b64_tr_b16 a[68:69], v12 offset:0
    ds_read_b64_tr_b16 a[70:71], v12 offset:2048
    ds_read_b64_tr_b16 a[72:73], v13 offset:0
    ds_read_b64_tr_b16 a[74:75], v13 offset:2048
    ds_read_b64_tr_b16 a[76:77], v14 offset:0
    ds_read_b64_tr_b16 a[78:79], v14 offset:2048
    ds_read_b64_tr_b16 a[80:81], v11 offset:4096
    ds_read_b64_tr_b16 a[82:83], v11 offset:6144
    ds_read_b64_tr_b16 a[84:85], v12 offset:4096
    ds_read_b64_tr_b16 a[86:87], v12 offset:6144
    ds_read_b64_tr_b16 a[88:89], v13 offset:4096
    ds_read_b64_tr_b16 a[90:91], v13 offset:6144
    ds_read_b64_tr_b16 a[92:93], v14 offset:4096
    ds_read_b64_tr_b16 a[94:95], v14 offset:6144
    buffer_load_dwordx4 v20, s[52:55], s81 offen offset:1024 lds
    buffer_load_dwordx4 v21, s[52:55], s81 offen offset:2048 lds
    buffer_load_dwordx4 v22, s[52:55], s81 offen offset:3072 lds
    v_readlane_b32 s81, v90, 10
    s_waitcnt lgkmcnt(8)
    s_add_u32 m0, s85, 65536
    s_nop 2
    buffer_load_dwordx4 v19, s[52:55], s81 offen offset:0 lds
    buffer_load_dwordx4 v20, s[52:55], s81 offen offset:1024 lds
    buffer_load_dwordx4 v21, s[52:55], s81 offen offset:2048 lds
    buffer_load_dwordx4 v22, s[52:55], s81 offen offset:3072 lds
    v_readlane_b32 s81, v90, 26
    s_waitcnt lgkmcnt(0)
    s_add_u32 m0, s85, 69632
    s_nop 2
    buffer_load_dwordx4 v19, s[52:55], s81 offen offset:0 lds
    buffer_load_dwordx4 v20, s[52:55], s81 offen offset:1024 lds
    buffer_load_dwordx4 v21, s[52:55], s81 offen offset:2048 lds
    buffer_load_dwordx4 v22, s[52:55], s81 offen offset:3072 lds
    s_add_u32 s89, s85, 98304
    v_add_u32 v11, s89, v92
    v_xor_b32 v12, 32, v11
    v_xor_b32_e64 v13, 64, v11
    v_xor_b32 v14, 96, v11
    ds_read_b64_tr_b16 a[96:97], v11 offset:0
    ds_read_b64_tr_b16 a[98:99], v11 offset:2048
    ds_read_b64_tr_b16 a[100:101], v12 offset:0
    ds_read_b64_tr_b16 a[102:103], v12 offset:2048
    ds_read_b64_tr_b16 a[104:105], v13 offset:0
    ds_read_b64_tr_b16 a[106:107], v13 offset:2048
    ds_read_b64_tr_b16 a[108:109], v14 offset:0
    ds_read_b64_tr_b16 a[110:111], v14 offset:2048
    ds_read_b64_tr_b16 a[112:113], v11 offset:4096
    ds_read_b64_tr_b16 a[114:115], v11 offset:6144
    ds_read_b64_tr_b16 a[116:117], v12 offset:4096
    ds_read_b64_tr_b16 a[118:119], v12 offset:6144
    ds_read_b64_tr_b16 a[120:121], v13 offset:4096
    ds_read_b64_tr_b16 a[122:123], v13 offset:6144
    ds_read_b64_tr_b16 a[124:125], v14 offset:4096
    ds_read_b64_tr_b16 a[126:127], v14 offset:6144
    v_readlane_b32 s81, v90, 11
    s_waitcnt lgkmcnt(8)
    s_add_u32 m0, s85, 98304
    s_nop 2
    buffer_load_dwordx4 v19, s[52:55], s81 offen offset:0 lds
    buffer_load_dwordx4 v20, s[52:55], s81 offen offset:1024 lds
    buffer_load_dwordx4 v21, s[52:55], s81 offen offset:2048 lds
    buffer_load_dwordx4 v22, s[52:55], s81 offen offset:3072 lds
    v_readlane_b32 s81, v90, 27
    s_waitcnt lgkmcnt(0)
    s_add_u32 m0, s85, 102400
    s_nop 2
    buffer_load_dwordx4 v19, s[52:55], s81 offen offset:0 lds
    buffer_load_dwordx4 v20, s[52:55], s81 offen offset:1024 lds
    buffer_load_dwordx4 v21, s[52:55], s81 offen offset:2048 lds
    buffer_load_dwordx4 v22, s[52:55], s81 offen offset:3072 lds
    s_lshl_b32 s92, s2, 2
    s_add_u32 s92, s92, s64
    s_cmp_eq_u32 s92, 1016
    s_cbranch_scc1 L_janitor
L_janret:
    s_lshl_b32 s74, s64, 11
    s_add_u32 s74, s74, 344064
    buffer_load_dword v34, v33, s[44:47], s74 offen sc1
    s_waitcnt vmcnt(0)
    s_lshl_b32 s76, s2, 7
    s_add_u32 s76, s76, 688128
    s_branch L_g2
L_g1S:
L_pad6:
    s_cbranch_execz L_pad10
    s_nop 0
    s_waitcnt vmcnt(8) lgkmcnt(0)
    s_barrier
    s_nop 0
    ds_read_b128 a[0:3], v23 offset:0
    ds_read_b128 a[4:7], v23 offset:2048
    ds_read_b128 a[8:11], v23 offset:4096
    ds_read_b128 a[12:15], v23 offset:6144
    ds_read_b128 a[16:19], v23 offset:8192
    ds_read_b64_tr_b16 a[36:37], v27 offset:16384
    ds_read_b64_tr_b16 a[38:39], v27 offset:16896
    ds_read_b64_tr_b16 a[40:41], v28 offset:16384
    ds_read_b64_tr_b16 a[42:43], v28 offset:16896
    ds_read_b64_tr_b16 a[44:45], v27 offset:24576
    ds_read_b64_tr_b16 a[46:47], v27 offset:25088
    ds_read_b64_tr_b16 a[48:49], v28 offset:24576
    ds_read_b64_tr_b16 a[50:51], v28 offset:25088
    ds_read_b128 a[20:23], v25 offset:0
    ds_read_b128 a[24:27], v25 offset:2048
    ds_read_b128 a[28:31], v25 offset:8192
    ds_read_b128 a[32:35], v25 offset:10240
    s_waitcnt lgkmcnt(0)
    v_mfma_f32_16x16x32_bf16 v[96:99], a[36:39], a[0:3], 0
    ds_read_b128 a[52:55], v24 offset:0
    v_mfma_f32_16x16x32_bf16 v[100:103], a[36:39], a[4:7], 0
    buffer_load_dwordx4 v14, s[40:43], s81 offen offset:3072 lds
    v_mfma_f32_16x16x32_bf16 v[104:107], a[36:39], a[8:11], 0
    ds_read_b128 a[56:59], v24 offset:2048
    s_add_u32 s81, s81, s84
    v_mfma_f32_16x16x32_bf16 v[108:111], a[36:39], a[12:15], 0
    ds_read_b128 a[60:63], v24 offset:4096
    s_add_u32 m0, s85, 36864
    v_mfma_f32_16x16x32_bf16 v[112:115], a[36:39], a[16:19], 0
    buffer_load_dwordx4 v11, s[40:43], s81 offen offset:0 lds
    v_mfma_f32_16x16x32_bf16 v[116:119], a[40:43], a[0:3], 0
    ds_read_b128 a[64:67], v24 offset:6144
    v_mfma_f32_16x16x32_bf16 v[120:123], a[40:43], a[4:7], 0
    v_mfma_f32_16x16x32_bf16 v[124:127], a[40:43], a[8:11], 0
    ds_read_b128 a[68:71], v24 offset:8192
    v_mfma_f32_16x16x32_bf16 v[128:131], a[40:43], a[12:15], 0
    buffer_load_dwordx4 v12, s[40:43], s81 offen offset:1024 lds
    v_mfma_f32_16x16x32_bf16 v[132:135], a[40:43], a[16:19], 0
    ds_read_b64_tr_b16 a[88:89], v27 offset:20480
    v_mfma_f32_16x16x32_bf16 v[136:139], a[44:47], a[0:3], 0
    buffer_load_dwordx4 v13, s[40:43], s81 offen offset:2048 lds
    v_mfma_f32_16x16x32_bf16 v[140:143], a[44:47], a[4:7], 0
    ds_read_b64_tr_b16 a[90:91], v27 offset:20992
    v_mfma_f32_16x16x32_bf16 v[144:147], a[44:47], a[8:11], 0
    ds_read_b64_tr_b16 a[92:93], v28 offset:20480
    v_mfma_f32_16x16x32_bf16 v[148:151], a[44:47], a[12:15], 0
    buffer_load_dwordx4 v14, s[40:43], s81 offen offset:3072 lds
    v_mfma_f32_16x16x32_bf16 v[152:155], a[44:47], a[16:19], 0
    ds_read_b64_tr_b16 a[94:95], v28 offset:20992
    v_mfma_f32_16x16x32_bf16 v[156:159], a[48:51], a[0:3], 0
    s_bfe_u32 s92, s78, 262152
    ds_read_b64_tr_b16 a[96:97], v27 offset:28672
    v_mfma_f32_16x16x32_bf16 v[160:163], a[48:51], a[4:7], 0
    s_lshl_b32 s80, s92, 7
    s_add_u32 m0, s86, 139264
    v_mfma_f32_16x16x32_bf16 v[164:167], a[48:51], a[8:11], 0
    ds_read_b64_tr_b16 a[98:99], v27 offset:29184
    v_mfma_f32_16x16x32_bf16 v[168:171], a[48:51], a[12:15], 0
    s_mov_b64 exec, s[90:91]
    buffer_load_dwordx4 v1, s[36:39], s80 offen offset:0 lds
    s_mov_b64 exec, -1
    v_mfma_f32_16x16x32_bf16 v[172:175], a[48:51], a[16:19], 0
    ds_read_b64_tr_b16 a[100:101], v28 offset:28672
    v_mfma_f32_16x16x32_bf16 v[176:179], a[0:3], a[20:23], 0
    buffer_load_dwordx4 v2, s[36:39], s80 offen offset:1024 lds
    v_mfma_f32_16x16x32_bf16 v[180:183], a[4:7], a[20:23], 0
    ds_read_b64_tr_b16 a[102:103], v28 offset:29184
    v_mfma_f32_16x16x32_bf16 v[184:187], a[8:11], a[20:23], 0
    ds_read_b128 a[72:75], v26 offset:0
    v_mfma_f32_16x16x32_bf16 v[188:191], a[12:15], a[20:23], 0
    buffer_load_dwordx4 v3, s[36:39], s80 offen offset:2048 lds
    v_mfma_f32_16x16x32_bf16 v[192:195], a[16:19], a[20:23], 0
    ds_read_b128 a[76:79], v26 offset:2048
    v_mfma_f32_16x16x32_bf16 v[196:199], a[0:3], a[24:27], 0
    buffer_load_dwordx4 v4, s[36:39], s80 offen offset:3072 lds
    v_mfma_f32_16x16x32_bf16 v[200:203], a[4:7], a[24:27], 0
    ds_read_b128 a[80:83], v26 offset:8192
    v_mfma_f32_16x16x32_bf16 v[204:207], a[8:11], a[24:27], 0
    v_mfma_f32_16x16x32_bf16 v[208:211], a[12:15], a[24:27], 0
    ds_read_b128 a[84:87], v26 offset:10240
    s_add_u32 m0, s86, 143360
    v_mfma_f32_16x16x32_bf16 v[212:215], a[16:19], a[24:27], 0
    buffer_load_dwordx4 v5, s[36:39], s80 offen offset:0 lds
    v_mfma_f32_16x16x32_bf16 v[216:219], a[0:3], a[28:31], 0
    s_mul_i32 s72, s72, 1664525
    v_mfma_f32_16x16x32_bf16 v[220:223], a[4:7], a[28:31], 0
    s_add_u32 s72, s72, 1013904223
    v_mfma_f32_16x16x32_bf16 v[224:227], a[8:11], a[28:31], 0
    s_bfe_u32 s92, s78, 262152
    v_mov_b32_e64 v29, s72
    s_mul_i32 s81, s92, s83
    v_mfma_f32_16x16x32_bf16 v[228:231], a[12:15], a[28:31], 0
    s_add_u32 m0, s85, 65536
L_pad7:
    s_cbranch_execz L_pad11
    s_nop 0
    v_mfma_f32_16x16x32_bf16 v[232:235], a[16:19], a[28:31], 0
    buffer_load_dwordx4 v11, s[40:43], s81 offen offset:0 lds
    v_mfma_f32_16x16x32_bf16 v[236:239], a[0:3], a[32:35], 0
    v_mfma_f32_16x16x32_bf16 v[240:243], a[4:7], a[32:35], 0
    v_mfma_f32_16x16x32_bf16 v[244:247], a[8:11], a[32:35], 0
    buffer_load_dwordx4 v12, s[40:43], s81 offen offset:1024 lds
    v_mfma_f32_16x16x32_bf16 v[248:251], a[12:15], a[32:35], 0
    v_mfma_f32_16x16x32_bf16 v[252:255], a[16:19], a[32:35], 0
    s_waitcnt vmcnt(7) lgkmcnt(0)
    s_barrier
    v_mfma_f32_16x16x32_bf16 v[96:99], a[88:91], a[52:55], v[96:99]
    ds_read_b128 a[0:3], v23 offset:20480
    v_mfma_f32_16x16x32_bf16 v[100:103], a[88:91], a[56:59], v[100:103]
    buffer_load_dwordx4 v13, s[40:43], s81 offen offset:2048 lds
    v_mfma_f32_16x16x32_bf16 v[104:107], a[88:91], a[60:63], v[104:107]
    ds_read_b128 a[4:7], v23 offset:22528
    v_mfma_f32_16x16x32_bf16 v[108:111], a[88:91], a[64:67], v[108:111]
    ds_read_b128 a[8:11], v23 offset:24576
    v_mfma_f32_16x16x32_bf16 v[112:115], a[88:91], a[68:71], v[112:115]
    buffer_load_dwordx4 v14, s[40:43], s81 offen offset:3072 lds
    v_mfma_f32_16x16x32_bf16 v[116:119], a[92:95], a[52:55], v[116:119]
    ds_read_b128 a[12:15], v23 offset:26624
    v_mfma_f32_16x16x32_bf16 v[120:123], a[92:95], a[56:59], v[120:123]
    ds_read_b128 a[16:19], v23 offset:28672
    s_add_u32 s81, s81, s84
    v_mfma_f32_16x16x32_bf16 v[124:127], a[92:95], a[60:63], v[124:127]
    s_add_u32 m0, s85, 69632
    v_mfma_f32_16x16x32_bf16 v[128:131], a[92:95], a[64:67], v[128:131]
    ds_read_b64_tr_b16 a[36:37], v27 offset:49152
    v_mfma_f32_16x16x32_bf16 v[132:135], a[92:95], a[68:71], v[132:135]
    buffer_load_dwordx4 v11, s[40:43], s81 offen offset:0 lds
    v_mfma_f32_16x16x32_bf16 v[136:139], a[96:99], a[52:55], v[136:139]
    ds_read_b64_tr_b16 a[38:39], v27 offset:49664
    v_mfma_f32_16x16x32_bf16 v[140:143], a[96:99], a[56:59], v[140:143]
    ds_read_b64_tr_b16 a[40:41], v28 offset:49152
    v_mfma_f32_16x16x32_bf16 v[144:147], a[96:99], a[60:63], v[144:147]
    buffer_load_dwordx4 v12, s[40:43], s81 offen offset:1024 lds
    v_mfma_f32_16x16x32_bf16 v[148:151], a[96:99], a[64:67], v[148:151]
    ds_read_b64_tr_b16 a[42:43], v28 offset:49664
    v_mfma_f32_16x16x32_bf16 v[152:155], a[96:99], a[68:71], v[152:155]
    ds_read_b64_tr_b16 a[44:45], v27 offset:57344
    v_mfma_f32_16x16x32_bf16 v[156:159], a[100:103], a[52:55], v[156:159]
    buffer_load_dwordx4 v13, s[40:43], s81 offen offset:2048 lds
    v_mfma_f32_16x16x32_bf16 v[160:163], a[100:103], a[56:59], v[160:163]
    ds_read_b64_tr_b16 a[46:47], v27 offset:57856
    v_mfma_f32_16x16x32_bf16 v[164:167], a[100:103], a[60:63], v[164:167]
    v_mfma_f32_16x16x32_bf16 v[168:171], a[100:103], a[64:67], v[168:171]
    ds_read_b64_tr_b16 a[48:49], v28 offset:57344
    v_mfma_f32_16x16x32_bf16 v[172:175], a[100:103], a[68:71], v[172:175]
    buffer_load_dwordx4 v14, s[40:43], s81 offen offset:3072 lds
    v_mfma_f32_16x16x32_bf16 v[176:179], a[52:55], a[72:75], v[176:179]
    ds_read_b64_tr_b16 a[50:51], v28 offset:57856
    v_mfma_f32_16x16x32_bf16 v[180:183], a[56:59], a[72:75], v[180:183]
    ds_read_b128 a[20:23], v25 offset:32768
    s_bfe_u32 s92, s78, 262156
    v_mfma_f32_16x16x32_bf16 v[184:187], a[60:63], a[72:75], v[184:187]
    s_lshl_b32 s80, s92, 7
    v_mfma_f32_16x16x32_bf16 v[188:191], a[64:67], a[72:75], v[188:191]
    ds_read_b128 a[24:27], v25 offset:34816
    s_add_u32 m0, s86, 98304
    v_mfma_f32_16x16x32_bf16 v[192:195], a[68:71], a[72:75], v[192:195]
    ds_read_b128 a[28:31], v25 offset:40960
    v_mfma_f32_16x16x32_bf16 v[196:199], a[52:55], a[76:79], v[196:199]
    s_mov_b64 exec, s[90:91]
    buffer_load_dwordx4 v1, s[36:39], s80 offen offset:0 lds
    s_mov_b64 exec, -1
    v_mfma_f32_16x16x32_bf16 v[200:203], a[56:59], a[76:79], v[200:203]
    ds_read_b128 a[32:35], v25 offset:43008
    v_mfma_f32_16x16x32_bf16 v[204:207], a[60:63], a[76:79], v[204:207]
    v_mfma_f32_16x16x32_bf16 v[208:211], a[64:67], a[76:79], v[208:211]
    buffer_load_dwordx4 v2, s[36:39], s80 offen offset:1024 lds
    v_mfma_f32_16x16x32_bf16 v[212:215], a[68:71], a[76:79], v[212:215]
    v_mfma_f32_16x16x32_bf16 v[216:219], a[52:55], a[80:83], v[216:219]
    v_mfma_f32_16x16x32_bf16 v[220:223], a[56:59], a[80:83], v[220:223]
    buffer_load_dwordx4 v3, s[36:39], s80 offen offset:2048 lds
    v_mfma_f32_16x16x32_bf16 v[224:227], a[60:63], a[80:83], v[224:227]
    v_mfma_f32_16x16x32_bf16 v[228:231], a[64:67], a[80:83], v[228:231]
    v_mfma_f32_16x16x32_bf16 v[232:235], a[68:71], a[80:83], v[232:235]
    buffer_load_dwordx4 v4, s[36:39], s80 offen offset:3072 lds
    v_mfma_f32_16x16x32_bf16 v[236:239], a[52:55], a[84:87], v[236:239]
    v_mfma_f32_16x16x32_bf16 v[240:243], a[56:59], a[84:87], v[240:243]
    v_mfma_f32_16x16x32_bf16 v[244:247], a[60:63], a[84:87], v[244:247]
    v_mfma_f32_16x16x32_bf16 v[248:251], a[64:67], a[84:87], v[248:251]
    s_add_u32 m0, s86, 102400
    v_mfma_f32_16x16x32_bf16 v[252:255], a[68:71], a[84:87], v[252:255]
    buffer_load_dwordx4 v5, s[36:39], s80 offen offset:0 lds
    s_waitcnt lgkmcnt(0)
    v_mfma_f32_16x16x32_bf16 v[96:99], a[36:39], a[0:3], v[96:99]
    ds_read_b128 a[52:55], v24 offset:20480
    v_mfma_f32_16x16x32_bf16 v[100:103], a[36:39], a[4:7], v[100:103]
    ds_read_b128 a[56:59], v24 offset:22528
    v_mfma_f32_16x16x32_bf16 v[104:107], a[36:39], a[8:11], v[104:107]
    s_bfe_u32 s92, s78, 262156
    v_mfma_f32_16x16x32_bf16 v[108:111], a[36:39], a[12:15], v[108:111]
    ds_read_b128 a[60:63], v24 offset:24576
    s_mul_i32 s81, s92, s83
    v_mfma_f32_16x16x32_bf16 v[112:115], a[36:39], a[16:19], v[112:115]
    s_add_u32 m0, s85, 0
    ds_read_b128 a[64:67], v24 offset:26624
    v_mfma_f32_16x16x32_bf16 v[116:119], a[40:43], a[0:3], v[116:119]
    buffer_load_dwordx4 v11, s[40:43], s81 offen offset:0 lds
    v_mfma_f32_16x16x32_bf16 v[120:123], a[40:43], a[4:7], v[120:123]
    ds_read_b128 a[68:71], v24 offset:28672
    v_mfma_f32_16x16x32_bf16 v[124:127], a[40:43], a[8:11], v[124:127]
    v_mfma_f32_16x16x32_bf16 v[128:131], a[40:43], a[12:15], v[128:131]
    ds_read_b64_tr_b16 a[88:89], v27 offset:53248
    v_mfma_f32_16x16x32_bf16 v[132:135], a[40:43], a[16:19], v[132:135]
    buffer_load_dwordx4 v12, s[40:43], s81 offen offset:1024 lds
    v_mfma_f32_16x16x32_bf16 v[136:139], a[44:47], a[0:3], v[136:139]
    ds_read_b64_tr_b16 a[90:91], v27 offset:53760
    v_mfma_f32_16x16x32_bf16 v[140:143], a[44:47], a[4:7], v[140:143]
    ds_read_b64_tr_b16 a[92:93], v28 offset:53248
    v_mfma_f32_16x16x32_bf16 v[144:147], a[44:47], a[8:11], v[144:147]
    buffer_load_dwordx4 v13, s[40:43], s81 offen offset:2048 lds
    v_mfma_f32_16x16x32_bf16 v[148:151], a[44:47], a[12:15], v[148:151]
    ds_read_b64_tr_b16 a[94:95], v28 offset:53760
    v_mfma_f32_16x16x32_bf16 v[152:155], a[44:47], a[16:19], v[152:155]
    ds_read_b64_tr_b16 a[96:97], v27 offset:61440
    v_mfma_f32_16x16x32_bf16 v[156:159], a[48:51], a[0:3], v[156:159]
    buffer_load_dwordx4 v14, s[40:43], s81 offen offset:3072 lds
    v_mfma_f32_16x16x32_bf16 v[160:163], a[48:51], a[4:7], v[160:163]
    ds_read_b64_tr_b16 a[98:99], v27 offset:61952
    v_mfma_f32_16x16x32_bf16 v[164:167], a[48:51], a[8:11], v[164:167]
    v_mfma_f32_16x16x32_bf16 v[168:171], a[48:51], a[12:15], v[168:171]
    ds_read_b64_tr_b16 a[100:101], v28 offset:61440
    s_add_u32 s81, s81, s84
    v_mfma_f32_16x16x32_bf16 v[172:175], a[48:51], a[16:19], v[172:175]
    s_add_u32 m0, s85, 4096
    ds_read_b64_tr_b16 a[102:103], v28 offset:61952
    v_mfma_f32_16x16x32_bf16 v[176:179], a[0:3], a[20:23], v[176:179]
    buffer_load_dwordx4 v11, s[40:43], s81 offen offset:0 lds
    v_mfma_f32_16x16x32_bf16 v[180:183], a[4:7], a[20:23], v[180:183]
    ds_read_b128 a[72:75], v26 offset:32768
    v_mfma_f32_16x16x32_bf16 v[184:187], a[8:11], a[20:23], v[184:187]
    v_mfma_f32_16x16x32_bf16 v[188:191], a[12:15], a[20:23], v[188:191]
    ds_read_b128 a[76:79], v26 offset:34816
    v_mfma_f32_16x16x32_bf16 v[192:195], a[16:19], a[20:23], v[192:195]
    ds_read_b128 a[80:83], v26 offset:40960
    v_mfma_f32_16x16x32_bf16 v[196:199], a[0:3], a[24:27], v[196:199]
    v_mfma_f32_16x16x32_bf16 v[200:203], a[4:7], a[24:27], v[200:203]
    ds_read_b128 a[84:87], v26 offset:43008
    v_mfma_f32_16x16x32_bf16 v[204:207], a[8:11], a[24:27], v[204:207]
    v_mfma_f32_16x16x32_bf16 v[208:211], a[12:15], a[24:27], v[208:211]
    v_mfma_f32_16x16x32_bf16 v[212:215], a[16:19], a[24:27], v[212:215]
    v_mfma_f32_16x16x32_bf16 v[216:219], a[0:3], a[28:31], v[216:219]
    v_mfma_f32_16x16x32_bf16 v[220:223], a[4:7], a[28:31], v[220:223]
    v_mfma_f32_16x16x32_bf16 v[224:227], a[8:11], a[28:31], v[224:227]
    v_mfma_f32_16x16x32_bf16 v[228:231], a[12:15], a[28:31], v[228:231]
    v_mfma_f32_16x16x32_bf16 v[232:235], a[16:19], a[28:31], v[232:235]
    v_mfma_f32_16x16x32_bf16 v[236:239], a[0:3], a[32:35], v[236:239]
    v_mfma_f32_16x16x32_bf16 v[240:243], a[4:7], a[32:35], v[240:243]
    v_mfma_f32_16x16x32_bf16 v[244:247], a[8:11], a[32:35], v[244:247]
    v_mfma_f32_16x16x32_bf16 v[248:251], a[12:15], a[32:35], v[248:251]
    v_mfma_f32_16x16x32_bf16 v[252:255], a[16:19], a[32:35], v[252:255]
    s_waitcnt vmcnt(10) lgkmcnt(0)
    s_barrier
    v_mfma_f32_16x16x32_bf16 v[96:99], a[88:91], a[52:55], v[96:99]
    ds_read_b128 a[0:3], v23 offset:40960
    v_mfma_f32_16x16x32_bf16 v[100:103], a[88:91], a[56:59], v[100:103]
    buffer_load_dwordx4 v12, s[40:43], s81 offen offset:1024 lds
    v_mfma_f32_16x16x32_bf16 v[104:107], a[88:91], a[60:63], v[104:107]
    ds_read_b128 a[4:7], v23 offset:43008
    v_mfma_f32_16x16x32_bf16 v[108:111], a[88:91], a[64:67], v[108:111]
    ds_read_b128 a[8:11], v23 offset:45056
    v_mfma_f32_16x16x32_bf16 v[112:115], a[88:91], a[68:71], v[112:115]
    buffer_load_dwordx4 v13, s[40:43], s81 offen offset:2048 lds
    v_mfma_f32_16x16x32_bf16 v[116:119], a[92:95], a[52:55], v[116:119]
    ds_read_b128 a[12:15], v23 offset:47104
    v_mfma_f32_16x16x32_bf16 v[120:123], a[92:95], a[56:59], v[120:123]
    ds_read_b128 a[16:19], v23 offset:49152
    v_mfma_f32_16x16x32_bf16 v[124:127], a[92:95], a[60:63], v[124:127]
    v_mfma_f32_16x16x32_bf16 v[128:131], a[92:95], a[64:67], v[128:131]
    ds_read_b64_tr_b16 a[36:37], v86 offset:16384
    v_mfma_f32_16x16x32_bf16 v[132:135], a[92:95], a[68:71], v[132:135]
    buffer_load_dwordx4 v14, s[40:43], s81 offen offset:3072 lds
    v_mfma_f32_16x16x32_bf16 v[136:139], a[96:99], a[52:55], v[136:139]
    ds_read_b64_tr_b16 a[38:39], v86 offset:16896
    v_mfma_f32_16x16x32_bf16 v[140:143], a[96:99], a[56:59], v[140:143]
    ds_read_b64_tr_b16 a[40:41], v87 offset:16384
    v_mfma_f32_16x16x32_bf16 v[144:147], a[96:99], a[60:63], v[144:147]
    buffer_load_dwordx2 v[50:51], v88, s[36:39], 0 offen offset:0
    v_mfma_f32_16x16x32_bf16 v[148:151], a[96:99], a[64:67], v[148:151]
    ds_read_b64_tr_b16 a[42:43], v87 offset:16896
    v_mfma_f32_16x16x32_bf16 v[152:155], a[96:99], a[68:71], v[152:155]
    ds_read_b64_tr_b16 a[44:45], v86 offset:24576
    v_mfma_f32_16x16x32_bf16 v[156:159], a[100:103], a[52:55], v[156:159]
    v_mfma_f32_16x16x32_bf16 v[160:163], a[100:103], a[56:59], v[160:163]
    ds_read_b64_tr_b16 a[46:47], v86 offset:25088
    v_mfma_f32_16x16x32_bf16 v[164:167], a[100:103], a[60:63], v[164:167]
    buffer_load_dwordx2 v[52:53], v88, s[36:39], 0 offen offset:256
    v_mfma_f32_16x16x32_bf16 v[168:171], a[100:103], a[64:67], v[168:171]
    ds_read_b64_tr_b16 a[48:49], v87 offset:24576
    v_mfma_f32_16x16x32_bf16 v[172:175], a[100:103], a[68:71], v[172:175]
    ds_read_b64_tr_b16 a[50:51], v87 offset:25088
    v_mfma_f32_16x16x32_bf16 v[176:179], a[52:55], a[72:75], v[176:179]
    buffer_load_dwordx2 v[54:55], v88, s[36:39], 0 offen offset:512
    v_mfma_f32_16x16x32_bf16 v[180:183], a[56:59], a[72:75], v[180:183]
    ds_read_b128 a[20:23], v84 offset:0
    v_mfma_f32_16x16x32_bf16 v[184:187], a[60:63], a[72:75], v[184:187]
    v_mfma_f32_16x16x32_bf16 v[188:191], a[64:67], a[72:75], v[188:191]
    ds_read_b128 a[24:27], v84 offset:2048
    v_mfma_f32_16x16x32_bf16 v[192:195], a[68:71], a[72:75], v[192:195]
    ds_read_b128 a[28:31], v84 offset:8192
    v_mfma_f32_16x16x32_bf16 v[196:199], a[52:55], a[76:79], v[196:199]
    buffer_load_dwordx2 v[56:57], v88, s[36:39], 0 offen offset:768
    v_mfma_f32_16x16x32_bf16 v[200:203], a[56:59], a[76:79], v[200:203]
    ds_read_b128 a[32:35], v84 offset:10240
    v_mfma_f32_16x16x32_bf16 v[204:207], a[60:63], a[76:79], v[204:207]
    v_mfma_f32_16x16x32_bf16 v[208:211], a[64:67], a[76:79], v[208:211]
    buffer_load_dwordx2 v[58:59], v88, s[36:39], 0 offen offset:1024
    v_mfma_f32_16x16x32_bf16 v[212:215], a[68:71], a[76:79], v[212:215]
    v_mfma_f32_16x16x32_bf16 v[216:219], a[52:55], a[80:83], v[216:219]
    v_mfma_f32_16x16x32_bf16 v[220:223], a[56:59], a[80:83], v[220:223]
    v_mfma_f32_16x16x32_bf16 v[224:227], a[60:63], a[80:83], v[224:227]
    v_mfma_f32_16x16x32_bf16 v[228:231], a[64:67], a[80:83], v[228:231]
    buffer_load_dword v89, v82, s[52:55], 0 offen
    v_mfma_f32_16x16x32_bf16 v[232:235], a[68:71], a[80:83], v[232:235]
    v_mfma_f32_16x16x32_bf16 v[236:239], a[52:55], a[84:87], v[236:239]
    v_mfma_f32_16x16x32_bf16 v[240:243], a[56:59], a[84:87], v[240:243]
    v_mfma_f32_16x16x32_bf16 v[244:247], a[60:63], a[84:87], v[244:247]
    s_bfe_u32 s92, s78, 262160
    v_mfma_f32_16x16x32_bf16 v[248:251], a[64:67], a[84:87], v[248:251]
    s_lshl_b32 s80, s92, 7
    v_mfma_f32_16x16x32_bf16 v[252:255], a[68:71], a[84:87], v[252:255]
    s_add_u32 m0, s86, 118784
    s_waitcnt lgkmcnt(0)
    v_mfma_f32_16x16x32_bf16 v[96:99], a[36:39], a[0:3], v[96:99]
    ds_read_b128 a[52:55], v24 offset:40960
    v_mfma_f32_16x16x32_bf16 v[100:103], a[36:39], a[4:7], v[100:103]
    s_mov_b64 exec, s[90:91]
    buffer_load_dwordx4 v1, s[36:39], s80 offen offset:0 lds
    s_mov_b64 exec, -1
    v_mfma_f32_16x16x32_bf16 v[104:107], a[36:39], a[8:11], v[104:107]
    ds_read_b128 a[56:59], v24 offset:43008
    v_mfma_f32_16x16x32_bf16 v[108:111], a[36:39], a[12:15], v[108:111]
    ds_read_b128 a[60:63], v24 offset:45056
    v_mfma_f32_16x16x32_bf16 v[112:115], a[36:39], a[16:19], v[112:115]
    ds_read_b128 a[64:67], v24 offset:47104
    v_mfma_f32_16x16x32_bf16 v[116:119], a[40:43], a[0:3], v[116:119]
    buffer_load_dwordx4 v2, s[36:39], s80 offen offset:1024 lds
    v_mfma_f32_16x16x32_bf16 v[120:123], a[40:43], a[4:7], v[120:123]
    ds_read_b128 a[68:71], v24 offset:49152
    v_mfma_f32_16x16x32_bf16 v[124:127], a[40:43], a[8:11], v[124:127]
    v_mfma_f32_16x16x32_bf16 v[128:131], a[40:43], a[12:15], v[128:131]
    ds_read_b64_tr_b16 a[88:89], v86 offset:20480
    v_mfma_f32_16x16x32_bf16 v[132:135], a[40:43], a[16:19], v[132:135]
    buffer_load_dwordx4 v3, s[36:39], s80 offen offset:2048 lds
    v_mfma_f32_16x16x32_bf16 v[136:139], a[44:47], a[0:3], v[136:139]
    ds_read_b64_tr_b16 a[90:91], v86 offset:20992
    v_mfma_f32_16x16x32_bf16 v[140:143], a[44:47], a[4:7], v[140:143]
    ds_read_b64_tr_b16 a[92:93], v87 offset:20480
    v_mfma_f32_16x16x32_bf16 v[144:147], a[44:47], a[8:11], v[144:147]
    v_mfma_f32_16x16x32_bf16 v[148:151], a[44:47], a[12:15], v[148:151]
    ds_read_b64_tr_b16 a[94:95], v87 offset:20992
    v_mfma_f32_16x16x32_bf16 v[152:155], a[44:47], a[16:19], v[152:155]
    buffer_load_dwordx4 v4, s[36:39], s80 offen offset:3072 lds
    v_mfma_f32_16x16x32_bf16 v[156:159], a[48:51], a[0:3], v[156:159]
    ds_read_b64_tr_b16 a[96:97], v86 offset:28672
    v_mfma_f32_16x16x32_bf16 v[160:163], a[48:51], a[4:7], v[160:163]
    ds_read_b64_tr_b16 a[98:99], v86 offset:29184
    v_mfma_f32_16x16x32_bf16 v[164:167], a[48:51], a[8:11], v[164:167]
    s_add_u32 m0, s86, 122880
    v_mfma_f32_16x16x32_bf16 v[168:171], a[48:51], a[12:15], v[168:171]
    ds_read_b64_tr_b16 a[100:101], v87 offset:28672
    v_mfma_f32_16x16x32_bf16 v[172:175], a[48:51], a[16:19], v[172:175]
    buffer_load_dwordx4 v5, s[36:39], s80 offen offset:0 lds
    v_mfma_f32_16x16x32_bf16 v[176:179], a[0:3], a[20:23], v[176:179]
    ds_read_b64_tr_b16 a[102:103], v87 offset:29184
    v_mfma_f32_16x16x32_bf16 v[180:183], a[4:7], a[20:23], v[180:183]
    ds_read_b128 a[72:75], v85 offset:0
    v_mfma_f32_16x16x32_bf16 v[184:187], a[8:11], a[20:23], v[184:187]
    s_bfe_u32 s92, s78, 262160
    v_mfma_f32_16x16x32_bf16 v[188:191], a[12:15], a[20:23], v[188:191]
    ds_read_b128 a[76:79], v85 offset:2048
    v_mfma_f32_16x16x32_bf16 v[192:195], a[16:19], a[20:23], v[192:195]
    s_mul_i32 s81, s92, s83
    ds_read_b128 a[80:83], v85 offset:8192
    v_mfma_f32_16x16x32_bf16 v[196:199], a[0:3], a[24:27], v[196:199]
    s_add_u32 m0, s85, 32768
    v_mfma_f32_16x16x32_bf16 v[200:203], a[4:7], a[24:27], v[200:203]
    ds_read_b128 a[84:87], v85 offset:10240
    v_mfma_f32_16x16x32_bf16 v[204:207], a[8:11], a[24:27], v[204:207]
    buffer_load_dwordx4 v11, s[40:43], s81 offen offset:0 lds
    v_mfma_f32_16x16x32_bf16 v[208:211], a[12:15], a[24:27], v[208:211]
    v_mfma_f32_16x16x32_bf16 v[212:215], a[16:19], a[24:27], v[212:215]
    v_mfma_f32_16x16x32_bf16 v[216:219], a[0:3], a[28:31], v[216:219]
    buffer_load_dwordx4 v12, s[40:43], s81 offen offset:1024 lds
    v_mfma_f32_16x16x32_bf16 v[220:223], a[4:7], a[28:31], v[220:223]
    v_mfma_f32_16x16x32_bf16 v[224:227], a[8:11], a[28:31], v[224:227]
    v_mfma_f32_16x16x32_bf16 v[228:231], a[12:15], a[28:31], v[228:231]
    v_mfma_f32_16x16x32_bf16 v[232:235], a[16:19], a[28:31], v[232:235]
    buffer_load_dwordx4 v13, s[40:43], s81 offen offset:2048 lds
    v_mfma_f32_16x16x32_bf16 v[236:239], a[0:3], a[32:35], v[236:239]
    v_mfma_f32_16x16x32_bf16 v[240:243], a[4:7], a[32:35], v[240:243]
    v_mfma_f32_16x16x32_bf16 v[244:247], a[8:11], a[32:35], v[244:247]
    v_mfma_f32_16x16x32_bf16 v[248:251], a[12:15], a[32:35], v[248:251]
    v_mfma_f32_16x16x32_bf16 v[252:255], a[16:19], a[32:35], v[252:255]
    s_waitcnt vmcnt(14) lgkmcnt(0)
    s_barrier
    v_mfma_f32_16x16x32_bf16 v[96:99], a[88:91], a[52:55], v[96:99]
    ds_read_b128 a[0:3], v23 offset:0
    v_mfma_f32_16x16x32_bf16 v[100:103], a[88:91], a[56:59], v[100:103]
    buffer_load_dwordx4 v14, s[40:43], s81 offen offset:3072 lds
    v_mfma_f32_16x16x32_bf16 v[104:107], a[88:91], a[60:63], v[104:107]
    ds_read_b128 a[4:7], v23 offset:2048
    v_mfma_f32_16x16x32_bf16 v[108:111], a[88:91], a[64:67], v[108:111]
    ds_read_b128 a[8:11], v23 offset:4096
    v_mfma_f32_16x16x32_bf16 v[112:115], a[88:91], a[68:71], v[112:115]
    s_waitcnt vmcnt(9)
    s_add_u32 s81, s81, s84
    v_lshlrev_b32 v60, 16, v50
    v_mfma_f32_16x16x32_bf16 v[116:119], a[92:95], a[52:55], v[116:119]
    ds_read_b128 a[12:15], v23 offset:6144
    s_add_u32 m0, s85, 36864
    v_and_b32 v61, 0xffff0000, v50
    v_mfma_f32_16x16x32_bf16 v[120:123], a[92:95], a[56:59], v[120:123]
    buffer_load_dwordx4 v11, s[40:43], s81 offen offset:0 lds
    v_mfma_f32_16x16x32_bf16 v[124:127], a[92:95], a[60:63], v[124:127]
    ds_read_b128 a[16:19], v23 offset:8192
    v_lshlrev_b32_e64 v62, 16, v51
    v_mfma_f32_16x16x32_bf16 v[128:131], a[92:95], a[64:67], v[128:131]
    ds_read_b64_tr_b16 a[36:37], v27 offset:16384
    v_and_b32 v63, 0xffff0000, v51
    v_mfma_f32_16x16x32_bf16 v[132:135], a[92:95], a[68:71], v[132:135]
    ds_read_b64_tr_b16 a[38:39], v27 offset:16896
    v_mfma_f32_16x16x32_bf16 v[136:139], a[96:99], a[52:55], v[136:139]
    v_lshlrev_b32_e64 v64, 16, v52
    v_mfma_f32_16x16x32_bf16 v[140:143], a[96:99], a[56:59], v[140:143]
    buffer_load_dwordx4 v12, s[40:43], s81 offen offset:1024 lds
    v_mfma_f32_16x16x32_bf16 v[144:147], a[96:99], a[60:63], v[144:147]
    ds_read_b64_tr_b16 a[40:41], v28 offset:16384
    v_and_b32 v65, 0xffff0000, v52
    v_mfma_f32_16x16x32_bf16 v[148:151], a[96:99], a[64:67], v[148:151]
    v_lshlrev_b32_e64 v66, 16, v53
    v_mfma_f32_16x16x32_bf16 v[152:155], a[96:99], a[68:71], v[152:155]
    ds_read_b64_tr_b16 a[42:43], v28 offset:16896
    v_and_b32 v67, 0xffff0000, v53
    v_mfma_f32_16x16x32_bf16 v[156:159], a[100:103], a[52:55], v[156:159]
    buffer_load_dwordx4 v13, s[40:43], s81 offen offset:2048 lds
    v_mfma_f32_16x16x32_bf16 v[160:163], a[100:103], a[56:59], v[160:163]
    ds_read_b64_tr_b16 a[44:45], v27 offset:24576
    v_lshlrev_b32_e64 v68, 16, v54
    v_mfma_f32_16x16x32_bf16 v[164:167], a[100:103], a[60:63], v[164:167]
    ds_read_b64_tr_b16 a[46:47], v27 offset:25088
    v_and_b32 v69, 0xffff0000, v54
    v_mfma_f32_16x16x32_bf16 v[168:171], a[100:103], a[64:67], v[168:171]
    ds_read_b64_tr_b16 a[48:49], v28 offset:24576
    v_lshlrev_b32_e64 v70, 16, v55
    v_mfma_f32_16x16x32_bf16 v[172:175], a[100:103], a[68:71], v[172:175]
    buffer_load_dwordx4 v14, s[40:43], s81 offen offset:3072 lds
    v_mfma_f32_16x16x32_bf16 v[176:179], a[52:55], a[72:75], v[176:179]
    ds_read_b64_tr_b16 a[50:51], v28 offset:25088
    v_and_b32 v71, 0xffff0000, v55
    v_mfma_f32_16x16x32_bf16 v[180:183], a[56:59], a[72:75], v[180:183]
    ds_read_b128 a[20:23], v25 offset:0
    v_lshlrev_b32_e64 v72, 16, v56
    v_mfma_f32_16x16x32_bf16 v[184:187], a[60:63], a[72:75], v[184:187]
    s_bfe_u32 s92, s78, 262164
    v_mfma_f32_16x16x32_bf16 v[188:191], a[64:67], a[72:75], v[188:191]
    ds_read_b128 a[24:27], v25 offset:2048
    v_and_b32 v73, 0xffff0000, v56
    v_mfma_f32_16x16x32_bf16 v[192:195], a[68:71], a[72:75], v[192:195]
    s_lshl_b32 s80, s92, 7
    v_lshlrev_b32 v74, 16, v57
    v_mfma_f32_16x16x32_bf16 v[196:199], a[52:55], a[76:79], v[196:199]
    ds_read_b128 a[28:31], v25 offset:8192
    s_add_u32 m0, s86, 139264
    v_and_b32 v75, 0xffff0000, v57
    v_mfma_f32_16x16x32_bf16 v[200:203], a[56:59], a[76:79], v[200:203]
    ds_read_b128 a[32:35], v25 offset:10240
    v_mfma_f32_16x16x32_bf16 v[204:207], a[60:63], a[76:79], v[204:207]
    s_mov_b64 exec, s[90:91]
    buffer_load_dwordx4 v1, s[36:39], s80 offen offset:0 lds
    s_mov_b64 exec, -1
    v_mfma_f32_16x16x32_bf16 v[208:211], a[64:67], a[76:79], v[208:211]
    v_lshlrev_b32_e64 v76, 16, v58
    v_and_b32 v77, 0xffff0000, v58
    v_mfma_f32_16x16x32_bf16 v[212:215], a[68:71], a[76:79], v[212:215]
    v_mfma_f32_16x16x32_bf16 v[216:219], a[52:55], a[80:83], v[216:219]
    v_lshlrev_b32_e64 v78, 16, v59
    v_mfma_f32_16x16x32_bf16 v[220:223], a[56:59], a[80:83], v[220:223]
    buffer_load_dwordx4 v2, s[36:39], s80 offen offset:1024 lds
    v_mfma_f32_16x16x32_bf16 v[224:227], a[60:63], a[80:83], v[224:227]
    v_and_b32 v79, 0xffff0000, v59
    v_mfma_f32_16x16x32_bf16 v[228:231], a[64:67], a[80:83], v[228:231]
    v_add_f32_e64 v50, v60, v61
    v_mfma_f32_16x16x32_bf16 v[232:235], a[68:71], a[80:83], v[232:235]
    v_add_f32_e64 v50, v50, v62
    v_mfma_f32_16x16x32_bf16 v[236:239], a[52:55], a[84:87], v[236:239]
    buffer_load_dwordx4 v3, s[36:39], s80 offen offset:2048 lds
    v_mfma_f32_16x16x32_bf16 v[240:243], a[56:59], a[84:87], v[240:243]
    v_add_f32_e64 v50, v50, v63
    v_mfma_f32_16x16x32_bf16 v[244:247], a[60:63], a[84:87], v[244:247]
    v_add_f32_e64 v50, v50, v64
    v_mfma_f32_16x16x32_bf16 v[248:251], a[64:67], a[84:87], v[248:251]
    v_add_f32_e64 v50, v50, v65
    v_mfma_f32_16x16x32_bf16 v[252:255], a[68:71], a[84:87], v[252:255]
    buffer_load_dwordx4 v4, s[36:39], s80 offen offset:3072 lds
    s_waitcnt lgkmcnt(0)
    v_mfma_f32_16x16x32_bf16 v[96:99], a[36:39], a[0:3], v[96:99]
    ds_read_b128 a[52:55], v24 offset:0
    v_add_f32 v50, v50, v66
    v_mfma_f32_16x16x32_bf16 v[100:103], a[36:39], a[4:7], v[100:103]
    ds_read_b128 a[56:59], v24 offset:2048
    v_add_f32_e64 v50, v50, v67
    v_mfma_f32_16x16x32_bf16 v[104:107], a[36:39], a[8:11], v[104:107]
    s_add_u32 m0, s86, 143360
    v_mfma_f32_16x16x32_bf16 v[108:111], a[36:39], a[12:15], v[108:111]
    v_add_f32_e64 v50, v50, v68
    v_mfma_f32_16x16x32_bf16 v[112:115], a[36:39], a[16:19], v[112:115]
    ds_read_b128 a[60:63], v24 offset:4096
    v_add_f32_e64 v50, v50, v69
    v_mfma_f32_16x16x32_bf16 v[116:119], a[40:43], a[0:3], v[116:119]
    buffer_load_dwordx4 v5, s[36:39], s80 offen offset:0 lds
    v_mfma_f32_16x16x32_bf16 v[120:123], a[40:43], a[4:7], v[120:123]
    ds_read_b128 a[64:67], v24 offset:6144
    v_add_f32_e64 v50, v50, v70
    v_mfma_f32_16x16x32_bf16 v[124:127], a[40:43], a[8:11], v[124:127]
    ds_read_b128 a[68:71], v24 offset:8192
    v_add_f32_e64 v50, v50, v71
    v_mfma_f32_16x16x32_bf16 v[128:131], a[40:43], a[12:15], v[128:131]
    ds_read_b64_tr_b16 a[88:89], v27 offset:20480
    s_bfe_u32 s92, s78, 262164
    v_add_f32_e64 v50, v50, v72
    v_mfma_f32_16x16x32_bf16 v[132:135], a[40:43], a[16:19], v[132:135]
    s_mul_i32 s81, s92, s83
    ds_read_b64_tr_b16 a[90:91], v27 offset:20992
    v_mfma_f32_16x16x32_bf16 v[136:139], a[44:47], a[0:3], v[136:139]
    v_add_f32 v50, v50, v73
    s_add_u32 m0, s85, 65536
    v_mfma_f32_16x16x32_bf16 v[140:143], a[44:47], a[4:7], v[140:143]
    ds_read_b64_tr_b16 a[92:93], v28 offset:20480
    v_add_f32_e64 v50, v50, v74
    v_mfma_f32_16x16x32_bf16 v[144:147], a[44:47], a[8:11], v[144:147]
    buffer_load_dwordx4 v11, s[40:43], s81 offen offset:0 lds
    v_mfma_f32_16x16x32_bf16 v[148:151], a[44:47], a[12:15], v[148:151]
    ds_read_b64_tr_b16 a[94:95], v28 offset:20992
    v_add_f32_e64 v50, v50, v75
    v_mfma_f32_16x16x32_bf16 v[152:155], a[44:47], a[16:19], v[152:155]
    v_add_f32_e64 v50, v50, v76
    v_mfma_f32_16x16x32_bf16 v[156:159], a[48:51], a[0:3], v[156:159]
    ds_read_b64_tr_b16 a[96:97], v27 offset:28672
    v_mfma_f32_16x16x32_bf16 v[160:163], a[48:51], a[4:7], v[160:163]
    v_add_f32_e64 v50, v50, v77
    v_mfma_f32_16x16x32_bf16 v[164:167], a[48:51], a[8:11], v[164:167]
    buffer_load_dwordx4 v12, s[40:43], s81 offen offset:1024 lds
    v_mfma_f32_16x16x32_bf16 v[168:171], a[48:51], a[12:15], v[168:171]
    ds_read_b64_tr_b16 a[98:99], v27 offset:29184
    v_add_f32_e64 v50, v50, v78
    v_mfma_f32_16x16x32_bf16 v[172:175], a[48:51], a[16:19], v[172:175]
    ds_read_b64_tr_b16 a[100:101], v28 offset:28672
    v_add_f32_e64 v50, v50, v79
    v_mfma_f32_16x16x32_bf16 v[176:179], a[0:3], a[20:23], v[176:179]
    ds_read_b64_tr_b16 a[102:103], v28 offset:29184
    v_add_f32_dpp v50, v50, v50 quad_perm:[1,0,3,2] row_mask:0xf bank_mask:0xf
    v_mfma_f32_16x16x32_bf16 v[180:183], a[4:7], a[20:23], v[180:183]
    buffer_load_dwordx4 v13, s[40:43], s81 offen offset:2048 lds
    v_mfma_f32_16x16x32_bf16 v[184:187], a[8:11], a[20:23], v[184:187]
    ds_read_b128 a[72:75], v26 offset:0
    v_add_f32_dpp v50, v50, v50 quad_perm:[2,3,0,1] row_mask:0xf bank_mask:0xf
    v_mfma_f32_16x16x32_bf16 v[188:191], a[12:15], a[20:23], v[188:191]
    ds_read_b128 a[76:79], v26 offset:2048
    v_add_f32_dpp v50, v50, v50 row_half_mirror row_mask:0xf bank_mask:0xf
    v_mfma_f32_16x16x32_bf16 v[192:195], a[16:19], a[20:23], v[192:195]
    buffer_load_dwordx4 v14, s[40:43], s81 offen offset:3072 lds
    v_mfma_f32_16x16x32_bf16 v[196:199], a[0:3], a[24:27], v[196:199]
    v_add_f32_dpp v50, v50, v50 row_mirror row_mask:0xf bank_mask:0xf
    v_mfma_f32_16x16x32_bf16 v[200:203], a[4:7], a[24:27], v[200:203]
    ds_read_b128 a[80:83], v26 offset:8192
    v_mov_b32_e64 v51, v50
    v_mfma_f32_16x16x32_bf16 v[204:207], a[8:11], a[24:27], v[204:207]
    ds_read_b128 a[84:87], v26 offset:10240
    v_permlane16_swap_b32 v50, v51
    v_mfma_f32_16x16x32_bf16 v[208:211], a[12:15], a[24:27], v[208:211]
    s_add_u32 s81, s81, s84
    v_add_f32_e64 v50, v50, v51
    v_mfma_f32_16x16x32_bf16 v[212:215], a[16:19], a[24:27], v[212:215]
    s_add_u32 m0, s85, 69632
    v_mfma_f32_16x16x32_bf16 v[216:219], a[0:3], a[28:31], v[216:219]
    v_mul_f32 v54, 0x3acccccd, v50
    v_mfma_f32_16x16x32_bf16 v[220:223], a[4:7], a[28:31], v[220:223]
    buffer_load_dwordx4 v11, s[40:43], s81 offen offset:0 lds
    v_mfma_f32_16x16x32_bf16 v[224:227], a[8:11], a[28:31], v[224:227]
    v_sub_f32_e64 v60, v60, v54
    v_mfma_f32_16x16x32_bf16 v[228:231], a[12:15], a[28:31], v[228:231]
    v_sub_f32_e64 v61, v61, v54
    v_mfma_f32_16x16x32_bf16 v[232:235], a[16:19], a[28:31], v[232:235]
    v_sub_f32_e64 v62, v62, v54
    v_mfma_f32_16x16x32_bf16 v[236:239], a[0:3], a[32:35], v[236:239]
    buffer_load_dwordx4 v12, s[40:43], s81 offen offset:1024 lds
    v_mfma_f32_16x16x32_bf16 v[240:243], a[4:7], a[32:35], v[240:243]
    v_sub_f32_e64 v63, v63, v54
    v_mfma_f32_16x16x32_bf16 v[244:247], a[8:11], a[32:35], v[244:247]
    v_sub_f32_e64 v64, v64, v54
    v_mfma_f32_16x16x32_bf16 v[248:251], a[12:15], a[32:35], v[248:251]
    v_mfma_f32_16x16x32_bf16 v[252:255], a[16:19], a[32:35], v[252:255]
    s_waitcnt vmcnt(11) lgkmcnt(0)
    s_barrier
    v_mfma_f32_16x16x32_bf16 v[96:99], a[88:91], a[52:55], v[96:99]
    ds_read_b128 a[0:3], v23 offset:20480
    v_sub_f32_e64 v65, v65, v54
    v_mfma_f32_16x16x32_bf16 v[100:103], a[88:91], a[56:59], v[100:103]
    buffer_load_dwordx4 v13, s[40:43], s81 offen offset:2048 lds
    v_mfma_f32_16x16x32_bf16 v[104:107], a[88:91], a[60:63], v[104:107]
    v_sub_f32 v66, v66, v54
    v_sub_f32 v67, v67, v54
    v_mfma_f32_16x16x32_bf16 v[108:111], a[88:91], a[64:67], v[108:111]
    ds_read_b128 a[4:7], v23 offset:22528
    v_mfma_f32_16x16x32_bf16 v[112:115], a[88:91], a[68:71], v[112:115]
    ds_read_b128 a[8:11], v23 offset:24576
    v_sub_f32_e64 v68, v68, v54
    v_mfma_f32_16x16x32_bf16 v[116:119], a[92:95], a[52:55], v[116:119]
    ds_read_b128 a[12:15], v23 offset:26624
    v_sub_f32_e64 v69, v69, v54
    v_mfma_f32_16x16x32_bf16 v[120:123], a[92:95], a[56:59], v[120:123]
    buffer_load_dwordx4 v14, s[40:43], s81 offen offset:3072 lds
    v_mfma_f32_16x16x32_bf16 v[124:127], a[92:95], a[60:63], v[124:127]
    ds_read_b128 a[16:19], v23 offset:28672
    v_sub_f32_e64 v70, v70, v54
    v_mfma_f32_16x16x32_bf16 v[128:131], a[92:95], a[64:67], v[128:131]
    ds_read_b64_tr_b16 a[36:37], v27 offset:49152
    v_sub_f32_e64 v71, v71, v54
    v_mfma_f32_16x16x32_bf16 v[132:135], a[92:95], a[68:71], v[132:135]
    v_sub_f32_e64 v72, v72, v54
    v_mfma_f32_16x16x32_bf16 v[136:139], a[96:99], a[52:55], v[136:139]
    ds_read_b64_tr_b16 a[38:39], v27 offset:49664
    v_mfma_f32_16x16x32_bf16 v[140:143], a[96:99], a[56:59], v[140:143]
    v_sub_f32_e64 v73, v73, v54
    v_mfma_f32_16x16x32_bf16 v[144:147], a[96:99], a[60:63], v[144:147]
L_pad8:
    s_cbranch_execz L_pad12
    s_nop 0
    ds_read_b64_tr_b16 a[40:41], v28 offset:49152
    s_bfe_u32 s92, s78, 262168
    v_sub_f32_e64 v74, v74, v54
    v_mfma_f32_16x16x32_bf16 v[148:151], a[96:99], a[64:67], v[148:151]
    ds_read_b64_tr_b16 a[42:43], v28 offset:49664
    v_sub_f32 v75, v75, v54
    s_lshl_b32 s80, s92, 7
    v_mfma_f32_16x16x32_bf16 v[152:155], a[96:99], a[68:71], v[152:155]
    ds_read_b64_tr_b16 a[44:45], v27 offset:57344
    v_mfma_f32_16x16x32_bf16 v[156:159], a[100:103], a[52:55], v[156:159]
    v_sub_f32_e64 v76, v76, v54
    s_add_u32 m0, s86, 98304
    v_mfma_f32_16x16x32_bf16 v[160:163], a[100:103], a[56:59], v[160:163]
    ds_read_b64_tr_b16 a[46:47], v27 offset:57856
    v_sub_f32_e64 v77, v77, v54
    v_mfma_f32_16x16x32_bf16 v[164:167], a[100:103], a[60:63], v[164:167]
    s_mov_b64 exec, s[90:91]
    buffer_load_dwordx4 v1, s[36:39], s80 offen offset:0 lds
    s_mov_b64 exec, -1
    v_mfma_f32_16x16x32_bf16 v[168:171], a[100:103], a[64:67], v[168:171]
    v_sub_f32_e64 v78, v78, v54
    v_mfma_f32_16x16x32_bf16 v[172:175], a[100:103], a[68:71], v[172:175]
    ds_read_b64_tr_b16 a[48:49], v28 offset:57344
    v_sub_f32_e64 v79, v79, v54
    v_mfma_f32_16x16x32_bf16 v[176:179], a[52:55], a[72:75], v[176:179]
    ds_read_b64_tr_b16 a[50:51], v28 offset:57856
    v_mul_f32_e64 v50, v60, v60
    v_mfma_f32_16x16x32_bf16 v[180:183], a[56:59], a[72:75], v[180:183]
    ds_read_b128 a[20:23], v25 offset:32768
    v_mfma_f32_16x16x32_bf16 v[184:187], a[60:63], a[72:75], v[184:187]
    v_fmac_f32_e64 v50, v61, v61
    v_mfma_f32_16x16x32_bf16 v[188:191], a[64:67], a[72:75], v[188:191]
    ds_read_b128 a[24:27], v25 offset:34816
    v_fmac_f32_e64 v50, v62, v62
    v_mfma_f32_16x16x32_bf16 v[192:195], a[68:71], a[72:75], v[192:195]
    buffer_load_dwordx4 v2, s[36:39], s80 offen offset:1024 lds
    v_mfma_f32_16x16x32_bf16 v[196:199], a[52:55], a[76:79], v[196:199]
    ds_read_b128 a[28:31], v25 offset:40960
    v_fmac_f32_e64 v50, v63, v63
    v_mfma_f32_16x16x32_bf16 v[200:203], a[56:59], a[76:79], v[200:203]
    v_fmac_f32_e64 v50, v64, v64
    v_mfma_f32_16x16x32_bf16 v[204:207], a[60:63], a[76:79], v[204:207]
    ds_read_b128 a[32:35], v25 offset:43008
    v_fmac_f32_e64 v50, v65, v65
    v_mfma_f32_16x16x32_bf16 v[208:211], a[64:67], a[76:79], v[208:211]
    v_mfma_f32_16x16x32_bf16 v[212:215], a[68:71], a[76:79], v[212:215]
    v_fmac_f32_e64 v50, v66, v66
    v_mfma_f32_16x16x32_bf16 v[216:219], a[52:55], a[80:83], v[216:219]
    buffer_load_dwordx4 v3, s[36:39], s80 offen offset:2048 lds
    v_mfma_f32_16x16x32_bf16 v[220:223], a[56:59], a[80:83], v[220:223]
    v_fmac_f32 v50, v67, v67
    v_fmac_f32 v50, v68, v68
    v_mfma_f32_16x16x32_bf16 v[224:227], a[60:63], a[80:83], v[224:227]
    v_mfma_f32_16x16x32_bf16 v[228:231], a[64:67], a[80:83], v[228:231]
    v_fmac_f32_e64 v50, v69, v69
    v_mfma_f32_16x16x32_bf16 v[232:235], a[68:71], a[80:83], v[232:235]
    v_fmac_f32_e64 v50, v70, v70
    v_mfma_f32_16x16x32_bf16 v[236:239], a[52:55], a[84:87], v[236:239]
    buffer_load_dwordx4 v4, s[36:39], s80 offen offset:3072 lds
    v_mfma_f32_16x16x32_bf16 v[240:243], a[56:59], a[84:87], v[240:243]
    v_fmac_f32_e64 v50, v71, v71
    v_mfma_f32_16x16x32_bf16 v[244:247], a[60:63], a[84:87], v[244:247]
    v_fmac_f32_e64 v50, v72, v72
    v_mfma_f32_16x16x32_bf16 v[248:251], a[64:67], a[84:87], v[248:251]
    v_fmac_f32_e64 v50, v73, v73
    v_mfma_f32_16x16x32_bf16 v[252:255], a[68:71], a[84:87], v[252:255]
    s_waitcnt lgkmcnt(0)
    v_mfma_f32_16x16x32_bf16 v[96:99], a[36:39], a[0:3], v[96:99]
    ds_read_b128 a[52:55], v24 offset:20480
    v_fmac_f32 v50, v74, v74
    v_mfma_f32_16x16x32_bf16 v[100:103], a[36:39], a[4:7], v[100:103]
    v_fmac_f32_e64 v50, v75, v75
    s_add_u32 m0, s86, 102400
    v_mfma_f32_16x16x32_bf16 v[104:107], a[36:39], a[8:11], v[104:107]
    ds_read_b128 a[56:59], v24 offset:22528
    v_fmac_f32_e64 v50, v76, v76
    v_mfma_f32_16x16x32_bf16 v[108:111], a[36:39], a[12:15], v[108:111]
    ds_read_b128 a[60:63], v24 offset:24576
    v_mfma_f32_16x16x32_bf16 v[112:115], a[36:39], a[16:19], v[112:115]
    buffer_load_dwordx4 v5, s[36:39], s80 offen offset:0 lds
    v_mfma_f32_16x16x32_bf16 v[116:119], a[40:43], a[0:3], v[116:119]
    v_fmac_f32 v50, v77, v77
    v_fmac_f32 v50, v78, v78
    v_mfma_f32_16x16x32_bf16 v[120:123], a[40:43], a[4:7], v[120:123]
    ds_read_b128 a[64:67], v24 offset:26624
    v_mfma_f32_16x16x32_bf16 v[124:127], a[40:43], a[8:11], v[124:127]
    ds_read_b128 a[68:71], v24 offset:28672
    v_fmac_f32_e64 v50, v79, v79
    v_mfma_f32_16x16x32_bf16 v[128:131], a[40:43], a[12:15], v[128:131]
    ds_read_b64_tr_b16 a[88:89], v27 offset:53248
    v_add_f32_dpp v50, v50, v50 quad_perm:[1,0,3,2] row_mask:0xf bank_mask:0xf
    v_mfma_f32_16x16x32_bf16 v[132:135], a[40:43], a[16:19], v[132:135]
    s_bfe_u32 s92, s78, 262168
    v_add_f32_dpp v50, v50, v50 quad_perm:[2,3,0,1] row_mask:0xf bank_mask:0xf
    v_mfma_f32_16x16x32_bf16 v[136:139], a[44:47], a[0:3], v[136:139]
    ds_read_b64_tr_b16 a[90:91], v27 offset:53760
    v_mfma_f32_16x16x32_bf16 v[140:143], a[44:47], a[4:7], v[140:143]
    v_add_f32_dpp v50, v50, v50 row_half_mirror row_mask:0xf bank_mask:0xf
    s_mul_i32 s81, s92, s83
    v_mfma_f32_16x16x32_bf16 v[144:147], a[44:47], a[8:11], v[144:147]
    ds_read_b64_tr_b16 a[92:93], v28 offset:53248
    v_add_f32_dpp v50, v50, v50 row_mirror row_mask:0xf bank_mask:0xf
    v_mfma_f32_16x16x32_bf16 v[148:151], a[44:47], a[12:15], v[148:151]
    s_add_u32 m0, s85, 0
    ds_read_b64_tr_b16 a[94:95], v28 offset:53760
    v_mov_b32_e64 v51, v50
    v_mfma_f32_16x16x32_bf16 v[152:155], a[44:47], a[16:19], v[152:155]
    ds_read_b64_tr_b16 a[96:97], v27 offset:61440
    v_mfma_f32_16x16x32_bf16 v[156:159], a[48:51], a[0:3], v[156:159]
    buffer_load_dwordx4 v11, s[40:43], s81 offen offset:0 lds
    v_mfma_f32_16x16x32_bf16 v[160:163], a[48:51], a[4:7], v[160:163]
    v_permlane16_swap_b32 v50, v51
    v_add_f32 v50, v50, v51
    v_mfma_f32_16x16x32_bf16 v[164:167], a[48:51], a[8:11], v[164:167]
    ds_read_b64_tr_b16 a[98:99], v27 offset:61952
    v_mfma_f32_16x16x32_bf16 v[168:171], a[48:51], a[12:15], v[168:171]
    ds_read_b64_tr_b16 a[100:101], v28 offset:61440
    v_mul_f32 v50, 0x3acccccd, v50
    v_mfma_f32_16x16x32_bf16 v[172:175], a[48:51], a[16:19], v[172:175]
    v_cvt_pk_bf16_f32 v50, v50, v50
    v_mfma_f32_16x16x32_bf16 v[176:179], a[0:3], a[20:23], v[176:179]
    ds_read_b64_tr_b16 a[102:103], v28 offset:61952
    v_lshlrev_b32_e64 v50, 16, v50
    v_mfma_f32_16x16x32_bf16 v[180:183], a[4:7], a[20:23], v[180:183]
    buffer_load_dwordx4 v12, s[40:43], s81 offen offset:1024 lds
    v_mfma_f32_16x16x32_bf16 v[184:187], a[8:11], a[20:23], v[184:187]
    ds_read_b128 a[72:75], v26 offset:32768
    v_add_f32 v50, 0x3727c5ac, v50
    v_mfma_f32_16x16x32_bf16 v[188:191], a[12:15], a[20:23], v[188:191]
    ds_read_b128 a[76:79], v26 offset:34816
    v_cvt_pk_bf16_f32 v50, v50, v50
    v_mfma_f32_16x16x32_bf16 v[192:195], a[16:19], a[20:23], v[192:195]
    ds_read_b128 a[80:83], v26 offset:40960
    v_mfma_f32_16x16x32_bf16 v[196:199], a[0:3], a[24:27], v[196:199]
    v_lshlrev_b32_e64 v50, 16, v50
    v_mfma_f32_16x16x32_bf16 v[200:203], a[4:7], a[24:27], v[200:203]
    ds_read_b128 a[84:87], v26 offset:43008
    v_mfma_f32_16x16x32_bf16 v[204:207], a[8:11], a[24:27], v[204:207]
    v_sqrt_f32_e64 v50, v50
    v_mfma_f32_16x16x32_bf16 v[208:211], a[12:15], a[24:27], v[208:211]
    buffer_load_dwordx4 v13, s[40:43], s81 offen offset:2048 lds
    v_mfma_f32_16x16x32_bf16 v[212:215], a[16:19], a[24:27], v[212:215]
    v_lshlrev_b32 v52, 3, v94
    v_mov_b32 v57, s72
    v_mfma_f32_16x16x32_bf16 v[216:219], a[0:3], a[28:31], v[216:219]
    v_lshlrev_b32_e64 v94, 2, v0
    v_mfma_f32_16x16x32_bf16 v[220:223], a[4:7], a[28:31], v[220:223]
    v_cvt_pk_bf16_f32 v56, v54, v50
    v_mfma_f32_16x16x32_bf16 v[224:227], a[8:11], a[28:31], v[224:227]
    buffer_load_dwordx4 v14, s[40:43], s81 offen offset:3072 lds
    v_mfma_f32_16x16x32_bf16 v[228:231], a[12:15], a[28:31], v[228:231]
    s_movk_i32 s93, 4096
    s_mov_b32 s94, 1
    v_mfma_f32_16x16x32_bf16 v[232:235], a[16:19], a[28:31], v[232:235]
    s_mov_b32 s95, 1
    v_mfma_f32_16x16x32_bf16 v[236:239], a[0:3], a[32:35], v[236:239]
    s_mov_b64 exec, s[94:95]
    buffer_store_dwordx2 v[56:57], v52, s[44:47], s93 offen sc1
    s_mov_b64 exec, -1
    v_mfma_f32_16x16x32_bf16 v[240:243], a[4:7], a[32:35], v[240:243]
    v_mfma_f32_16x16x32_bf16 v[244:247], a[8:11], a[32:35], v[244:247]
    v_mfma_f32_16x16x32_bf16 v[248:251], a[12:15], a[32:35], v[248:251]
    v_mfma_f32_16x16x32_bf16 v[252:255], a[16:19], a[32:35], v[252:255]
    s_waitcnt vmcnt(10) lgkmcnt(0)
    s_barrier
    v_mfma_f32_16x16x32_bf16 v[96:99], a[88:91], a[52:55], v[96:99]
    ds_read_b128 a[0:3], v23 offset:40960
    s_add_u32 s81, s81, s84
    v_mfma_f32_16x16x32_bf16 v[100:103], a[88:91], a[56:59], v[100:103]
    s_add_u32 m0, s85, 4096
    ds_read_b128 a[4:7], v23 offset:43008
    v_mfma_f32_16x16x32_bf16 v[104:107], a[88:91], a[60:63], v[104:107]
    v_mfma_f32_16x16x32_bf16 v[108:111], a[88:91], a[64:67], v[108:111]
    buffer_load_dwordx4 v11, s[40:43], s81 offen offset:0 lds
    v_mfma_f32_16x16x32_bf16 v[112:115], a[88:91], a[68:71], v[112:115]
    ds_read_b128 a[8:11], v23 offset:45056
    v_mfma_f32_16x16x32_bf16 v[116:119], a[92:95], a[52:55], v[116:119]
    ds_read_b128 a[12:15], v23 offset:47104
    v_mfma_f32_16x16x32_bf16 v[120:123], a[92:95], a[56:59], v[120:123]
    ds_read_b128 a[16:19], v23 offset:49152
    v_mfma_f32_16x16x32_bf16 v[124:127], a[92:95], a[60:63], v[124:127]
    v_mfma_f32_16x16x32_bf16 v[128:131], a[92:95], a[64:67], v[128:131]
    buffer_load_dwordx4 v12, s[40:43], s81 offen offset:1024 lds
    v_mfma_f32_16x16x32_bf16 v[132:135], a[92:95], a[68:71], v[132:135]
    ds_read_b64_tr_b16 a[36:37], v86 offset:16384
    v_mfma_f32_16x16x32_bf16 v[136:139], a[96:99], a[52:55], v[136:139]
    ds_read_b64_tr_b16 a[38:39], v86 offset:16896
    v_mfma_f32_16x16x32_bf16 v[140:143], a[96:99], a[56:59], v[140:143]
    ds_read_b64_tr_b16 a[40:41], v87 offset:16384
    v_mfma_f32_16x16x32_bf16 v[144:147], a[96:99], a[60:63], v[144:147]
    v_mfma_f32_16x16x32_bf16 v[148:151], a[96:99], a[64:67], v[148:151]
    buffer_load_dwordx4 v13, s[40:43], s81 offen offset:2048 lds
    v_mfma_f32_16x16x32_bf16 v[152:155], a[96:99], a[68:71], v[152:155]
    ds_read_b64_tr_b16 a[42:43], v87 offset:16896
    v_mfma_f32_16x16x32_bf16 v[156:159], a[100:103], a[52:55], v[156:159]
    ds_read_b64_tr_b16 a[44:45], v86 offset:24576
    v_mfma_f32_16x16x32_bf16 v[160:163], a[100:103], a[56:59], v[160:163]
    ds_read_b64_tr_b16 a[46:47], v86 offset:25088
    v_mfma_f32_16x16x32_bf16 v[164:167], a[100:103], a[60:63], v[164:167]
    v_mfma_f32_16x16x32_bf16 v[168:171], a[100:103], a[64:67], v[168:171]
    buffer_load_dwordx4 v14, s[40:43], s81 offen offset:3072 lds
    v_mfma_f32_16x16x32_bf16 v[172:175], a[100:103], a[68:71], v[172:175]
    ds_read_b64_tr_b16 a[48:49], v87 offset:24576
    v_mfma_f32_16x16x32_bf16 v[176:179], a[52:55], a[72:75], v[176:179]
    ds_read_b64_tr_b16 a[50:51], v87 offset:25088
    v_mfma_f32_16x16x32_bf16 v[180:183], a[56:59], a[72:75], v[180:183]
    ds_read_b128 a[20:23], v84 offset:0
    v_mfma_f32_16x16x32_bf16 v[184:187], a[60:63], a[72:75], v[184:187]
    v_mfma_f32_16x16x32_bf16 v[188:191], a[64:67], a[72:75], v[188:191]
    ds_read_b128 a[24:27], v84 offset:2048
    s_bfe_u32 s92, s78, 262172
    v_mfma_f32_16x16x32_bf16 v[192:195], a[68:71], a[72:75], v[192:195]
    s_lshl_b32 s80, s92, 7
    ds_read_b128 a[28:31], v84 offset:8192
    v_mfma_f32_16x16x32_bf16 v[196:199], a[52:55], a[76:79], v[196:199]
    v_mfma_f32_16x16x32_bf16 v[200:203], a[56:59], a[76:79], v[200:203]
    s_add_u32 m0, s86, 118784
    ds_read_b128 a[32:35], v84 offset:10240
    v_mfma_f32_16x16x32_bf16 v[204:207], a[60:63], a[76:79], v[204:207]
    s_mov_b64 exec, s[90:91]
    buffer_load_dwordx4 v1, s[36:39], s80 offen offset:0 lds
    s_mov_b64 exec, -1
    v_mfma_f32_16x16x32_bf16 v[208:211], a[64:67], a[76:79], v[208:211]
    v_mfma_f32_16x16x32_bf16 v[212:215], a[68:71], a[76:79], v[212:215]
    v_mfma_f32_16x16x32_bf16 v[216:219], a[52:55], a[80:83], v[216:219]
    v_mfma_f32_16x16x32_bf16 v[220:223], a[56:59], a[80:83], v[220:223]
    v_mfma_f32_16x16x32_bf16 v[224:227], a[60:63], a[80:83], v[224:227]
    buffer_load_dwordx4 v2, s[36:39], s80 offen offset:1024 lds
    v_mfma_f32_16x16x32_bf16 v[228:231], a[64:67], a[80:83], v[228:231]
    v_mfma_f32_16x16x32_bf16 v[232:235], a[68:71], a[80:83], v[232:235]
    v_mfma_f32_16x16x32_bf16 v[236:239], a[52:55], a[84:87], v[236:239]
    v_mfma_f32_16x16x32_bf16 v[240:243], a[56:59], a[84:87], v[240:243]
    v_mfma_f32_16x16x32_bf16 v[244:247], a[60:63], a[84:87], v[244:247]
    buffer_load_dwordx4 v3, s[36:39], s80 offen offset:2048 lds
    v_mfma_f32_16x16x32_bf16 v[248:251], a[64:67], a[84:87], v[248:251]
    v_mfma_f32_16x16x32_bf16 v[252:255], a[68:71], a[84:87], v[252:255]
    s_waitcnt lgkmcnt(0)
    v_mfma_f32_16x16x32_bf16 v[96:99], a[36:39], a[0:3], v[96:99]
    ds_read_b128 a[52:55], v24 offset:40960
    v_mfma_f32_16x16x32_bf16 v[100:103], a[36:39], a[4:7], v[100:103]
    ds_read_b128 a[56:59], v24 offset:43008
    v_mfma_f32_16x16x32_bf16 v[104:107], a[36:39], a[8:11], v[104:107]
    buffer_load_dwordx4 v4, s[36:39], s80 offen offset:3072 lds
    v_mfma_f32_16x16x32_bf16 v[108:111], a[36:39], a[12:15], v[108:111]
    ds_read_b128 a[60:63], v24 offset:45056
    v_mfma_f32_16x16x32_bf16 v[112:115], a[36:39], a[16:19], v[112:115]
    ds_read_b128 a[64:67], v24 offset:47104
    v_mfma_f32_16x16x32_bf16 v[116:119], a[40:43], a[0:3], v[116:119]
    v_mfma_f32_16x16x32_bf16 v[120:123], a[40:43], a[4:7], v[120:123]
    ds_read_b128 a[68:71], v24 offset:49152
    v_mfma_f32_16x16x32_bf16 v[124:127], a[40:43], a[8:11], v[124:127]
    s_add_u32 m0, s86, 122880
    v_mfma_f32_16x16x32_bf16 v[128:131], a[40:43], a[12:15], v[128:131]
    ds_read_b64_tr_b16 a[88:89], v86 offset:20480
    v_mfma_f32_16x16x32_bf16 v[132:135], a[40:43], a[16:19], v[132:135]
    buffer_load_dwordx4 v5, s[36:39], s80 offen offset:0 lds
    v_mfma_f32_16x16x32_bf16 v[136:139], a[44:47], a[0:3], v[136:139]
    ds_read_b64_tr_b16 a[90:91], v86 offset:20992
    v_mfma_f32_16x16x32_bf16 v[140:143], a[44:47], a[4:7], v[140:143]
    ds_read_b64_tr_b16 a[92:93], v87 offset:20480
    v_mfma_f32_16x16x32_bf16 v[144:147], a[44:47], a[8:11], v[144:147]
    v_mfma_f32_16x16x32_bf16 v[148:151], a[44:47], a[12:15], v[148:151]
    ds_read_b64_tr_b16 a[94:95], v87 offset:20992
    v_mfma_f32_16x16x32_bf16 v[152:155], a[44:47], a[16:19], v[152:155]
    s_bfe_u32 s92, s78, 262172
    ds_read_b64_tr_b16 a[96:97], v86 offset:28672
    v_mfma_f32_16x16x32_bf16 v[156:159], a[48:51], a[0:3], v[156:159]
    s_mul_i32 s81, s92, s83
    v_mfma_f32_16x16x32_bf16 v[160:163], a[48:51], a[4:7], v[160:163]
    ds_read_b64_tr_b16 a[98:99], v86 offset:29184
    v_mfma_f32_16x16x32_bf16 v[164:167], a[48:51], a[8:11], v[164:167]
    s_add_u32 m0, s85, 32768
    v_mfma_f32_16x16x32_bf16 v[168:171], a[48:51], a[12:15], v[168:171]
    ds_read_b64_tr_b16 a[100:101], v87 offset:28672
    v_mfma_f32_16x16x32_bf16 v[172:175], a[48:51], a[16:19], v[172:175]
    buffer_load_dwordx4 v11, s[40:43], s81 offen offset:0 lds
    v_mfma_f32_16x16x32_bf16 v[176:179], a[0:3], a[20:23], v[176:179]
    ds_read_b64_tr_b16 a[102:103], v87 offset:29184
    v_mfma_f32_16x16x32_bf16 v[180:183], a[4:7], a[20:23], v[180:183]
    ds_read_b128 a[72:75], v85 offset:0
    v_mfma_f32_16x16x32_bf16 v[184:187], a[8:11], a[20:23], v[184:187]
    v_mfma_f32_16x16x32_bf16 v[188:191], a[12:15], a[20:23], v[188:191]
    ds_read_b128 a[76:79], v85 offset:2048
    v_mfma_f32_16x16x32_bf16 v[192:195], a[16:19], a[20:23], v[192:195]
    buffer_load_dwordx4 v12, s[40:43], s81 offen offset:1024 lds
    v_mfma_f32_16x16x32_bf16 v[196:199], a[0:3], a[24:27], v[196:199]
    ds_read_b128 a[80:83], v85 offset:8192
    v_mfma_f32_16x16x32_bf16 v[200:203], a[4:7], a[24:27], v[200:203]
    ds_read_b128 a[84:87], v85 offset:10240
    v_mfma_f32_16x16x32_bf16 v[204:207], a[8:11], a[24:27], v[204:207]
    v_mfma_f32_16x16x32_bf16 v[208:211], a[12:15], a[24:27], v[208:211]
    buffer_load_dwordx4 v13, s[40:43], s81 offen offset:2048 lds
    v_mfma_f32_16x16x32_bf16 v[212:215], a[16:19], a[24:27], v[212:215]
    v_mfma_f32_16x16x32_bf16 v[216:219], a[0:3], a[28:31], v[216:219]
    v_mfma_f32_16x16x32_bf16 v[220:223], a[4:7], a[28:31], v[220:223]
    v_mfma_f32_16x16x32_bf16 v[224:227], a[8:11], a[28:31], v[224:227]
    v_mfma_f32_16x16x32_bf16 v[228:231], a[12:15], a[28:31], v[228:231]
    buffer_load_dwordx4 v14, s[40:43], s81 offen offset:3072 lds
    v_mfma_f32_16x16x32_bf16 v[232:235], a[16:19], a[28:31], v[232:235]
    v_mfma_f32_16x16x32_bf16 v[236:239], a[0:3], a[32:35], v[236:239]
    v_mfma_f32_16x16x32_bf16 v[240:243], a[4:7], a[32:35], v[240:243]
    v_mfma_f32_16x16x32_bf16 v[244:247], a[8:11], a[32:35], v[244:247]
    v_mfma_f32_16x16x32_bf16 v[248:251], a[12:15], a[32:35], v[248:251]
    v_mfma_f32_16x16x32_bf16 v[252:255], a[16:19], a[32:35], v[252:255]
    s_waitcnt vmcnt(9) lgkmcnt(0)
    s_barrier
    v_mfma_f32_16x16x32_bf16 v[96:99], a[88:91], a[52:55], v[96:99]
    ds_read_b128 a[0:3], v23 offset:0
    s_add_u32 s81, s81, s84
    v_mfma_f32_16x16x32_bf16 v[100:103], a[88:91], a[56:59], v[100:103]
    s_add_u32 m0, s85, 36864
    ds_read_b128 a[4:7], v23 offset:2048
    v_mfma_f32_16x16x32_bf16 v[104:107], a[88:91], a[60:63], v[104:107]
    buffer_load_dwordx4 v11, s[40:43], s81 offen offset:0 lds
    v_mfma_f32_16x16x32_bf16 v[108:111], a[88:91], a[64:67], v[108:111]
    ds_read_b128 a[8:11], v23 offset:4096
    v_mfma_f32_16x16x32_bf16 v[112:115], a[88:91], a[68:71], v[112:115]
    ds_read_b128 a[12:15], v23 offset:6144
    v_mfma_f32_16x16x32_bf16 v[116:119], a[92:95], a[52:55], v[116:119]
    v_mfma_f32_16x16x32_bf16 v[120:123], a[92:95], a[56:59], v[120:123]
    buffer_load_dwordx4 v12, s[40:43], s81 offen offset:1024 lds
    v_mfma_f32_16x16x32_bf16 v[124:127], a[92:95], a[60:63], v[124:127]
    ds_read_b128 a[16:19], v23 offset:8192
    v_mfma_f32_16x16x32_bf16 v[128:131], a[92:95], a[64:67], v[128:131]
    ds_read_b64_tr_b16 a[36:37], v27 offset:16384
    v_mfma_f32_16x16x32_bf16 v[132:135], a[92:95], a[68:71], v[132:135]
    ds_read_b64_tr_b16 a[38:39], v27 offset:16896
    v_mfma_f32_16x16x32_bf16 v[136:139], a[96:99], a[52:55], v[136:139]
    buffer_load_dwordx4 v13, s[40:43], s81 offen offset:2048 lds
    v_mfma_f32_16x16x32_bf16 v[140:143], a[96:99], a[56:59], v[140:143]
    ds_read_b64_tr_b16 a[40:41], v28 offset:16384
    v_mfma_f32_16x16x32_bf16 v[144:147], a[96:99], a[60:63], v[144:147]
    v_mfma_f32_16x16x32_bf16 v[148:151], a[96:99], a[64:67], v[148:151]
    ds_read_b64_tr_b16 a[42:43], v28 offset:16896
    v_mfma_f32_16x16x32_bf16 v[152:155], a[96:99], a[68:71], v[152:155]
    buffer_load_dwordx4 v14, s[40:43], s81 offen offset:3072 lds
    v_mfma_f32_16x16x32_bf16 v[156:159], a[100:103], a[52:55], v[156:159]
    ds_read_b64_tr_b16 a[44:45], v27 offset:24576
    v_mfma_f32_16x16x32_bf16 v[160:163], a[100:103], a[56:59], v[160:163]
    ds_read_b64_tr_b16 a[46:47], v27 offset:25088
    v_mfma_f32_16x16x32_bf16 v[164:167], a[100:103], a[60:63], v[164:167]
    s_bfe_u32 s92, s79, 262144
    v_mfma_f32_16x16x32_bf16 v[168:171], a[100:103], a[64:67], v[168:171]
    ds_read_b64_tr_b16 a[48:49], v28 offset:24576
    v_mfma_f32_16x16x32_bf16 v[172:175], a[100:103], a[68:71], v[172:175]
    s_lshl_b32 s80, s92, 7
    ds_read_b64_tr_b16 a[50:51], v28 offset:25088
    v_mfma_f32_16x16x32_bf16 v[176:179], a[52:55], a[72:75], v[176:179]
    s_add_u32 m0, s86, 139264
    v_mfma_f32_16x16x32_bf16 v[180:183], a[56:59], a[72:75], v[180:183]
    s_mov_b64 exec, s[90:91]
    buffer_load_dwordx4 v1, s[36:39], s80 offen offset:0 lds
    s_mov_b64 exec, -1
    v_mfma_f32_16x16x32_bf16 v[184:187], a[60:63], a[72:75], v[184:187]
    ds_read_b128 a[20:23], v25 offset:0
    v_mfma_f32_16x16x32_bf16 v[188:191], a[64:67], a[72:75], v[188:191]
    ds_read_b128 a[24:27], v25 offset:2048
    v_mfma_f32_16x16x32_bf16 v[192:195], a[68:71], a[72:75], v[192:195]
    ds_read_b128 a[28:31], v25 offset:8192
    v_mfma_f32_16x16x32_bf16 v[196:199], a[52:55], a[76:79], v[196:199]
    buffer_load_dwordx4 v2, s[36:39], s80 offen offset:1024 lds
    v_mfma_f32_16x16x32_bf16 v[200:203], a[56:59], a[76:79], v[200:203]
    ds_read_b128 a[32:35], v25 offset:10240
    v_mfma_f32_16x16x32_bf16 v[204:207], a[60:63], a[76:79], v[204:207]
    v_mfma_f32_16x16x32_bf16 v[208:211], a[64:67], a[76:79], v[208:211]
    v_mfma_f32_16x16x32_bf16 v[212:215], a[68:71], a[76:79], v[212:215]
    buffer_load_dwordx4 v3, s[36:39], s80 offen offset:2048 lds
    v_mfma_f32_16x16x32_bf16 v[216:219], a[52:55], a[80:83], v[216:219]
    v_mfma_f32_16x16x32_bf16 v[220:223], a[56:59], a[80:83], v[220:223]
    v_mfma_f32_16x16x32_bf16 v[224:227], a[60:63], a[80:83], v[224:227]
    v_mfma_f32_16x16x32_bf16 v[228:231], a[64:67], a[80:83], v[228:231]
    buffer_load_dwordx4 v4, s[36:39], s80 offen offset:3072 lds
    v_mfma_f32_16x16x32_bf16 v[232:235], a[68:71], a[80:83], v[232:235]
    v_mfma_f32_16x16x32_bf16 v[236:239], a[52:55], a[84:87], v[236:239]
    v_mfma_f32_16x16x32_bf16 v[240:243], a[56:59], a[84:87], v[240:243]
    s_add_u32 m0, s86, 143360
    v_mfma_f32_16x16x32_bf16 v[244:247], a[60:63], a[84:87], v[244:247]
    v_mfma_f32_16x16x32_bf16 v[248:251], a[64:67], a[84:87], v[248:251]
    buffer_load_dwordx4 v5, s[36:39], s80 offen offset:0 lds
    v_mfma_f32_16x16x32_bf16 v[252:255], a[68:71], a[84:87], v[252:255]
    s_waitcnt lgkmcnt(0)
    v_mfma_f32_16x16x32_bf16 v[96:99], a[36:39], a[0:3], v[96:99]
    ds_read_b128 a[52:55], v24 offset:0
    v_mfma_f32_16x16x32_bf16 v[100:103], a[36:39], a[4:7], v[100:103]
    ds_read_b128 a[56:59], v24 offset:2048
    v_mfma_f32_16x16x32_bf16 v[104:107], a[36:39], a[8:11], v[104:107]
    s_bfe_u32 s92, s79, 262144
    v_mfma_f32_16x16x32_bf16 v[108:111], a[36:39], a[12:15], v[108:111]
    s_mul_i32 s81, s92, s83
    ds_read_b128 a[60:63], v24 offset:4096
    v_mfma_f32_16x16x32_bf16 v[112:115], a[36:39], a[16:19], v[112:115]
    s_add_u32 m0, s85, 65536
    ds_read_b128 a[64:67], v24 offset:6144
    v_mfma_f32_16x16x32_bf16 v[116:119], a[40:43], a[0:3], v[116:119]
    buffer_load_dwordx4 v11, s[40:43], s81 offen offset:0 lds
    v_mfma_f32_16x16x32_bf16 v[120:123], a[40:43], a[4:7], v[120:123]
    ds_read_b128 a[68:71], v24 offset:8192
    v_mfma_f32_16x16x32_bf16 v[124:127], a[40:43], a[8:11], v[124:127]
    v_mfma_f32_16x16x32_bf16 v[128:131], a[40:43], a[12:15], v[128:131]
    ds_read_b64_tr_b16 a[88:89], v27 offset:20480
    v_mfma_f32_16x16x32_bf16 v[132:135], a[40:43], a[16:19], v[132:135]
    buffer_load_dwordx4 v12, s[40:43], s81 offen offset:1024 lds
    v_mfma_f32_16x16x32_bf16 v[136:139], a[44:47], a[0:3], v[136:139]
    ds_read_b64_tr_b16 a[90:91], v27 offset:20992
    v_mfma_f32_16x16x32_bf16 v[140:143], a[44:47], a[4:7], v[140:143]
    ds_read_b64_tr_b16 a[92:93], v28 offset:20480
    v_mfma_f32_16x16x32_bf16 v[144:147], a[44:47], a[8:11], v[144:147]
    v_mfma_f32_16x16x32_bf16 v[148:151], a[44:47], a[12:15], v[148:151]
    ds_read_b64_tr_b16 a[94:95], v28 offset:20992
    v_mfma_f32_16x16x32_bf16 v[152:155], a[44:47], a[16:19], v[152:155]
    buffer_load_dwordx4 v13, s[40:43], s81 offen offset:2048 lds
    v_mfma_f32_16x16x32_bf16 v[156:159], a[48:51], a[0:3], v[156:159]
    ds_read_b64_tr_b16 a[96:97], v27 offset:28672
    v_mfma_f32_16x16x32_bf16 v[160:163], a[48:51], a[4:7], v[160:163]
    ds_read_b64_tr_b16 a[98:99], v27 offset:29184
    v_mfma_f32_16x16x32_bf16 v[164:167], a[48:51], a[8:11], v[164:167]
    buffer_load_dwordx4 v14, s[40:43], s81 offen offset:3072 lds
    v_mfma_f32_16x16x32_bf16 v[168:171], a[48:51], a[12:15], v[168:171]
    ds_read_b64_tr_b16 a[100:101], v28 offset:28672
    v_mfma_f32_16x16x32_bf16 v[172:175], a[48:51], a[16:19], v[172:175]
    ds_read_b64_tr_b16 a[102:103], v28 offset:29184
    v_mfma_f32_16x16x32_bf16 v[176:179], a[0:3], a[20:23], v[176:179]
    v_mfma_f32_16x16x32_bf16 v[180:183], a[4:7], a[20:23], v[180:183]
    s_add_u32 s81, s81, s84
    ds_read_b128 a[72:75], v26 offset:0
    v_mfma_f32_16x16x32_bf16 v[184:187], a[8:11], a[20:23], v[184:187]
    s_add_u32 m0, s85, 69632
    v_mfma_f32_16x16x32_bf16 v[188:191], a[12:15], a[20:23], v[188:191]
    ds_read_b128 a[76:79], v26 offset:2048
    v_mfma_f32_16x16x32_bf16 v[192:195], a[16:19], a[20:23], v[192:195]
    buffer_load_dwordx4 v11, s[40:43], s81 offen offset:0 lds
    v_mfma_f32_16x16x32_bf16 v[196:199], a[0:3], a[24:27], v[196:199]
    ds_read_b128 a[80:83], v26 offset:8192
    v_mfma_f32_16x16x32_bf16 v[200:203], a[4:7], a[24:27], v[200:203]
    ds_read_b128 a[84:87], v26 offset:10240
    v_mfma_f32_16x16x32_bf16 v[204:207], a[8:11], a[24:27], v[204:207]
    buffer_load_dwordx4 v12, s[40:43], s81 offen offset:1024 lds
    v_mfma_f32_16x16x32_bf16 v[208:211], a[12:15], a[24:27], v[208:211]
    v_mfma_f32_16x16x32_bf16 v[212:215], a[16:19], a[24:27], v[212:215]
    v_mfma_f32_16x16x32_bf16 v[216:219], a[0:3], a[28:31], v[216:219]
    v_mfma_f32_16x16x32_bf16 v[220:223], a[4:7], a[28:31], v[220:223]
    buffer_load_dwordx4 v13, s[40:43], s81 offen offset:2048 lds
    v_mfma_f32_16x16x32_bf16 v[224:227], a[8:11], a[28:31], v[224:227]
    v_mfma_f32_16x16x32_bf16 v[228:231], a[12:15], a[28:31], v[228:231]
    v_mfma_f32_16x16x32_bf16 v[232:235], a[16:19], a[28:31], v[232:235]
    v_mfma_f32_16x16x32_bf16 v[236:239], a[0:3], a[32:35], v[236:239]
    buffer_load_dwordx4 v14, s[40:43], s81 offen offset:3072 lds
    v_mfma_f32_16x16x32_bf16 v[240:243], a[4:7], a[32:35], v[240:243]
    v_mfma_f32_16x16x32_bf16 v[244:247], a[8:11], a[32:35], v[244:247]
    v_mfma_f32_16x16x32_bf16 v[248:251], a[12:15], a[32:35], v[248:251]
    v_mfma_f32_16x16x32_bf16 v[252:255], a[16:19], a[32:35], v[252:255]
    s_waitcnt vmcnt(13) lgkmcnt(0)
    s_barrier
    v_mfma_f32_16x16x32_bf16 v[96:99], a[88:91], a[52:55], v[96:99]
    ds_read_b128 a[0:3], v23 offset:20480
    s_bfe_u32 s92, s79, 262148
    v_and_b32_e64 v55, 15, v0
    v_mfma_f32_16x16x32_bf16 v[100:103], a[88:91], a[56:59], v[100:103]
    s_lshl_b32 s80, s92, 7
    ds_read_b128 a[4:7], v23 offset:22528
    v_mfma_f32_16x16x32_bf16 v[104:107], a[88:91], a[60:63], v[104:107]
    s_add_u32 m0, s86, 98304
    s_lshl_b32 s88, s71, 7
    v_mfma_f32_16x16x32_bf16 v[108:111], a[88:91], a[64:67], v[108:111]
    ds_read_b128 a[8:11], v23 offset:24576
    v_lshl_add_u32 v54, v55, 3, s88
    v_mfma_f32_16x16x32_bf16 v[112:115], a[88:91], a[68:71], v[112:115]
    s_mov_b64 exec, s[90:91]
    buffer_load_dwordx4 v1, s[36:39], s80 offen offset:0 lds
    s_mov_b64 exec, -1
    v_mfma_f32_16x16x32_bf16 v[116:119], a[92:95], a[52:55], v[116:119]
    ds_read_b128 a[12:15], v23 offset:26624
    v_mfma_f32_16x16x32_bf16 v[120:123], a[92:95], a[56:59], v[120:123]
    v_mul_u32_u24_e64 v55, 20, v95
    v_mfma_f32_16x16x32_bf16 v[124:127], a[92:95], a[60:63], v[124:127]
    ds_read_b128 a[16:19], v23 offset:28672
    v_mfma_f32_16x16x32_bf16 v[128:131], a[92:95], a[64:67], v[128:131]
    ds_read_b64_tr_b16 a[36:37], v27 offset:49152
    v_mfma_f32_16x16x32_bf16 v[132:135], a[92:95], a[68:71], v[132:135]
    buffer_load_dwordx4 v2, s[36:39], s80 offen offset:1024 lds
    v_mfma_f32_16x16x32_bf16 v[136:139], a[96:99], a[52:55], v[136:139]
    s_mul_i32 s88, s70, 79
    ds_read_b64_tr_b16 a[38:39], v27 offset:49664
    s_add_u32 s88, s88, s64
    v_mfma_f32_16x16x32_bf16 v[140:143], a[96:99], a[56:59], v[140:143]
    v_mov_b32 v56, v55
    v_mfma_f32_16x16x32_bf16 v[144:147], a[96:99], a[60:63], v[144:147]
    ds_read_b64_tr_b16 a[40:41], v28 offset:49152
    v_mfma_f32_16x16x32_bf16 v[148:151], a[96:99], a[64:67], v[148:151]
    buffer_load_dwordx4 v3, s[36:39], s80 offen offset:2048 lds
    v_mfma_f32_16x16x32_bf16 v[152:155], a[96:99], a[68:71], v[152:155]
    ds_read_b64_tr_b16 a[42:43], v28 offset:49664
    v_add_u32_e64 v55, s88, v55
    v_mfma_f32_16x16x32_bf16 v[156:159], a[100:103], a[52:55], v[156:159]
    ds_read_b64_tr_b16 a[44:45], v27 offset:57344
    v_mfma_f32_16x16x32_bf16 v[160:163], a[100:103], a[56:59], v[160:163]
    ds_read_b64_tr_b16 a[46:47], v27 offset:57856
    s_lshl_b32 s88, s82, 2
    v_mfma_f32_16x16x32_bf16 v[164:167], a[100:103], a[60:63], v[164:167]
    buffer_load_dwordx4 v4, s[36:39], s80 offen offset:3072 lds
    v_mfma_f32_16x16x32_bf16 v[168:171], a[100:103], a[64:67], v[168:171]
    s_add_u32 s88, s88, s64
    ds_read_b64_tr_b16 a[48:49], v28 offset:57344
    s_add_u32 s88, s88, 1975
    v_mfma_f32_16x16x32_bf16 v[172:175], a[100:103], a[68:71], v[172:175]
    v_add_u32_e64 v56, s88, v56
    v_mfma_f32_16x16x32_bf16 v[176:179], a[52:55], a[72:75], v[176:179]
    ds_read_b64_tr_b16 a[50:51], v28 offset:57856
    v_mfma_f32_16x16x32_bf16 v[180:183], a[56:59], a[72:75], v[180:183]
    ds_read_b128 a[20:23], v25 offset:32768
    s_add_u32 m0, s86, 102400
    v_mfma_f32_16x16x32_bf16 v[184:187], a[60:63], a[72:75], v[184:187]
    v_mov_b32 v57, 1280
    v_mfma_f32_16x16x32_bf16 v[188:191], a[64:67], a[72:75], v[188:191]
    ds_read_b128 a[24:27], v25 offset:34816
    v_mfma_f32_16x16x32_bf16 v[192:195], a[68:71], a[72:75], v[192:195]
    buffer_load_dwordx4 v5, s[36:39], s80 offen offset:0 lds
    v_mfma_f32_16x16x32_bf16 v[196:199], a[52:55], a[76:79], v[196:199]
    ds_read_b128 a[28:31], v25 offset:40960
    v_mad_u32_u24 v50, v55, v57, v54
    v_mfma_f32_16x16x32_bf16 v[200:203], a[56:59], a[76:79], v[200:203]
    ds_read_b128 a[32:35], v25 offset:43008
    v_mfma_f32_16x16x32_bf16 v[204:207], a[60:63], a[76:79], v[204:207]
    s_bfe_u32 s92, s79, 262148
    v_mad_u32_u24 v51, v56, v57, v54
    v_mfma_f32_16x16x32_bf16 v[208:211], a[64:67], a[76:79], v[208:211]
    s_mul_i32 s81, s92, s83
    v_mfma_f32_16x16x32_bf16 v[212:215], a[68:71], a[76:79], v[212:215]
    v_mfma_f32_16x16x32_bf16 v[216:219], a[52:55], a[80:83], v[216:219]
    s_add_u32 m0, s85, 0
    s_movk_i32 s88, 4088
    v_mfma_f32_16x16x32_bf16 v[220:223], a[56:59], a[80:83], v[220:223]
    v_lshl_add_u32 v52, v55, 3, s88
    v_mfma_f32_16x16x32_bf16 v[224:227], a[60:63], a[80:83], v[224:227]
    buffer_load_dwordx4 v11, s[40:43], s81 offen offset:0 lds
    v_mfma_f32_16x16x32_bf16 v[228:231], a[64:67], a[80:83], v[228:231]
    v_mfma_f32_16x16x32_bf16 v[232:235], a[68:71], a[80:83], v[232:235]
L_pad9:
    s_cbranch_execz L_pad13
    s_nop 0
    v_lshl_add_u32 v53, v56, 3, s88
    v_mfma_f32_16x16x32_bf16 v[236:239], a[52:55], a[84:87], v[236:239]
    v_mfma_f32_16x16x32_bf16 v[240:243], a[56:59], a[84:87], v[240:243]
    buffer_load_dwordx4 v12, s[40:43], s81 offen offset:1024 lds
    v_mfma_f32_16x16x32_bf16 v[244:247], a[60:63], a[84:87], v[244:247]
    v_max_u32 v55, v57, v50
    v_mfma_f32_16x16x32_bf16 v[248:251], a[64:67], a[84:87], v[248:251]
    v_mfma_f32_16x16x32_bf16 v[252:255], a[68:71], a[84:87], v[252:255]
    v_min_u32 v53, 20472, v53
    s_waitcnt lgkmcnt(0)
    v_mfma_f32_16x16x32_bf16 v[96:99], a[36:39], a[0:3], v[96:99]
    ds_read_b128 a[52:55], v24 offset:20480
    v_mfma_f32_16x16x32_bf16 v[100:103], a[36:39], a[4:7], v[100:103]
    buffer_load_dwordx4 v13, s[40:43], s81 offen offset:2048 lds
    v_mfma_f32_16x16x32_bf16 v[104:107], a[36:39], a[8:11], v[104:107]
    ds_read_b128 a[56:59], v24 offset:22528
    v_max_u32 v56, 4096, v52
    v_mfma_f32_16x16x32_bf16 v[108:111], a[36:39], a[12:15], v[108:111]
    ds_read_b128 a[60:63], v24 offset:24576
    v_mfma_f32_16x16x32_bf16 v[112:115], a[36:39], a[16:19], v[112:115]
    ds_read_b128 a[64:67], v24 offset:26624
    v_mfma_f32_16x16x32_bf16 v[116:119], a[40:43], a[0:3], v[116:119]
    buffer_load_dwordx4 v14, s[40:43], s81 offen offset:3072 lds
    v_mfma_f32_16x16x32_bf16 v[120:123], a[40:43], a[4:7], v[120:123]
    v_accvgpr_write_b32 a250, v52
    v_mfma_f32_16x16x32_bf16 v[124:127], a[40:43], a[8:11], v[124:127]
    ds_read_b128 a[68:71], v24 offset:28672
    v_mfma_f32_16x16x32_bf16 v[128:131], a[40:43], a[12:15], v[128:131]
    ds_read_b64_tr_b16 a[88:89], v27 offset:53248
    v_accvgpr_write_b32 a251, v53
    v_mfma_f32_16x16x32_bf16 v[132:135], a[40:43], a[16:19], v[132:135]
    s_add_u32 s81, s81, s84
    ds_read_b64_tr_b16 a[90:91], v27 offset:53760
    v_mfma_f32_16x16x32_bf16 v[136:139], a[44:47], a[0:3], v[136:139]
    s_add_u32 m0, s85, 4096
    v_mfma_f32_16x16x32_bf16 v[140:143], a[44:47], a[4:7], v[140:143]
    v_accvgpr_write_b32 a252, v56
    v_mfma_f32_16x16x32_bf16 v[144:147], a[44:47], a[8:11], v[144:147]
    ds_read_b64_tr_b16 a[92:93], v28 offset:53248
    v_mfma_f32_16x16x32_bf16 v[148:151], a[44:47], a[12:15], v[148:151]
    buffer_load_dwordx4 v11, s[40:43], s81 offen offset:0 lds
    v_mfma_f32_16x16x32_bf16 v[152:155], a[44:47], a[16:19], v[152:155]
    ds_read_b64_tr_b16 a[94:95], v28 offset:53760
    v_mfma_f32_16x16x32_bf16 v[156:159], a[48:51], a[0:3], v[156:159]
    buffer_load_dwordx2 a[248:249], v54, s[56:59], 0 offen
    v_mfma_f32_16x16x32_bf16 v[160:163], a[48:51], a[4:7], v[160:163]
    ds_read_b64_tr_b16 a[96:97], v27 offset:61440
    s_movk_i32 s88, 0
    v_mfma_f32_16x16x32_bf16 v[164:167], a[48:51], a[8:11], v[164:167]
    ds_read_b64_tr_b16 a[98:99], v27 offset:61952
    v_mfma_f32_16x16x32_bf16 v[168:171], a[48:51], a[12:15], v[168:171]
    buffer_load_dwordx4 v12, s[40:43], s81 offen offset:1024 lds
    v_mfma_f32_16x16x32_bf16 v[172:175], a[48:51], a[16:19], v[172:175]
    buffer_load_dwordx2 a[104:105], v55, s[60:63], s88 offen
    v_mfma_f32_16x16x32_bf16 v[176:179], a[0:3], a[20:23], v[176:179]
    ds_read_b64_tr_b16 a[100:101], v28 offset:61440
    s_movk_i32 s88, 5120
    v_mfma_f32_16x16x32_bf16 v[180:183], a[4:7], a[20:23], v[180:183]
    ds_read_b64_tr_b16 a[102:103], v28 offset:61952
    v_mfma_f32_16x16x32_bf16 v[184:187], a[8:11], a[20:23], v[184:187]
    buffer_load_dwordx4 v13, s[40:43], s81 offen offset:2048 lds
    v_mfma_f32_16x16x32_bf16 v[188:191], a[12:15], a[20:23], v[188:191]
    ds_read_b128 a[72:75], v26 offset:32768
    v_mfma_f32_16x16x32_bf16 v[192:195], a[16:19], a[20:23], v[192:195]
    buffer_load_dwordx2 a[106:107], v50, s[60:63], s88 offen
    v_mfma_f32_16x16x32_bf16 v[196:199], a[0:3], a[24:27], v[196:199]
    ds_read_b128 a[76:79], v26 offset:34816
    s_movk_i32 s88, 10240
    v_mfma_f32_16x16x32_bf16 v[200:203], a[4:7], a[24:27], v[200:203]
    ds_read_b128 a[80:83], v26 offset:40960
    v_mfma_f32_16x16x32_bf16 v[204:207], a[8:11], a[24:27], v[204:207]
    buffer_load_dwordx2 a[108:109], v50, s[60:63], s88 offen
    v_mfma_f32_16x16x32_bf16 v[208:211], a[12:15], a[24:27], v[208:211]
    buffer_load_dwordx4 v14, s[40:43], s81 offen offset:3072 lds
    v_mfma_f32_16x16x32_bf16 v[212:215], a[16:19], a[24:27], v[212:215]
    ds_read_b128 a[84:87], v26 offset:43008
    s_movk_i32 s88, 15360
    v_mfma_f32_16x16x32_bf16 v[216:219], a[0:3], a[28:31], v[216:219]
    buffer_load_dwordx2 a[110:111], v50, s[60:63], s88 offen
    v_mfma_f32_16x16x32_bf16 v[220:223], a[4:7], a[28:31], v[220:223]
    s_movk_i32 s88, 20480
    v_mfma_f32_16x16x32_bf16 v[224:227], a[8:11], a[28:31], v[224:227]
    buffer_load_dwordx2 a[112:113], v50, s[60:63], s88 offen
    v_mfma_f32_16x16x32_bf16 v[228:231], a[12:15], a[28:31], v[228:231]
    v_mfma_f32_16x16x32_bf16 v[232:235], a[16:19], a[28:31], v[232:235]
    v_mfma_f32_16x16x32_bf16 v[236:239], a[0:3], a[32:35], v[236:239]
    s_movk_i32 s88, 0
    v_mfma_f32_16x16x32_bf16 v[240:243], a[4:7], a[32:35], v[240:243]
    buffer_load_dwordx2 a[114:115], v51, s[60:63], s88 offen
    v_mfma_f32_16x16x32_bf16 v[244:247], a[8:11], a[32:35], v[244:247]
    v_mfma_f32_16x16x32_bf16 v[248:251], a[12:15], a[32:35], v[248:251]
    v_mfma_f32_16x16x32_bf16 v[252:255], a[16:19], a[32:35], v[252:255]
    s_waitcnt vmcnt(20) lgkmcnt(0)
    s_barrier
    v_mfma_f32_16x16x32_bf16 v[96:99], a[88:91], a[52:55], v[96:99]
    ds_read_b128 a[0:3], v23 offset:40960
    v_readlane_b32 s81, v90, 0
    v_mfma_f32_16x16x32_bf16 v[100:103], a[88:91], a[56:59], v[100:103]
    ds_read_b128 a[4:7], v23 offset:43008
    v_mfma_f32_16x16x32_bf16 v[104:107], a[88:91], a[60:63], v[104:107]
    s_add_u32 m0, s85, 32768
    v_mfma_f32_16x16x32_bf16 v[108:111], a[88:91], a[64:67], v[108:111]
    ds_read_b128 a[8:11], v23 offset:45056
    v_mfma_f32_16x16x32_bf16 v[112:115], a[88:91], a[68:71], v[112:115]
    buffer_load_dwordx4 v15, s[96:99], s81 offen offset:0 lds
    v_mfma_f32_16x16x32_bf16 v[116:119], a[92:95], a[52:55], v[116:119]
    ds_read_b128 a[12:15], v23 offset:47104
    v_mfma_f32_16x16x32_bf16 v[120:123], a[92:95], a[56:59], v[120:123]
    ds_read_b128 a[16:19], v23 offset:49152
    v_mfma_f32_16x16x32_bf16 v[124:127], a[92:95], a[60:63], v[124:127]
    buffer_load_dwordx4 v16, s[96:99], s81 offen offset:1024 lds
    v_mfma_f32_16x16x32_bf16 v[128:131], a[92:95], a[64:67], v[128:131]
    ds_read_b64_tr_b16 a[36:37], v86 offset:16384
    v_mfma_f32_16x16x32_bf16 v[132:135], a[92:95], a[68:71], v[132:135]
    buffer_load_dwordx4 v17, s[96:99], s81 offen offset:2048 lds
    v_mfma_f32_16x16x32_bf16 v[136:139], a[96:99], a[52:55], v[136:139]
    ds_read_b64_tr_b16 a[38:39], v86 offset:16896
    v_mfma_f32_16x16x32_bf16 v[140:143], a[96:99], a[56:59], v[140:143]
    ds_read_b64_tr_b16 a[40:41], v87 offset:16384
    v_mfma_f32_16x16x32_bf16 v[144:147], a[96:99], a[60:63], v[144:147]
    buffer_load_dwordx4 v18, s[96:99], s81 offen offset:3072 lds
    v_mfma_f32_16x16x32_bf16 v[148:151], a[96:99], a[64:67], v[148:151]
    ds_read_b64_tr_b16 a[42:43], v87 offset:16896
    v_mfma_f32_16x16x32_bf16 v[152:155], a[96:99], a[68:71], v[152:155]
    ds_read_b64_tr_b16 a[44:45], v86 offset:24576
    v_mfma_f32_16x16x32_bf16 v[156:159], a[100:103], a[52:55], v[156:159]
    v_readlane_b32 s81, v90, 16
    v_mfma_f32_16x16x32_bf16 v[160:163], a[100:103], a[56:59], v[160:163]
    ds_read_b64_tr_b16 a[46:47], v86 offset:25088
    v_mfma_f32_16x16x32_bf16 v[164:167], a[100:103], a[60:63], v[164:167]
    v_mfma_f32_16x16x32_bf16 v[168:171], a[100:103], a[64:67], v[168:171]
    s_add_u32 m0, s85, 36864
    ds_read_b64_tr_b16 a[48:49], v87 offset:24576
    v_mfma_f32_16x16x32_bf16 v[172:175], a[100:103], a[68:71], v[172:175]
    buffer_load_dwordx4 v15, s[96:99], s81 offen offset:0 lds
    v_mfma_f32_16x16x32_bf16 v[176:179], a[52:55], a[72:75], v[176:179]
    ds_read_b64_tr_b16 a[50:51], v87 offset:25088
    v_mfma_f32_16x16x32_bf16 v[180:183], a[56:59], a[72:75], v[180:183]
    ds_read_b128 a[20:23], v84 offset:0
    v_mfma_f32_16x16x32_bf16 v[184:187], a[60:63], a[72:75], v[184:187]
    buffer_load_dwordx4 v16, s[96:99], s81 offen offset:1024 lds
    v_mfma_f32_16x16x32_bf16 v[188:191], a[64:67], a[72:75], v[188:191]
    ds_read_b128 a[24:27], v84 offset:2048
    v_mfma_f32_16x16x32_bf16 v[192:195], a[68:71], a[72:75], v[192:195]
    buffer_load_dwordx4 v17, s[96:99], s81 offen offset:2048 lds
    v_mfma_f32_16x16x32_bf16 v[196:199], a[52:55], a[76:79], v[196:199]
    ds_read_b128 a[28:31], v84 offset:8192
    v_mfma_f32_16x16x32_bf16 v[200:203], a[56:59], a[76:79], v[200:203]
    ds_read_b128 a[32:35], v84 offset:10240
    v_mfma_f32_16x16x32_bf16 v[204:207], a[60:63], a[76:79], v[204:207]
    buffer_load_dwordx4 v18, s[96:99], s81 offen offset:3072 lds
    v_mfma_f32_16x16x32_bf16 v[208:211], a[64:67], a[76:79], v[208:211]
    v_mfma_f32_16x16x32_bf16 v[212:215], a[68:71], a[76:79], v[212:215]
    v_mfma_f32_16x16x32_bf16 v[216:219], a[52:55], a[80:83], v[216:219]
    s_movk_i32 s87, 4096
    v_mfma_f32_16x16x32_bf16 v[220:223], a[56:59], a[80:83], v[220:223]
    s_lshl_b32 s93, s68, 1
    v_mfma_f32_16x16x32_bf16 v[224:227], a[60:63], a[80:83], v[224:227]
    s_add_u32 s93, s93, s66
    v_mfma_f32_16x16x32_bf16 v[228:231], a[64:67], a[80:83], v[228:231]
    s_mul_i32 s94, s93, 6144
    s_add_u32 s94, s94, 724992
    v_mfma_f32_16x16x32_bf16 v[232:235], a[68:71], a[80:83], v[232:235]
    s_add_u32 s95, s94, 4096
    v_mfma_f32_16x16x32_bf16 v[236:239], a[52:55], a[84:87], v[236:239]
    s_lshl_b32 s93, s93, 7
    v_mfma_f32_16x16x32_bf16 v[240:243], a[56:59], a[84:87], v[240:243]
    s_add_u32 s93, s93, 720896
    v_mfma_f32_16x16x32_bf16 v[244:247], a[60:63], a[84:87], v[244:247]
    v_lshlrev_b32_e64 v68, 4, v0
    v_mfma_f32_16x16x32_bf16 v[248:251], a[64:67], a[84:87], v[248:251]
    v_mfma_f32_16x16x32_bf16 v[252:255], a[68:71], a[84:87], v[252:255]
    s_waitcnt lgkmcnt(0)
    v_mfma_f32_16x16x32_bf16 v[96:99], a[36:39], a[0:3], v[96:99]
    ds_read_b128 a[52:55], v24 offset:40960
    v_mfma_f32_16x16x32_bf16 v[100:103], a[36:39], a[4:7], v[100:103]
    buffer_load_dwordx2 v[30:31], v33, s[44:47], s87 offen sc1
    v_mfma_f32_16x16x32_bf16 v[104:107], a[36:39], a[8:11], v[104:107]
    ds_read_b128 a[56:59], v24 offset:43008
    v_mfma_f32_16x16x32_bf16 v[108:111], a[36:39], a[12:15], v[108:111]
    buffer_load_dwordx2 v[34:35], v37, s[44:47], s87 offen sc1
    v_mfma_f32_16x16x32_bf16 v[112:115], a[36:39], a[16:19], v[112:115]
    ds_read_b128 a[60:63], v24 offset:45056
    v_mfma_f32_16x16x32_bf16 v[116:119], a[40:43], a[0:3], v[116:119]
    ds_read_b128 a[64:67], v24 offset:47104
    v_mfma_f32_16x16x32_bf16 v[120:123], a[40:43], a[4:7], v[120:123]
    buffer_load_dwordx2 v[38:39], v41, s[44:47], s87 offen sc1
    v_mfma_f32_16x16x32_bf16 v[124:127], a[40:43], a[8:11], v[124:127]
    ds_read_b128 a[68:71], v24 offset:49152
    v_mfma_f32_16x16x32_bf16 v[128:131], a[40:43], a[12:15], v[128:131]
    ds_read_b64_tr_b16 a[88:89], v86 offset:20480
    v_mfma_f32_16x16x32_bf16 v[132:135], a[40:43], a[16:19], v[132:135]
    buffer_load_dwordx2 v[42:43], v45, s[44:47], s87 offen sc1
    v_mfma_f32_16x16x32_bf16 v[136:139], a[44:47], a[0:3], v[136:139]
    ds_read_b64_tr_b16 a[90:91], v86 offset:20992
    v_mfma_f32_16x16x32_bf16 v[140:143], a[44:47], a[4:7], v[140:143]
    ds_read_b64_tr_b16 a[92:93], v87 offset:20480
    v_mfma_f32_16x16x32_bf16 v[144:147], a[44:47], a[8:11], v[144:147]
    buffer_load_dwordx2 v[46:47], v49, s[44:47], s87 offen sc1
    v_mfma_f32_16x16x32_bf16 v[148:151], a[44:47], a[12:15], v[148:151]
    ds_read_b64_tr_b16 a[94:95], v87 offset:20992
    v_mfma_f32_16x16x32_bf16 v[152:155], a[44:47], a[16:19], v[152:155]
    buffer_load_dword v67, off, s[44:47], s93 sc1
    v_mfma_f32_16x16x32_bf16 v[156:159], a[48:51], a[0:3], v[156:159]
    ds_read_b64_tr_b16 a[96:97], v86 offset:28672
    v_mfma_f32_16x16x32_bf16 v[160:163], a[48:51], a[4:7], v[160:163]
    ds_read_b64_tr_b16 a[98:99], v86 offset:29184
    v_mfma_f32_16x16x32_bf16 v[164:167], a[48:51], a[8:11], v[164:167]
    buffer_load_dwordx2 a[116:117], v56, s[44:47], 0 offen offset:0 sc1
    v_mfma_f32_16x16x32_bf16 v[168:171], a[48:51], a[12:15], v[168:171]
    ds_read_b64_tr_b16 a[100:101], v87 offset:28672
    v_mfma_f32_16x16x32_bf16 v[172:175], a[48:51], a[16:19], v[172:175]
    ds_read_b64_tr_b16 a[102:103], v87 offset:29184
    v_mfma_f32_16x16x32_bf16 v[176:179], a[0:3], a[20:23], v[176:179]
    buffer_load_dwordx2 a[118:119], v52, s[44:47], 0 offen offset:32 sc1
    v_mfma_f32_16x16x32_bf16 v[180:183], a[4:7], a[20:23], v[180:183]
    ds_read_b128 a[72:75], v85 offset:0
    v_mfma_f32_16x16x32_bf16 v[184:187], a[8:11], a[20:23], v[184:187]
    v_mfma_f32_16x16x32_bf16 v[188:191], a[12:15], a[20:23], v[188:191]
    ds_read_b128 a[76:79], v85 offset:2048
    v_mfma_f32_16x16x32_bf16 v[192:195], a[16:19], a[20:23], v[192:195]
    buffer_load_dwordx2 a[120:121], v52, s[44:47], 0 offen offset:64 sc1
    v_mfma_f32_16x16x32_bf16 v[196:199], a[0:3], a[24:27], v[196:199]
    ds_read_b128 a[80:83], v85 offset:8192
    v_mfma_f32_16x16x32_bf16 v[200:203], a[4:7], a[24:27], v[200:203]
    buffer_load_dwordx2 a[122:123], v52, s[44:47], 0 offen offset:96 sc1
    v_mfma_f32_16x16x32_bf16 v[204:207], a[8:11], a[24:27], v[204:207]
    ds_read_b128 a[84:87], v85 offset:10240
    v_mfma_f32_16x16x32_bf16 v[208:211], a[12:15], a[24:27], v[208:211]
    buffer_load_dwordx2 a[124:125], v52, s[44:47], 0 offen offset:128 sc1
    v_mfma_f32_16x16x32_bf16 v[212:215], a[16:19], a[24:27], v[212:215]
    v_mfma_f32_16x16x32_bf16 v[216:219], a[0:3], a[28:31], v[216:219]
    v_mfma_f32_16x16x32_bf16 v[220:223], a[4:7], a[28:31], v[220:223]
    buffer_load_dwordx2 a[126:127], v53, s[44:47], 0 offen offset:0 sc1
    v_mfma_f32_16x16x32_bf16 v[224:227], a[8:11], a[28:31], v[224:227]
    v_mfma_f32_16x16x32_bf16 v[228:231], a[12:15], a[28:31], v[228:231]
    v_mfma_f32_16x16x32_bf16 v[232:235], a[16:19], a[28:31], v[232:235]
    s_mov_b64 s[60:61], s[48:49]
    v_mfma_f32_16x16x32_bf16 v[236:239], a[0:3], a[32:35], v[236:239]
    s_cmp_lt_u32 s68, 18
    s_cselect_b32 s88, s73, 0
    v_mfma_f32_16x16x32_bf16 v[240:243], a[4:7], a[32:35], v[240:243]
    s_mul_i32 s62, s88, 12513280
    v_mfma_f32_16x16x32_bf16 v[244:247], a[8:11], a[32:35], v[244:247]
    s_cmp_eq_u32 s88, 1
    s_cselect_b32 s77, s77, 1024
    v_mfma_f32_16x16x32_bf16 v[248:251], a[12:15], a[32:35], v[248:251]
    s_cmp_eq_u32 s73, 1
    s_cselect_b32 s76, s76, 1024
    v_mfma_f32_16x16x32_bf16 v[252:255], a[16:19], a[32:35], v[252:255]
    s_waitcnt vmcnt(23) lgkmcnt(0)
    s_barrier
    v_mfma_f32_16x16x32_bf16 v[96:99], a[88:91], a[52:55], v[96:99]
    ds_read_b128 a[0:3], v23 offset:0
    v_readlane_b32 s81, v90, 1
    v_mfma_f32_16x16x32_bf16 v[100:103], a[88:91], a[56:59], v[100:103]
    ds_read_b128 a[4:7], v23 offset:2048
    v_mfma_f32_16x16x32_bf16 v[104:107], a[88:91], a[60:63], v[104:107]
    v_mfma_f32_16x16x32_bf16 v[108:111], a[88:91], a[64:67], v[108:111]
    ds_read_b128 a[8:11], v23 offset:4096
    s_add_u32 m0, s85, 65536
    v_mfma_f32_16x16x32_bf16 v[112:115], a[88:91], a[68:71], v[112:115]
    buffer_load_dwordx4 v15, s[96:99], s81 offen offset:0 lds
    v_mfma_f32_16x16x32_bf16 v[116:119], a[92:95], a[52:55], v[116:119]
    ds_read_b128 a[12:15], v23 offset:6144
    v_mfma_f32_16x16x32_bf16 v[120:123], a[92:95], a[56:59], v[120:123]
    ds_read_b128 a[16:19], v23 offset:8192
    v_mfma_f32_16x16x32_bf16 v[124:127], a[92:95], a[60:63], v[124:127]
    v_mfma_f32_16x16x32_bf16 v[128:131], a[92:95], a[64:67], v[128:131]
    s_add_u32 s89, s85, 32768
    ds_read_b64_tr_b16 a[36:37], v27 offset:16384
    v_add_u32_e64 v78, s89, v92
    v_mfma_f32_16x16x32_bf16 v[132:135], a[92:95], a[68:71], v[132:135]
    buffer_load_dwordx4 v16, s[96:99], s81 offen offset:1024 lds
    v_mfma_f32_16x16x32_bf16 v[136:139], a[96:99], a[52:55], v[136:139]
    ds_read_b64_tr_b16 a[38:39], v27 offset:16896
    v_mfma_f32_16x16x32_bf16 v[140:143], a[96:99], a[56:59], v[140:143]
    ds_read_b64_tr_b16 a[40:41], v28 offset:16384
    v_xor_b32_e64 v79, 32, v78
    v_mfma_f32_16x16x32_bf16 v[144:147], a[96:99], a[60:63], v[144:147]
    buffer_load_dwordx4 v17, s[96:99], s81 offen offset:2048 lds
    v_mfma_f32_16x16x32_bf16 v[148:151], a[96:99], a[64:67], v[148:151]
    ds_read_b64_tr_b16 a[42:43], v28 offset:16896
    v_mfma_f32_16x16x32_bf16 v[152:155], a[96:99], a[68:71], v[152:155]
    v_xor_b32_e64 v80, 64, v78
    v_mfma_f32_16x16x32_bf16 v[156:159], a[100:103], a[52:55], v[156:159]
    ds_read_b64_tr_b16 a[44:45], v27 offset:24576
    v_mfma_f32_16x16x32_bf16 v[160:163], a[100:103], a[56:59], v[160:163]
    buffer_load_dwordx4 v18, s[96:99], s81 offen offset:3072 lds
    v_mfma_f32_16x16x32_bf16 v[164:167], a[100:103], a[60:63], v[164:167]
    ds_read_b64_tr_b16 a[46:47], v27 offset:25088
    v_xor_b32 v81, 96, v78
    v_mfma_f32_16x16x32_bf16 v[168:171], a[100:103], a[64:67], v[168:171]
    ds_read_b64_tr_b16 a[48:49], v28 offset:24576
    v_mfma_f32_16x16x32_bf16 v[172:175], a[100:103], a[68:71], v[172:175]
    v_readlane_b32 s81, v90, 17
    v_mfma_f32_16x16x32_bf16 v[176:179], a[52:55], a[72:75], v[176:179]
    ds_read_b64_tr_b16 a[50:51], v28 offset:25088
    s_waitcnt vmcnt(20)
    v_mfma_f32_16x16x32_bf16 v[180:183], a[56:59], a[72:75], v[180:183]
    ds_read_b128 a[20:23], v25 offset:0
    v_mfma_f32_16x16x32_bf16 v[184:187], a[60:63], a[72:75], v[184:187]
    ds_read_b64_tr_b16 a[128:129], v78 offset:0
    v_mfma_f32_16x16x32_bf16 v[188:191], a[64:67], a[72:75], v[188:191]
    ds_read_b128 a[24:27], v25 offset:2048
    s_add_u32 m0, s85, 69632
    v_mfma_f32_16x16x32_bf16 v[192:195], a[68:71], a[72:75], v[192:195]
    buffer_load_dwordx4 v15, s[96:99], s81 offen offset:0 lds
    v_mfma_f32_16x16x32_bf16 v[196:199], a[52:55], a[76:79], v[196:199]
    ds_read_b64_tr_b16 a[130:131], v78 offset:2048
    v_mfma_f32_16x16x32_bf16 v[200:203], a[56:59], a[76:79], v[200:203]
    ds_read_b128 a[28:31], v25 offset:8192
    v_mfma_f32_16x16x32_bf16 v[204:207], a[60:63], a[76:79], v[204:207]
    ds_read_b128 a[32:35], v25 offset:10240
    v_mfma_f32_16x16x32_bf16 v[208:211], a[64:67], a[76:79], v[208:211]
    ds_read_b64_tr_b16 a[132:133], v79 offset:0
    v_mfma_f32_16x16x32_bf16 v[212:215], a[68:71], a[76:79], v[212:215]
    buffer_load_dwordx4 v16, s[96:99], s81 offen offset:1024 lds
    v_mfma_f32_16x16x32_bf16 v[216:219], a[52:55], a[80:83], v[216:219]
    s_waitcnt vmcnt(12)
    ds_read_b64_tr_b16 a[134:135], v79 offset:2048
    v_mfma_f32_16x16x32_bf16 v[220:223], a[56:59], a[80:83], v[220:223]
    v_xor_b32_e64 v66, v31, v29
    v_mfma_f32_16x16x32_bf16 v[224:227], a[60:63], a[80:83], v[224:227]
    buffer_load_dwordx4 v17, s[96:99], s81 offen offset:2048 lds
    v_mfma_f32_16x16x32_bf16 v[228:231], a[64:67], a[80:83], v[228:231]
    ds_read_b64_tr_b16 a[136:137], v80 offset:0
    v_mfma_f32_16x16x32_bf16 v[232:235], a[68:71], a[80:83], v[232:235]
    v_bitop3_b32 v66, v35, v29, v66 bitop3:0xbe
    v_mfma_f32_16x16x32_bf16 v[236:239], a[52:55], a[84:87], v[236:239]
    buffer_load_dwordx4 v18, s[96:99], s81 offen offset:3072 lds
    v_mfma_f32_16x16x32_bf16 v[240:243], a[56:59], a[84:87], v[240:243]
    ds_read_b64_tr_b16 a[138:139], v80 offset:2048
    v_mfma_f32_16x16x32_bf16 v[244:247], a[60:63], a[84:87], v[244:247]
    v_bitop3_b32 v66, v39, v29, v66 bitop3:0xbe
    v_mfma_f32_16x16x32_bf16 v[248:251], a[64:67], a[84:87], v[248:251]
    v_mfma_f32_16x16x32_bf16 v[252:255], a[68:71], a[84:87], v[252:255]
    ds_read_b64_tr_b16 a[140:141], v81 offset:0
    v_readlane_b32 s81, v90, 2
    s_waitcnt lgkmcnt(5)
    v_mfma_f32_16x16x32_bf16 v[96:99], a[36:39], a[0:3], v[96:99]
    ds_read_b128 a[52:55], v24 offset:0
    v_mfma_f32_16x16x32_bf16 v[100:103], a[36:39], a[4:7], v[100:103]
    v_bitop3_b32 v66, v43, v29, v66 bitop3:0xbe
    v_mfma_f32_16x16x32_bf16 v[104:107], a[36:39], a[8:11], v[104:107]
    ds_read_b128 a[56:59], v24 offset:2048
    v_mfma_f32_16x16x32_bf16 v[108:111], a[36:39], a[12:15], v[108:111]
    ds_read_b64_tr_b16 a[142:143], v81 offset:2048
    s_add_u32 m0, s85, 131072
    v_mfma_f32_16x16x32_bf16 v[112:115], a[36:39], a[16:19], v[112:115]
    ds_read_b128 a[60:63], v24 offset:4096
    v_bitop3_b32 v66, v47, v29, v66 bitop3:0xbe
    v_mfma_f32_16x16x32_bf16 v[116:119], a[40:43], a[0:3], v[116:119]
    buffer_load_dwordx4 v15, s[96:99], s81 offen offset:0 lds
    v_mfma_f32_16x16x32_bf16 v[120:123], a[40:43], a[4:7], v[120:123]
    ds_read_b128 a[64:67], v24 offset:6144
    v_mfma_f32_16x16x32_bf16 v[124:127], a[40:43], a[8:11], v[124:127]
    ds_read_b64_tr_b16 a[144:145], v78 offset:4096
    v_bitop3_b32 v66, v67, v29, v66 bitop3:0xbe
    v_mfma_f32_16x16x32_bf16 v[128:131], a[40:43], a[12:15], v[128:131]
    ds_read_b128 a[68:71], v24 offset:8192
    v_mfma_f32_16x16x32_bf16 v[132:135], a[40:43], a[16:19], v[132:135]
    buffer_load_dwordx4 v16, s[96:99], s81 offen offset:1024 lds
    v_mfma_f32_16x16x32_bf16 v[136:139], a[44:47], a[0:3], v[136:139]
    ds_read_b64_tr_b16 a[88:89], v27 offset:20480
    v_mfma_f32_16x16x32_bf16 v[140:143], a[44:47], a[4:7], v[140:143]
    ds_read_b64_tr_b16 a[146:147], v78 offset:6144
    v_cmp_ne_u32 vcc, 0, v66
    v_mfma_f32_16x16x32_bf16 v[144:147], a[44:47], a[8:11], v[144:147]
    ds_read_b64_tr_b16 a[90:91], v27 offset:20992
    v_mfma_f32_16x16x32_bf16 v[148:151], a[44:47], a[12:15], v[148:151]
    ds_read_b64_tr_b16 a[92:93], v28 offset:20480
    v_mfma_f32_16x16x32_bf16 v[152:155], a[44:47], a[16:19], v[152:155]
    buffer_load_dwordx4 v17, s[96:99], s81 offen offset:2048 lds
    v_mfma_f32_16x16x32_bf16 v[156:159], a[48:51], a[0:3], v[156:159]
    ds_read_b64_tr_b16 a[148:149], v79 offset:4096
    s_cbranch_vccnz L_sp_statS
L_ok_statS:
    v_mfma_f32_16x16x32_bf16 v[160:163], a[48:51], a[4:7], v[160:163]
    ds_read_b64_tr_b16 a[94:95], v28 offset:20992
    v_mfma_f32_16x16x32_bf16 v[164:167], a[48:51], a[8:11], v[164:167]
    ds_read_b64_tr_b16 a[96:97], v27 offset:28672
    v_mfma_f32_16x16x32_bf16 v[168:171], a[48:51], a[12:15], v[168:171]
    ds_read_b64_tr_b16 a[150:151], v79 offset:6144
    v_mfma_f32_16x16x32_bf16 v[172:175], a[48:51], a[16:19], v[172:175]
    buffer_load_dwordx4 v18, s[96:99], s81 offen offset:3072 lds
    v_mfma_f32_16x16x32_bf16 v[176:179], a[0:3], a[20:23], v[176:179]
    buffer_load_dwordx4 a[224:227], v68, s[44:47], s94 offen offset:0 sc1
    v_mfma_f32_16x16x32_bf16 v[180:183], a[4:7], a[20:23], v[180:183]
    ds_read_b64_tr_b16 a[98:99], v27 offset:29184
    v_readlane_b32 s81, v90, 18
    v_mfma_f32_16x16x32_bf16 v[184:187], a[8:11], a[20:23], v[184:187]
    ds_read_b64_tr_b16 a[100:101], v28 offset:28672
    s_add_u32 m0, s85, 135168
    v_mfma_f32_16x16x32_bf16 v[188:191], a[12:15], a[20:23], v[188:191]
    ds_read_b64_tr_b16 a[152:153], v80 offset:4096
    v_mfma_f32_16x16x32_bf16 v[192:195], a[16:19], a[20:23], v[192:195]
    buffer_load_dwordx4 a[228:231], v68, s[44:47], s94 offen offset:1024 sc1
    v_mfma_f32_16x16x32_bf16 v[196:199], a[0:3], a[24:27], v[196:199]
    ds_read_b64_tr_b16 a[102:103], v28 offset:29184
    v_mfma_f32_16x16x32_bf16 v[200:203], a[4:7], a[24:27], v[200:203]
    ds_read_b64_tr_b16 a[154:155], v80 offset:6144
    v_mfma_f32_16x16x32_bf16 v[204:207], a[8:11], a[24:27], v[204:207]
    ds_read_b128 a[72:75], v26 offset:0
    v_mfma_f32_16x16x32_bf16 v[208:211], a[12:15], a[24:27], v[208:211]
    buffer_load_dwordx4 a[232:235], v68, s[44:47], s94 offen offset:2048 sc1
    v_mfma_f32_16x16x32_bf16 v[212:215], a[16:19], a[24:27], v[212:215]
    ds_read_b128 a[76:79], v26 offset:2048
    v_mfma_f32_16x16x32_bf16 v[216:219], a[0:3], a[28:31], v[216:219]
    ds_read_b64_tr_b16 a[156:157], v81 offset:4096
    v_mfma_f32_16x16x32_bf16 v[220:223], a[4:7], a[28:31], v[220:223]
    buffer_load_dwordx4 v15, s[96:99], s81 offen offset:0 lds
    v_mfma_f32_16x16x32_bf16 v[224:227], a[8:11], a[28:31], v[224:227]
    ds_read_b128 a[80:83], v26 offset:8192
    v_mfma_f32_16x16x32_bf16 v[228:231], a[12:15], a[28:31], v[228:231]
    buffer_load_dwordx4 a[236:239], v68, s[44:47], s94 offen offset:3072 sc1
    v_mfma_f32_16x16x32_bf16 v[232:235], a[16:19], a[28:31], v[232:235]
    ds_read_b128 a[84:87], v26 offset:10240
    v_mfma_f32_16x16x32_bf16 v[236:239], a[0:3], a[32:35], v[236:239]
    ds_read_b64_tr_b16 a[158:159], v81 offset:6144
    v_mfma_f32_16x16x32_bf16 v[240:243], a[4:7], a[32:35], v[240:243]
    buffer_load_dwordx4 v16, s[96:99], s81 offen offset:1024 lds
    v_mfma_f32_16x16x32_bf16 v[244:247], a[8:11], a[32:35], v[244:247]
    buffer_load_dwordx4 a[240:243], v68, s[44:47], s95 offen offset:0 sc1
    v_mfma_f32_16x16x32_bf16 v[248:251], a[12:15], a[32:35], v[248:251]
    buffer_load_dwordx4 v17, s[96:99], s81 offen offset:2048 lds
    v_mfma_f32_16x16x32_bf16 v[252:255], a[16:19], a[32:35], v[252:255]
    buffer_load_dwordx4 a[244:247], v68, s[44:47], s95 offen offset:1024 sc1
    buffer_load_dwordx4 v18, s[96:99], s81 offen offset:3072 lds
    s_waitcnt lgkmcnt(0)
    s_barrier
    v_mfma_f32_16x16x32_bf16 v[96:99], a[88:91], a[52:55], v[96:99]
    v_readlane_b32 s81, v90, 3
    v_and_b32 v32, 0xffff0000, v30
    v_mfma_f32_16x16x32_bf16 v[100:103], a[88:91], a[56:59], v[100:103]
    s_add_u32 s89, s85, 65536
    v_add_u32 v78, s89, v92
    v_lshlrev_b32_e64 v30, 16, v30
    v_mfma_f32_16x16x32_bf16 v[104:107], a[88:91], a[60:63], v[104:107]
    v_xor_b32_e64 v79, 32, v78
    v_mfma_f32_16x16x32_bf16 v[108:111], a[88:91], a[64:67], v[108:111]
    v_rcp_f32_e64 v33, v32
    v_mfma_f32_16x16x32_bf16 v[112:115], a[88:91], a[68:71], v[112:115]
    v_xor_b32 v30, 0x80000000, v30
    v_xor_b32_e64 v80, 64, v78
    s_add_u32 m0, s85, 32768
    v_mfma_f32_16x16x32_bf16 v[116:119], a[92:95], a[52:55], v[116:119]
    v_mul_f32_e64 v32, v32, v32
    v_mfma_f32_16x16x32_bf16 v[120:123], a[92:95], a[56:59], v[120:123]
    buffer_load_dwordx4 v15, s[96:99], s81 offen offset:0 lds
    v_mfma_f32_16x16x32_bf16 v[124:127], a[92:95], a[60:63], v[124:127]
    v_xor_b32 v81, 96, v78
    v_mul_f32 v31, 0xbfb8aa3b, v33
    s_waitcnt vmcnt(19)
    v_mfma_f32_16x16x32_bf16 v[128:131], a[92:95], a[64:67], v[128:131]
    v_and_b32 v36, 0xffff0000, v34
    v_lshlrev_b32 v34, 16, v34
    v_mfma_f32_16x16x32_bf16 v[132:135], a[92:95], a[68:71], v[132:135]
    ds_read_b64_tr_b16 a[160:161], v78 offset:0
    v_mfma_f32_16x16x32_bf16 v[136:139], a[96:99], a[52:55], v[136:139]
    buffer_load_dwordx4 v16, s[96:99], s81 offen offset:1024 lds
    v_mfma_f32_16x16x32_bf16 v[140:143], a[96:99], a[56:59], v[140:143]
    v_rcp_f32_e64 v37, v36
    v_mfma_f32_16x16x32_bf16 v[144:147], a[96:99], a[60:63], v[144:147]
    ds_read_b64_tr_b16 a[162:163], v78 offset:2048
    v_xor_b32 v34, 0x80000000, v34
    v_mfma_f32_16x16x32_bf16 v[148:151], a[96:99], a[64:67], v[148:151]
    ds_read_b64_tr_b16 a[164:165], v79 offset:0
    v_mul_f32_e64 v36, v36, v36
    v_mfma_f32_16x16x32_bf16 v[152:155], a[96:99], a[68:71], v[152:155]
    buffer_load_dwordx4 v17, s[96:99], s81 offen offset:2048 lds
    v_mfma_f32_16x16x32_bf16 v[156:159], a[100:103], a[52:55], v[156:159]
    ds_read_b64_tr_b16 a[166:167], v79 offset:2048
    v_mul_f32 v35, 0xbfb8aa3b, v37
    v_mfma_f32_16x16x32_bf16 v[160:163], a[100:103], a[56:59], v[160:163]
    v_and_b32 v40, 0xffff0000, v38
    v_lshlrev_b32_e64 v38, 16, v38
    v_mfma_f32_16x16x32_bf16 v[164:167], a[100:103], a[60:63], v[164:167]
    buffer_load_dwordx4 v18, s[96:99], s81 offen offset:3072 lds
    v_mfma_f32_16x16x32_bf16 v[168:171], a[100:103], a[64:67], v[168:171]
    ds_read_b64_tr_b16 a[168:169], v80 offset:0
    v_mfma_f32_16x16x32_bf16 v[172:175], a[100:103], a[68:71], v[172:175]
    ds_read_b64_tr_b16 a[170:171], v80 offset:2048
    v_readlane_b32 s81, v90, 19
    v_mfma_f32_16x16x32_bf16 v[176:179], a[52:55], a[72:75], v[176:179]
    v_rcp_f32_e64 v41, v40
    v_mfma_f32_16x16x32_bf16 v[180:183], a[56:59], a[72:75], v[180:183]
    v_xor_b32 v38, 0x80000000, v38
    v_mul_f32_e64 v40, v40, v40
    v_mfma_f32_16x16x32_bf16 v[184:187], a[60:63], a[72:75], v[184:187]
    ds_read_b64_tr_b16 a[172:173], v81 offset:0
    v_mul_f32 v39, 0xbfb8aa3b, v41
    v_mfma_f32_16x16x32_bf16 v[188:191], a[64:67], a[72:75], v[188:191]
    ds_read_b64_tr_b16 a[174:175], v81 offset:2048
    v_and_b32 v44, 0xffff0000, v42
    s_waitcnt vmcnt(18)
    v_mfma_f32_16x16x32_bf16 v[192:195], a[68:71], a[72:75], v[192:195]
    s_add_u32 m0, s85, 36864
    ds_read_b64_tr_b16 a[176:177], v78 offset:4096
    v_lshlrev_b32 v42, 16, v42
    v_mfma_f32_16x16x32_bf16 v[196:199], a[52:55], a[76:79], v[196:199]
    buffer_load_dwordx4 v15, s[96:99], s81 offen offset:0 lds
    v_mfma_f32_16x16x32_bf16 v[200:203], a[56:59], a[76:79], v[200:203]
    ds_read_b64_tr_b16 a[178:179], v78 offset:6144
    v_mfma_f32_16x16x32_bf16 v[204:207], a[60:63], a[76:79], v[204:207]
    v_rcp_f32_e64 v45, v44
    v_mfma_f32_16x16x32_bf16 v[208:211], a[64:67], a[76:79], v[208:211]
    v_xor_b32 v42, 0x80000000, v42
    v_mul_f32_e64 v44, v44, v44
    v_mfma_f32_16x16x32_bf16 v[212:215], a[68:71], a[76:79], v[212:215]
    ds_read_b64_tr_b16 a[180:181], v79 offset:4096
    v_mul_f32 v43, 0xbfb8aa3b, v45
    v_mfma_f32_16x16x32_bf16 v[216:219], a[52:55], a[80:83], v[216:219]
    buffer_load_dwordx4 v16, s[96:99], s81 offen offset:1024 lds
    v_mfma_f32_16x16x32_bf16 v[220:223], a[56:59], a[80:83], v[220:223]
    ds_read_b64_tr_b16 a[182:183], v79 offset:6144
    v_and_b32 v48, 0xffff0000, v46
    v_mfma_f32_16x16x32_bf16 v[224:227], a[60:63], a[80:83], v[224:227]
    ds_read_b64_tr_b16 a[184:185], v80 offset:4096
    v_lshlrev_b32_e64 v46, 16, v46
    v_mfma_f32_16x16x32_bf16 v[228:231], a[64:67], a[80:83], v[228:231]
    buffer_load_dwordx4 v17, s[96:99], s81 offen offset:2048 lds
    v_mfma_f32_16x16x32_bf16 v[232:235], a[68:71], a[80:83], v[232:235]
    ds_read_b64_tr_b16 a[186:187], v80 offset:6144
    v_mfma_f32_16x16x32_bf16 v[236:239], a[52:55], a[84:87], v[236:239]
    v_rcp_f32_e64 v49, v48
    v_mfma_f32_16x16x32_bf16 v[240:243], a[56:59], a[84:87], v[240:243]
    v_xor_b32 v46, 0x80000000, v46
    v_mul_f32_e64 v48, v48, v48
L_pad10:
    s_cbranch_execz L_pad14
    s_nop 0
    v_mfma_f32_16x16x32_bf16 v[244:247], a[60:63], a[84:87], v[244:247]
    ds_read_b64_tr_b16 a[188:189], v81 offset:4096
    v_mul_f32 v47, 0xbfb8aa3b, v49
    v_mfma_f32_16x16x32_bf16 v[248:251], a[64:67], a[84:87], v[248:251]
    buffer_load_dwordx4 v18, s[96:99], s81 offen offset:3072 lds
    v_mfma_f32_16x16x32_bf16 v[252:255], a[68:71], a[84:87], v[252:255]
    ds_read_b64_tr_b16 a[190:191], v81 offset:6144
    v_mov_b32_dpp v50, v96 row_newbcast:0 row_mask:0xf bank_mask:0xf
    v_mov_b32_dpp v51, v97 row_newbcast:0 row_mask:0xf bank_mask:0xf
    v_mov_b32_dpp v52, v98 row_newbcast:0 row_mask:0xf bank_mask:0xf
    v_readlane_b32 s81, v90, 4
    s_add_u32 m0, s85, 0
    s_nop 3
    buffer_load_dwordx4 v15, s[96:99], s81 offen offset:0 lds
    v_mov_b32_dpp v53, v99 row_newbcast:0 row_mask:0xf bank_mask:0xf
    v_mov_b32_dpp v54, v116 row_newbcast:0 row_mask:0xf bank_mask:0xf
    v_mov_b32_dpp v55, v117 row_newbcast:0 row_mask:0xf bank_mask:0xf
    v_mov_b32_dpp v56, v118 row_newbcast:0 row_mask:0xf bank_mask:0xf
    v_mov_b32_dpp v57, v119 row_newbcast:0 row_mask:0xf bank_mask:0xf
    v_mov_b32_dpp v58, v136 row_newbcast:0 row_mask:0xf bank_mask:0xf
    v_mov_b32_dpp v59, v137 row_newbcast:0 row_mask:0xf bank_mask:0xf
    v_mov_b32_dpp v60, v138 row_newbcast:0 row_mask:0xf bank_mask:0xf
    v_mov_b32_dpp v61, v139 row_newbcast:0 row_mask:0xf bank_mask:0xf
    v_mov_b32_dpp v62, v156 row_newbcast:0 row_mask:0xf bank_mask:0xf
    v_mov_b32_dpp v63, v157 row_newbcast:0 row_mask:0xf bank_mask:0xf
    v_mov_b32_dpp v64, v158 row_newbcast:0 row_mask:0xf bank_mask:0xf
    v_mov_b32_dpp v65, v159 row_newbcast:0 row_mask:0xf bank_mask:0xf
    v_pk_fma_f32 v[96:97], v[50:51], v[30:31], v[96:97] op_sel_hi:[1,0,1]
    buffer_load_dwordx4 v16, s[96:99], s81 offen offset:1024 lds
    v_pk_fma_f32 v[98:99], v[52:53], v[30:31], v[98:99] op_sel_hi:[1,0,1]
    v_pk_fma_f32 v[116:117], v[54:55], v[30:31], v[116:117] op_sel_hi:[1,0,1]
    v_pk_fma_f32 v[118:119], v[56:57], v[30:31], v[118:119] op_sel_hi:[1,0,1]
    v_pk_mul_f32 v[66:67], v[96:97], v[30:31] op_sel:[0,1] op_sel_hi:[1,1]
    v_pk_mul_f32 v[68:69], v[98:99], v[30:31] op_sel:[0,1] op_sel_hi:[1,1]
    v_pk_mul_f32 v[70:71], v[116:117], v[30:31] op_sel:[0,1] op_sel_hi:[1,1]
    v_pk_mul_f32 v[72:73], v[118:119], v[30:31] op_sel:[0,1] op_sel_hi:[1,1]
    v_exp_f32 v66, v66
    v_exp_f32 v67, v67
    v_pk_fma_f32 v[136:137], v[58:59], v[30:31], v[136:137] op_sel_hi:[1,0,1]
    v_exp_f32 v68, v68
    v_exp_f32 v69, v69
    v_pk_fma_f32 v[138:139], v[60:61], v[30:31], v[138:139] op_sel_hi:[1,0,1]
    v_exp_f32_e64 v70, v70
    buffer_load_dwordx4 v17, s[96:99], s81 offen offset:2048 lds
    v_exp_f32_e64 v71, v71
    v_pk_fma_f32 v[156:157], v[62:63], v[30:31], v[156:157] op_sel_hi:[1,0,1]
    v_exp_f32 v72, v72
    v_exp_f32 v73, v73
    v_pk_fma_f32 v[158:159], v[64:65], v[30:31], v[158:159] op_sel_hi:[1,0,1]
    v_pk_fma_f32 v[66:67], v[66:67], v[32:33], v[32:33] op_sel_hi:[1,0,0]
    v_pk_fma_f32 v[68:69], v[68:69], v[32:33], v[32:33] op_sel_hi:[1,0,0]
    v_pk_fma_f32 v[70:71], v[70:71], v[32:33], v[32:33] op_sel_hi:[1,0,0]
    v_pk_fma_f32 v[72:73], v[72:73], v[32:33], v[32:33] op_sel_hi:[1,0,0]
    v_rcp_f32 v66, v66
    v_rcp_f32 v67, v67
    v_pk_mul_f32 v[96:97], v[96:97], v[136:137]
    v_rcp_f32 v68, v68
    v_rcp_f32 v69, v69
    buffer_load_dwordx4 v18, s[96:99], s81 offen offset:3072 lds
    v_pk_mul_f32 v[98:99], v[98:99], v[138:139]
    v_rcp_f32 v70, v70
    v_rcp_f32 v71, v71
    v_pk_mul_f32 v[116:117], v[116:117], v[156:157]
    v_rcp_f32 v72, v72
    v_rcp_f32 v73, v73
    v_pk_mul_f32 v[118:119], v[118:119], v[158:159]
    v_pk_mul_f32 v[96:97], v[96:97], v[66:67]
    v_pk_mul_f32 v[98:99], v[98:99], v[68:69]
    v_pk_mul_f32 v[116:117], v[116:117], v[70:71]
    v_pk_mul_f32 v[118:119], v[118:119], v[72:73]
    v_cvt_pk_bf16_f32 v96, v96, v97
    v_cvt_pk_bf16_f32 v97, v98, v99
    v_cvt_pk_bf16_f32 v98, v116, v117
    v_readlane_b32 s81, v90, 20
    s_add_u32 m0, s85, 4096
    s_nop 3
    buffer_load_dwordx4 v15, s[96:99], s81 offen offset:0 lds
    v_cvt_pk_bf16_f32 v99, v118, v119
    buffer_store_dwordx4 v[96:99], v6, s[60:63], s101 offen sc1
    v_and_b32 v23, 15, v0
    s_add_u32 s93, s85, 98304
    v_cmp_ne_u32_e64 vcc, 0, v23
    v_lshl_add_u32 v23, v23, 3, s93
    v_lshl_add_u32 v24, v95, 5, s93
    v_cndmask_b32 v33, 0, v33, vcc
    v_cmp_gt_u32 vcc, 16, v0
    ds_write2_b32 v23, v30, v33 offset0:0 offset1:1
    ds_write2_b32 v23, v34, v37 offset0:32 offset1:33
    ds_write2_b32 v23, v38, v41 offset0:64 offset1:65
    ds_write2_b32 v23, v42, v45 offset0:96 offset1:97
    ds_write2_b32 v23, v46, v49 offset0:128 offset1:129
    v_cndmask_b32 v1, 0, 1.0, vcc
    v_pk_fma_f32 v[100:101], v[50:51], v[34:35], v[100:101] op_sel_hi:[1,0,1]
    v_pk_fma_f32 v[102:103], v[52:53], v[34:35], v[102:103] op_sel_hi:[1,0,1]
    v_pk_fma_f32 v[120:121], v[54:55], v[34:35], v[120:121] op_sel_hi:[1,0,1]
    v_pk_fma_f32 v[122:123], v[56:57], v[34:35], v[122:123] op_sel_hi:[1,0,1]
    v_pk_mul_f32 v[66:67], v[100:101], v[34:35] op_sel:[0,1] op_sel_hi:[1,1]
    v_pk_mul_f32 v[68:69], v[102:103], v[34:35] op_sel:[0,1] op_sel_hi:[1,1]
    v_pk_mul_f32 v[70:71], v[120:121], v[34:35] op_sel:[0,1] op_sel_hi:[1,1]
    v_pk_mul_f32 v[72:73], v[122:123], v[34:35] op_sel:[0,1] op_sel_hi:[1,1]
    v_exp_f32 v66, v66
    v_exp_f32 v67, v67
    v_pk_fma_f32 v[140:141], v[58:59], v[34:35], v[140:141] op_sel_hi:[1,0,1]
    buffer_load_dwordx4 v16, s[96:99], s81 offen offset:1024 lds
    v_exp_f32 v68, v68
    v_exp_f32 v69, v69
    v_pk_fma_f32 v[142:143], v[60:61], v[34:35], v[142:143] op_sel_hi:[1,0,1]
    v_exp_f32 v70, v70
    v_exp_f32 v71, v71
    v_pk_fma_f32 v[160:161], v[62:63], v[34:35], v[160:161] op_sel_hi:[1,0,1]
    v_exp_f32 v72, v72
    v_exp_f32 v73, v73
    v_pk_fma_f32 v[162:163], v[64:65], v[34:35], v[162:163] op_sel_hi:[1,0,1]
    v_pk_fma_f32 v[66:67], v[66:67], v[36:37], v[36:37] op_sel_hi:[1,0,0]
    v_pk_fma_f32 v[68:69], v[68:69], v[36:37], v[36:37] op_sel_hi:[1,0,0]
    v_pk_fma_f32 v[70:71], v[70:71], v[36:37], v[36:37] op_sel_hi:[1,0,0]
    v_pk_fma_f32 v[72:73], v[72:73], v[36:37], v[36:37] op_sel_hi:[1,0,0]
    v_rcp_f32_e64 v66, v66
    buffer_load_dwordx4 v17, s[96:99], s81 offen offset:2048 lds
    v_rcp_f32_e64 v67, v67
    v_pk_mul_f32 v[100:101], v[100:101], v[140:141]
    v_rcp_f32 v68, v68
    v_rcp_f32 v69, v69
    v_pk_mul_f32 v[102:103], v[102:103], v[142:143]
    v_rcp_f32 v70, v70
    v_rcp_f32 v71, v71
    v_pk_mul_f32 v[120:121], v[120:121], v[160:161]
    v_rcp_f32 v72, v72
    v_rcp_f32 v73, v73
    v_pk_mul_f32 v[122:123], v[122:123], v[162:163]
    v_pk_mul_f32 v[100:101], v[100:101], v[66:67]
    v_pk_mul_f32 v[102:103], v[102:103], v[68:69]
    v_pk_mul_f32 v[120:121], v[120:121], v[70:71]
    buffer_load_dwordx4 v18, s[96:99], s81 offen offset:3072 lds
    v_pk_mul_f32 v[122:123], v[122:123], v[72:73]
    v_cvt_pk_bf16_f32 v100, v100, v101
    v_cvt_pk_bf16_f32 v101, v102, v103
    v_cvt_pk_bf16_f32 v102, v120, v121
    v_cvt_pk_bf16_f32 v103, v122, v123
    buffer_store_dwordx4 v[100:103], v7, s[60:63], s101 offen sc1
    v_pk_fma_f32 v[104:105], v[50:51], v[38:39], v[104:105] op_sel_hi:[1,0,1]
    v_pk_fma_f32 v[106:107], v[52:53], v[38:39], v[106:107] op_sel_hi:[1,0,1]
    v_pk_fma_f32 v[124:125], v[54:55], v[38:39], v[124:125] op_sel_hi:[1,0,1]
    v_pk_fma_f32 v[126:127], v[56:57], v[38:39], v[126:127] op_sel_hi:[1,0,1]
    v_pk_mul_f32 v[66:67], v[104:105], v[38:39] op_sel:[0,1] op_sel_hi:[1,1]
    v_pk_mul_f32 v[68:69], v[106:107], v[38:39] op_sel:[0,1] op_sel_hi:[1,1]
    v_pk_mul_f32 v[70:71], v[124:125], v[38:39] op_sel:[0,1] op_sel_hi:[1,1]
    v_readlane_b32 s81, v90, 5
    s_waitcnt lgkmcnt(13)
    s_add_u32 m0, s85, 65536
    s_nop 2
    buffer_load_dwordx4 v15, s[96:99], s81 offen offset:0 lds
    v_pk_mul_f32 v[72:73], v[126:127], v[38:39] op_sel:[0,1] op_sel_hi:[1,1]
    v_exp_f32 v66, v66
    v_exp_f32 v67, v67
    v_pk_fma_f32 v[144:145], v[58:59], v[38:39], v[144:145] op_sel_hi:[1,0,1]
    v_exp_f32 v68, v68
    v_exp_f32 v69, v69
    v_pk_fma_f32 v[146:147], v[60:61], v[38:39], v[146:147] op_sel_hi:[1,0,1]
    v_exp_f32 v70, v70
    v_exp_f32 v71, v71
    v_pk_fma_f32 v[164:165], v[62:63], v[38:39], v[164:165] op_sel_hi:[1,0,1]
    v_exp_f32 v72, v72
    v_exp_f32 v73, v73
    v_pk_fma_f32 v[166:167], v[64:65], v[38:39], v[166:167] op_sel_hi:[1,0,1]
    v_pk_fma_f32 v[66:67], v[66:67], v[40:41], v[40:41] op_sel_hi:[1,0,0]
    buffer_load_dwordx4 v16, s[96:99], s81 offen offset:1024 lds
    v_pk_fma_f32 v[68:69], v[68:69], v[40:41], v[40:41] op_sel_hi:[1,0,0]
    v_pk_fma_f32 v[70:71], v[70:71], v[40:41], v[40:41] op_sel_hi:[1,0,0]
    v_pk_fma_f32 v[72:73], v[72:73], v[40:41], v[40:41] op_sel_hi:[1,0,0]
    v_rcp_f32 v66, v66
    v_rcp_f32 v67, v67
    v_pk_mul_f32 v[104:105], v[104:105], v[144:145]
    v_rcp_f32 v68, v68
    v_rcp_f32 v69, v69
    v_pk_mul_f32 v[106:107], v[106:107], v[146:147]
    v_rcp_f32 v70, v70
    v_rcp_f32 v71, v71
    v_pk_mul_f32 v[124:125], v[124:125], v[164:165]
    v_rcp_f32 v72, v72
    v_rcp_f32 v73, v73
    buffer_load_dwordx4 v17, s[96:99], s81 offen offset:2048 lds
    v_pk_mul_f32 v[126:127], v[126:127], v[166:167]
    v_pk_mul_f32 v[104:105], v[104:105], v[66:67]
    v_pk_mul_f32 v[106:107], v[106:107], v[68:69]
    v_pk_mul_f32 v[124:125], v[124:125], v[70:71]
    v_pk_mul_f32 v[126:127], v[126:127], v[72:73]
    v_cvt_pk_bf16_f32 v104, v104, v105
    v_cvt_pk_bf16_f32 v105, v106, v107
    v_cvt_pk_bf16_f32 v106, v124, v125
    v_cvt_pk_bf16_f32 v107, v126, v127
    buffer_store_dwordx4 v[104:107], v8, s[60:63], s101 offen sc1
    v_pk_fma_f32 v[108:109], v[50:51], v[42:43], v[108:109] op_sel_hi:[1,0,1]
    v_pk_fma_f32 v[110:111], v[52:53], v[42:43], v[110:111] op_sel_hi:[1,0,1]
    v_pk_fma_f32 v[128:129], v[54:55], v[42:43], v[128:129] op_sel_hi:[1,0,1]
    buffer_load_dwordx4 v18, s[96:99], s81 offen offset:3072 lds
    v_pk_fma_f32 v[130:131], v[56:57], v[42:43], v[130:131] op_sel_hi:[1,0,1]
    v_pk_mul_f32 v[66:67], v[108:109], v[42:43] op_sel:[0,1] op_sel_hi:[1,1]
    v_pk_mul_f32 v[68:69], v[110:111], v[42:43] op_sel:[0,1] op_sel_hi:[1,1]
    v_pk_mul_f32 v[70:71], v[128:129], v[42:43] op_sel:[0,1] op_sel_hi:[1,1]
    v_pk_mul_f32 v[72:73], v[130:131], v[42:43] op_sel:[0,1] op_sel_hi:[1,1]
    v_exp_f32 v66, v66
    v_exp_f32 v67, v67
    v_pk_fma_f32 v[148:149], v[58:59], v[42:43], v[148:149] op_sel_hi:[1,0,1]
    v_exp_f32 v68, v68
    v_exp_f32 v69, v69
    v_pk_fma_f32 v[150:151], v[60:61], v[42:43], v[150:151] op_sel_hi:[1,0,1]
    v_exp_f32 v70, v70
    v_exp_f32 v71, v71
    v_pk_fma_f32 v[168:169], v[62:63], v[42:43], v[168:169] op_sel_hi:[1,0,1]
    v_readlane_b32 s81, v90, 21
    s_waitcnt lgkmcnt(5)
    s_add_u32 m0, s85, 69632
    s_nop 2
    buffer_load_dwordx4 v15, s[96:99], s81 offen offset:0 lds
    v_exp_f32 v72, v72
    v_exp_f32 v73, v73
    v_pk_fma_f32 v[170:171], v[64:65], v[42:43], v[170:171] op_sel_hi:[1,0,1]
    v_pk_fma_f32 v[66:67], v[66:67], v[44:45], v[44:45] op_sel_hi:[1,0,0]
    v_pk_fma_f32 v[68:69], v[68:69], v[44:45], v[44:45] op_sel_hi:[1,0,0]
    v_pk_fma_f32 v[70:71], v[70:71], v[44:45], v[44:45] op_sel_hi:[1,0,0]
    v_pk_fma_f32 v[72:73], v[72:73], v[44:45], v[44:45] op_sel_hi:[1,0,0]
    v_rcp_f32 v66, v66
    v_rcp_f32 v67, v67
    v_pk_mul_f32 v[108:109], v[108:109], v[148:149]
    v_rcp_f32 v68, v68
    v_rcp_f32 v69, v69
    v_pk_mul_f32 v[110:111], v[110:111], v[150:151]
    v_rcp_f32_e64 v70, v70
    buffer_load_dwordx4 v16, s[96:99], s81 offen offset:1024 lds
    v_rcp_f32_e64 v71, v71
    v_pk_mul_f32 v[128:129], v[128:129], v[168:169]
    v_rcp_f32 v72, v72
    v_rcp_f32 v73, v73
    v_pk_mul_f32 v[130:131], v[130:131], v[170:171]
    v_pk_mul_f32 v[108:109], v[108:109], v[66:67]
    v_pk_mul_f32 v[110:111], v[110:111], v[68:69]
    v_pk_mul_f32 v[128:129], v[128:129], v[70:71]
    v_pk_mul_f32 v[130:131], v[130:131], v[72:73]
    v_cvt_pk_bf16_f32 v108, v108, v109
    v_cvt_pk_bf16_f32 v109, v110, v111
    v_cvt_pk_bf16_f32 v110, v128, v129
    v_cvt_pk_bf16_f32 v111, v130, v131
    buffer_store_dwordx4 v[108:111], v9, s[60:63], s101 offen sc1
    buffer_load_dwordx4 v17, s[96:99], s81 offen offset:2048 lds
    v_pk_fma_f32 v[112:113], v[50:51], v[46:47], v[112:113] op_sel_hi:[1,0,1]
    v_pk_fma_f32 v[114:115], v[52:53], v[46:47], v[114:115] op_sel_hi:[1,0,1]
    v_pk_fma_f32 v[132:133], v[54:55], v[46:47], v[132:133] op_sel_hi:[1,0,1]
    v_pk_fma_f32 v[134:135], v[56:57], v[46:47], v[134:135] op_sel_hi:[1,0,1]
    v_pk_mul_f32 v[66:67], v[112:113], v[46:47] op_sel:[0,1] op_sel_hi:[1,1]
    v_pk_mul_f32 v[68:69], v[114:115], v[46:47] op_sel:[0,1] op_sel_hi:[1,1]
    v_pk_mul_f32 v[70:71], v[132:133], v[46:47] op_sel:[0,1] op_sel_hi:[1,1]
    v_pk_mul_f32 v[72:73], v[134:135], v[46:47] op_sel:[0,1] op_sel_hi:[1,1]
    v_exp_f32 v66, v66
    v_exp_f32 v67, v67
    v_pk_fma_f32 v[152:153], v[58:59], v[46:47], v[152:153] op_sel_hi:[1,0,1]
    v_exp_f32 v68, v68
    v_exp_f32 v69, v69
    buffer_load_dwordx4 v18, s[96:99], s81 offen offset:3072 lds
    v_pk_fma_f32 v[154:155], v[60:61], v[46:47], v[154:155] op_sel_hi:[1,0,1]
    v_exp_f32 v70, v70
    v_exp_f32 v71, v71
    v_pk_fma_f32 v[172:173], v[62:63], v[46:47], v[172:173] op_sel_hi:[1,0,1]
    v_exp_f32 v72, v72
    v_exp_f32 v73, v73
    v_pk_fma_f32 v[174:175], v[64:65], v[46:47], v[174:175] op_sel_hi:[1,0,1]
    v_pk_fma_f32 v[66:67], v[66:67], v[48:49], v[48:49] op_sel_hi:[1,0,0]
    v_pk_fma_f32 v[68:69], v[68:69], v[48:49], v[48:49] op_sel_hi:[1,0,0]
    v_pk_fma_f32 v[70:71], v[70:71], v[48:49], v[48:49] op_sel_hi:[1,0,0]
    v_pk_fma_f32 v[72:73], v[72:73], v[48:49], v[48:49] op_sel_hi:[1,0,0]
    v_rcp_f32 v66, v66
    v_rcp_f32 v67, v67
    v_pk_mul_f32 v[112:113], v[112:113], v[152:153]
    v_rcp_f32 v68, v68
    v_rcp_f32 v69, v69
    v_pk_mul_f32 v[114:115], v[114:115], v[154:155]
    v_rcp_f32 v70, v70
    v_rcp_f32 v71, v71
    v_pk_mul_f32 v[132:133], v[132:133], v[172:173]
    v_rcp_f32 v72, v72
    v_rcp_f32 v73, v73
    v_pk_mul_f32 v[134:135], v[134:135], v[174:175]
    v_pk_mul_f32 v[112:113], v[112:113], v[66:67]
    v_pk_mul_f32 v[114:115], v[114:115], v[68:69]
    v_pk_mul_f32 v[132:133], v[132:133], v[70:71]
    v_pk_mul_f32 v[134:135], v[134:135], v[72:73]
    v_cvt_pk_bf16_f32 v112, v112, v113
    v_cvt_pk_bf16_f32 v113, v114, v115
    v_cvt_pk_bf16_f32 v114, v132, v133
    v_cvt_pk_bf16_f32 v115, v134, v135
    buffer_store_dwordx4 v[112:115], v10, s[60:63], s101 offen sc1
    v_mfma_f32_16x16x4_f32 v[74:77], v1, v176, 0
    ds_read_b128 v[96:99], v24 offset:0
    ds_read_b128 v[100:103], v24 offset:16
    ds_read_b128 v[104:107], v24 offset:128
    v_mfma_f32_16x16x4_f32 v[78:81], v1, v196, 0
    ds_read_b128 v[108:111], v24 offset:144
    ds_read_b128 v[112:115], v24 offset:256
    v_mfma_f32_16x16x4_f32 v[82:85], v1, v216, 0
    ds_read_b128 v[116:119], v24 offset:272
    ds_read_b128 v[120:123], v24 offset:384
    ds_read_b128 v[124:127], v24 offset:400
    v_mfma_f32_16x16x4_f32 v[86:89], v1, v236, 0
    ds_read_b128 v[128:131], v24 offset:512
    ds_read_b128 v[132:135], v24 offset:528
    s_waitcnt vmcnt(30)
    s_nop 0
    v_accvgpr_read_b32 v50, a226
    v_accvgpr_read_b32 v51, a227
    v_accvgpr_read_b32 v52, a238
    v_accvgpr_read_b32 v53, a239
    v_accvgpr_read_b32 v54, a224
    v_accvgpr_read_b32 v55, a225
    v_accvgpr_read_b32 v56, a236
    v_accvgpr_read_b32 v57, a237
    s_waitcnt lgkmcnt(0)
    s_nop 0
    v_pk_mul_f32 v[2:3], v[50:51], v[74:75] op_sel_hi:[1,0]
    v_pk_fma_f32 v[2:3], v[50:51], v[82:83], v[2:3] op_sel:[1,0,0] op_sel_hi:[0,0,1] neg_hi:[1,0,0]
    v_pk_mul_f32 v[4:5], v[52:53], v[78:79] op_sel_hi:[1,0]
    v_pk_fma_f32 v[4:5], v[52:53], v[86:87], v[4:5] op_sel:[1,0,0] op_sel_hi:[0,0,1] neg_hi:[1,0,0]
    v_pk_mul_f32 v[74:75], v[50:51], v[176:177] op_sel:[0,0] op_sel_hi:[1,0]
    v_pk_mul_f32 v[76:77], v[52:53], v[196:197] op_sel:[0,0] op_sel_hi:[1,0]
    v_pk_mul_f32 v[78:79], v[50:51], v[176:177] op_sel:[0,1] op_sel_hi:[1,1]
    v_readlane_b32 s81, v90, 6
    s_add_u32 m0, s85, 98304
    s_nop 3
    s_nop 0
    buffer_load_dwordx4 v15, s[96:99], s81 offen offset:0 lds
    v_pk_mul_f32 v[80:81], v[52:53], v[196:197] op_sel:[0,1] op_sel_hi:[1,1]
    v_pk_fma_f32 v[176:177], v[50:51], v[216:217], v[74:75] op_sel:[1,0,0] op_sel_hi:[0,0,1] neg_hi:[1,0,0]
    v_pk_fma_f32 v[196:197], v[52:53], v[236:237], v[76:77] op_sel:[1,0,0] op_sel_hi:[0,0,1] neg_hi:[1,0,0]
    v_pk_fma_f32 v[216:217], v[50:51], v[216:217], v[78:79] op_sel:[1,1,0] op_sel_hi:[0,1,1] neg_hi:[1,0,0]
    v_pk_fma_f32 v[236:237], v[52:53], v[236:237], v[80:81] op_sel:[1,1,0] op_sel_hi:[0,1,1] neg_hi:[1,0,0]
    v_pk_fma_f32 v[176:177], v[2:3], v[96:97], v[176:177] op_sel_hi:[1,0,1]
    v_pk_fma_f32 v[196:197], v[4:5], v[96:97], v[196:197] op_sel_hi:[1,0,1]
    v_pk_fma_f32 v[216:217], v[2:3], v[98:99], v[216:217] op_sel_hi:[1,0,1]
    v_pk_fma_f32 v[236:237], v[4:5], v[98:99], v[236:237] op_sel_hi:[1,0,1]
    v_pk_mul_f32 v[176:177], v[176:177], v[96:97] op_sel:[0,1] op_sel_hi:[1,1]
    v_pk_mul_f32 v[196:197], v[196:197], v[96:97] op_sel:[0,1] op_sel_hi:[1,1]
    v_pk_mul_f32 v[216:217], v[216:217], v[98:99] op_sel:[0,1] op_sel_hi:[1,1]
    v_pk_mul_f32 v[236:237], v[236:237], v[98:99] op_sel:[0,1] op_sel_hi:[1,1]
    v_pk_fma_f32 v[86:87], v[176:177], v[54:55], v[216:217] op_sel_hi:[1,0,1]
    v_pk_fma_f32 v[88:89], v[196:197], v[56:57], v[236:237] op_sel_hi:[1,0,1]
    v_pk_fma_f32 v[82:83], v[176:177], v[54:55], v[86:87] op_sel:[1,1,0] op_sel_hi:[0,1,1] neg_lo:[1,0,0]
    v_pk_fma_f32 v[84:85], v[196:197], v[56:57], v[88:89] op_sel:[1,1,0] op_sel_hi:[0,1,1] neg_lo:[1,0,0]
    v_pk_mul_f32 v[74:75], v[50:51], v[178:179] op_sel:[0,0] op_sel_hi:[1,0]
    buffer_load_dwordx4 v16, s[96:99], s81 offen offset:1024 lds
    v_pk_mul_f32 v[76:77], v[52:53], v[198:199] op_sel:[0,0] op_sel_hi:[1,0]
    v_pk_mul_f32 v[78:79], v[50:51], v[178:179] op_sel:[0,1] op_sel_hi:[1,1]
    v_pk_mul_f32 v[80:81], v[52:53], v[198:199] op_sel:[0,1] op_sel_hi:[1,1]
    v_pk_fma_f32 v[178:179], v[50:51], v[218:219], v[74:75] op_sel:[1,0,0] op_sel_hi:[0,0,1] neg_hi:[1,0,0]
    v_pk_fma_f32 v[198:199], v[52:53], v[238:239], v[76:77] op_sel:[1,0,0] op_sel_hi:[0,0,1] neg_hi:[1,0,0]
    v_pk_fma_f32 v[218:219], v[50:51], v[218:219], v[78:79] op_sel:[1,1,0] op_sel_hi:[0,1,1] neg_hi:[1,0,0]
    v_pk_fma_f32 v[238:239], v[52:53], v[238:239], v[80:81] op_sel:[1,1,0] op_sel_hi:[0,1,1] neg_hi:[1,0,0]
    v_pk_fma_f32 v[178:179], v[2:3], v[100:101], v[178:179] op_sel_hi:[1,0,1]
    v_pk_fma_f32 v[198:199], v[4:5], v[100:101], v[198:199] op_sel_hi:[1,0,1]
    v_pk_fma_f32 v[218:219], v[2:3], v[102:103], v[218:219] op_sel_hi:[1,0,1]
    v_pk_fma_f32 v[238:239], v[4:5], v[102:103], v[238:239] op_sel_hi:[1,0,1]
    v_pk_mul_f32 v[178:179], v[178:179], v[100:101] op_sel:[0,1] op_sel_hi:[1,1]
    v_pk_mul_f32 v[198:199], v[198:199], v[100:101] op_sel:[0,1] op_sel_hi:[1,1]
    v_pk_mul_f32 v[218:219], v[218:219], v[102:103] op_sel:[0,1] op_sel_hi:[1,1]
    v_pk_mul_f32 v[238:239], v[238:239], v[102:103] op_sel:[0,1] op_sel_hi:[1,1]
    v_pk_fma_f32 v[86:87], v[82:83], v[54:55], v[178:179] op_sel_hi:[1,0,1]
    v_pk_fma_f32 v[88:89], v[84:85], v[56:57], v[198:199] op_sel_hi:[1,0,1]
    v_pk_fma_f32 v[82:83], v[82:83], v[54:55], v[86:87] op_sel:[1,1,0] op_sel_hi:[0,1,1] neg_lo:[1,0,0]
    buffer_load_dwordx4 v17, s[96:99], s81 offen offset:2048 lds
    v_pk_fma_f32 v[84:85], v[84:85], v[56:57], v[88:89] op_sel:[1,1,0] op_sel_hi:[0,1,1] neg_lo:[1,0,0]
    v_pk_fma_f32 v[86:87], v[82:83], v[54:55], v[218:219] op_sel_hi:[1,0,1]
    v_pk_fma_f32 v[88:89], v[84:85], v[56:57], v[238:239] op_sel_hi:[1,0,1]
    v_pk_fma_f32 v[82:83], v[82:83], v[54:55], v[86:87] op_sel:[1,1,0] op_sel_hi:[0,1,1] neg_lo:[1,0,0]
    v_pk_fma_f32 v[84:85], v[84:85], v[56:57], v[88:89] op_sel:[1,1,0] op_sel_hi:[0,1,1] neg_lo:[1,0,0]
    v_pk_mul_f32 v[74:75], v[50:51], v[180:181] op_sel:[0,0] op_sel_hi:[1,0]
    v_pk_mul_f32 v[76:77], v[52:53], v[200:201] op_sel:[0,0] op_sel_hi:[1,0]
    v_pk_mul_f32 v[78:79], v[50:51], v[180:181] op_sel:[0,1] op_sel_hi:[1,1]
    v_pk_mul_f32 v[80:81], v[52:53], v[200:201] op_sel:[0,1] op_sel_hi:[1,1]
    v_pk_fma_f32 v[180:181], v[50:51], v[220:221], v[74:75] op_sel:[1,0,0] op_sel_hi:[0,0,1] neg_hi:[1,0,0]
    v_pk_fma_f32 v[200:201], v[52:53], v[240:241], v[76:77] op_sel:[1,0,0] op_sel_hi:[0,0,1] neg_hi:[1,0,0]
    v_pk_fma_f32 v[220:221], v[50:51], v[220:221], v[78:79] op_sel:[1,1,0] op_sel_hi:[0,1,1] neg_hi:[1,0,0]
    v_pk_fma_f32 v[240:241], v[52:53], v[240:241], v[80:81] op_sel:[1,1,0] op_sel_hi:[0,1,1] neg_hi:[1,0,0]
    v_pk_fma_f32 v[180:181], v[2:3], v[104:105], v[180:181] op_sel_hi:[1,0,1]
    v_pk_fma_f32 v[200:201], v[4:5], v[104:105], v[200:201] op_sel_hi:[1,0,1]
    v_pk_fma_f32 v[220:221], v[2:3], v[106:107], v[220:221] op_sel_hi:[1,0,1]
    v_pk_fma_f32 v[240:241], v[4:5], v[106:107], v[240:241] op_sel_hi:[1,0,1]
    v_pk_mul_f32 v[180:181], v[180:181], v[104:105] op_sel:[0,1] op_sel_hi:[1,1]
    buffer_load_dwordx4 v18, s[96:99], s81 offen offset:3072 lds
    v_pk_mul_f32 v[200:201], v[200:201], v[104:105] op_sel:[0,1] op_sel_hi:[1,1]
    v_pk_mul_f32 v[220:221], v[220:221], v[106:107] op_sel:[0,1] op_sel_hi:[1,1]
    v_pk_mul_f32 v[240:241], v[240:241], v[106:107] op_sel:[0,1] op_sel_hi:[1,1]
    v_pk_fma_f32 v[86:87], v[82:83], v[54:55], v[180:181] op_sel_hi:[1,0,1]
    v_pk_fma_f32 v[88:89], v[84:85], v[56:57], v[200:201] op_sel_hi:[1,0,1]
    v_pk_fma_f32 v[82:83], v[82:83], v[54:55], v[86:87] op_sel:[1,1,0] op_sel_hi:[0,1,1] neg_lo:[1,0,0]
    v_pk_fma_f32 v[84:85], v[84:85], v[56:57], v[88:89] op_sel:[1,1,0] op_sel_hi:[0,1,1] neg_lo:[1,0,0]
    v_pk_fma_f32 v[86:87], v[82:83], v[54:55], v[220:221] op_sel_hi:[1,0,1]
    v_pk_fma_f32 v[88:89], v[84:85], v[56:57], v[240:241] op_sel_hi:[1,0,1]
    v_pk_fma_f32 v[82:83], v[82:83], v[54:55], v[86:87] op_sel:[1,1,0] op_sel_hi:[0,1,1] neg_lo:[1,0,0]
    v_pk_fma_f32 v[84:85], v[84:85], v[56:57], v[88:89] op_sel:[1,1,0] op_sel_hi:[0,1,1] neg_lo:[1,0,0]
    v_pk_mul_f32 v[74:75], v[50:51], v[182:183] op_sel:[0,0] op_sel_hi:[1,0]
    v_pk_mul_f32 v[76:77], v[52:53], v[202:203] op_sel:[0,0] op_sel_hi:[1,0]
    v_pk_mul_f32 v[78:79], v[50:51], v[182:183] op_sel:[0,1] op_sel_hi:[1,1]
    v_pk_mul_f32 v[80:81], v[52:53], v[202:203] op_sel:[0,1] op_sel_hi:[1,1]
    v_pk_fma_f32 v[182:183], v[50:51], v[222:223], v[74:75] op_sel:[1,0,0] op_sel_hi:[0,0,1] neg_hi:[1,0,0]
    v_pk_fma_f32 v[202:203], v[52:53], v[242:243], v[76:77] op_sel:[1,0,0] op_sel_hi:[0,0,1] neg_hi:[1,0,0]
    v_pk_fma_f32 v[222:223], v[50:51], v[222:223], v[78:79] op_sel:[1,1,0] op_sel_hi:[0,1,1] neg_hi:[1,0,0]
    v_readlane_b32 s81, v90, 22
    s_add_u32 m0, s85, 102400
    s_nop 3
    buffer_load_dwordx4 v15, s[96:99], s81 offen offset:0 lds
    s_add_u32 s89, s85, 131072
    v_add_u32 v11, s89, v92
    v_xor_b32 v12, 32, v11
    v_xor_b32 v13, 64, v11
    v_xor_b32 v14, 96, v11
    ds_read_b64_tr_b16 a[192:193], v11 offset:0
    ds_read_b64_tr_b16 a[194:195], v11 offset:2048
    ds_read_b64_tr_b16 a[196:197], v12 offset:0
    ds_read_b64_tr_b16 a[198:199], v12 offset:2048
    ds_read_b64_tr_b16 a[200:201], v13 offset:0
    ds_read_b64_tr_b16 a[202:203], v13 offset:2048
    ds_read_b64_tr_b16 a[204:205], v14 offset:0
    ds_read_b64_tr_b16 a[206:207], v14 offset:2048
    s_waitcnt vmcnt(34)
    s_nop 0
    ds_read_b64_tr_b16 a[208:209], v11 offset:4096
    ds_read_b64_tr_b16 a[210:211], v11 offset:6144
    ds_read_b64_tr_b16 a[212:213], v12 offset:4096
    ds_read_b64_tr_b16 a[214:215], v12 offset:6144
    ds_read_b64_tr_b16 a[216:217], v13 offset:4096
    ds_read_b64_tr_b16 a[218:219], v13 offset:6144
    ds_read_b64_tr_b16 a[220:221], v14 offset:4096
    ds_read_b64_tr_b16 a[222:223], v14 offset:6144
    v_pk_fma_f32 v[242:243], v[52:53], v[242:243], v[80:81] op_sel:[1,1,0] op_sel_hi:[0,1,1] neg_hi:[1,0,0]
    v_pk_fma_f32 v[182:183], v[2:3], v[108:109], v[182:183] op_sel_hi:[1,0,1]
    v_pk_fma_f32 v[202:203], v[4:5], v[108:109], v[202:203] op_sel_hi:[1,0,1]
    v_pk_fma_f32 v[222:223], v[2:3], v[110:111], v[222:223] op_sel_hi:[1,0,1]
    v_pk_fma_f32 v[242:243], v[4:5], v[110:111], v[242:243] op_sel_hi:[1,0,1]
    v_pk_mul_f32 v[182:183], v[182:183], v[108:109] op_sel:[0,1] op_sel_hi:[1,1]
    v_pk_mul_f32 v[202:203], v[202:203], v[108:109] op_sel:[0,1] op_sel_hi:[1,1]
    v_pk_mul_f32 v[222:223], v[222:223], v[110:111] op_sel:[0,1] op_sel_hi:[1,1]
    v_pk_mul_f32 v[242:243], v[242:243], v[110:111] op_sel:[0,1] op_sel_hi:[1,1]
    v_pk_fma_f32 v[86:87], v[82:83], v[54:55], v[182:183] op_sel_hi:[1,0,1]
    v_pk_fma_f32 v[88:89], v[84:85], v[56:57], v[202:203] op_sel_hi:[1,0,1]
    v_pk_fma_f32 v[82:83], v[82:83], v[54:55], v[86:87] op_sel:[1,1,0] op_sel_hi:[0,1,1] neg_lo:[1,0,0]
    v_pk_fma_f32 v[84:85], v[84:85], v[56:57], v[88:89] op_sel:[1,1,0] op_sel_hi:[0,1,1] neg_lo:[1,0,0]
    v_pk_fma_f32 v[86:87], v[82:83], v[54:55], v[222:223] op_sel_hi:[1,0,1]
    v_pk_fma_f32 v[88:89], v[84:85], v[56:57], v[242:243] op_sel_hi:[1,0,1]
    v_pk_fma_f32 v[82:83], v[82:83], v[54:55], v[86:87] op_sel:[1,1,0] op_sel_hi:[0,1,1] neg_lo:[1,0,0]
    v_pk_fma_f32 v[84:85], v[84:85], v[56:57], v[88:89] op_sel:[1,1,0] op_sel_hi:[0,1,1] neg_lo:[1,0,0]
    v_pk_mul_f32 v[74:75], v[50:51], v[184:185] op_sel:[0,0] op_sel_hi:[1,0]
    buffer_load_dwordx4 v16, s[96:99], s81 offen offset:1024 lds
    v_pk_mul_f32 v[76:77], v[52:53], v[204:205] op_sel:[0,0] op_sel_hi:[1,0]
    v_pk_mul_f32 v[78:79], v[50:51], v[184:185] op_sel:[0,1] op_sel_hi:[1,1]
    v_pk_mul_f32 v[80:81], v[52:53], v[204:205] op_sel:[0,1] op_sel_hi:[1,1]
    v_pk_fma_f32 v[184:185], v[50:51], v[224:225], v[74:75] op_sel:[1,0,0] op_sel_hi:[0,0,1] neg_hi:[1,0,0]
    v_pk_fma_f32 v[204:205], v[52:53], v[244:245], v[76:77] op_sel:[1,0,0] op_sel_hi:[0,0,1] neg_hi:[1,0,0]
    v_pk_fma_f32 v[224:225], v[50:51], v[224:225], v[78:79] op_sel:[1,1,0] op_sel_hi:[0,1,1] neg_hi:[1,0,0]
    v_pk_fma_f32 v[244:245], v[52:53], v[244:245], v[80:81] op_sel:[1,1,0] op_sel_hi:[0,1,1] neg_hi:[1,0,0]
    v_pk_fma_f32 v[184:185], v[2:3], v[112:113], v[184:185] op_sel_hi:[1,0,1]
    v_pk_fma_f32 v[204:205], v[4:5], v[112:113], v[204:205] op_sel_hi:[1,0,1]
    v_pk_fma_f32 v[224:225], v[2:3], v[114:115], v[224:225] op_sel_hi:[1,0,1]
    v_pk_fma_f32 v[244:245], v[4:5], v[114:115], v[244:245] op_sel_hi:[1,0,1]
    v_pk_mul_f32 v[184:185], v[184:185], v[112:113] op_sel:[0,1] op_sel_hi:[1,1]
    v_pk_mul_f32 v[204:205], v[204:205], v[112:113] op_sel:[0,1] op_sel_hi:[1,1]
    v_pk_mul_f32 v[224:225], v[224:225], v[114:115] op_sel:[0,1] op_sel_hi:[1,1]
    v_pk_mul_f32 v[244:245], v[244:245], v[114:115] op_sel:[0,1] op_sel_hi:[1,1]
    v_pk_fma_f32 v[86:87], v[82:83], v[54:55], v[184:185] op_sel_hi:[1,0,1]
    v_pk_fma_f32 v[88:89], v[84:85], v[56:57], v[204:205] op_sel_hi:[1,0,1]
    v_pk_fma_f32 v[82:83], v[82:83], v[54:55], v[86:87] op_sel:[1,1,0] op_sel_hi:[0,1,1] neg_lo:[1,0,0]
    buffer_load_dwordx4 v17, s[96:99], s81 offen offset:2048 lds
    v_pk_fma_f32 v[84:85], v[84:85], v[56:57], v[88:89] op_sel:[1,1,0] op_sel_hi:[0,1,1] neg_lo:[1,0,0]
    v_pk_fma_f32 v[86:87], v[82:83], v[54:55], v[224:225] op_sel_hi:[1,0,1]
    v_pk_fma_f32 v[88:89], v[84:85], v[56:57], v[244:245] op_sel_hi:[1,0,1]
    v_pk_fma_f32 v[82:83], v[82:83], v[54:55], v[86:87] op_sel:[1,1,0] op_sel_hi:[0,1,1] neg_lo:[1,0,0]
    v_pk_fma_f32 v[84:85], v[84:85], v[56:57], v[88:89] op_sel:[1,1,0] op_sel_hi:[0,1,1] neg_lo:[1,0,0]
    v_pk_mul_f32 v[74:75], v[50:51], v[186:187] op_sel:[0,0] op_sel_hi:[1,0]
    v_pk_mul_f32 v[76:77], v[52:53], v[206:207] op_sel:[0,0] op_sel_hi:[1,0]
    v_pk_mul_f32 v[78:79], v[50:51], v[186:187] op_sel:[0,1] op_sel_hi:[1,1]
    v_pk_mul_f32 v[80:81], v[52:53], v[206:207] op_sel:[0,1] op_sel_hi:[1,1]
    v_pk_fma_f32 v[186:187], v[50:51], v[226:227], v[74:75] op_sel:[1,0,0] op_sel_hi:[0,0,1] neg_hi:[1,0,0]
    v_pk_fma_f32 v[206:207], v[52:53], v[246:247], v[76:77] op_sel:[1,0,0] op_sel_hi:[0,0,1] neg_hi:[1,0,0]
    v_pk_fma_f32 v[226:227], v[50:51], v[226:227], v[78:79] op_sel:[1,1,0] op_sel_hi:[0,1,1] neg_hi:[1,0,0]
    v_pk_fma_f32 v[246:247], v[52:53], v[246:247], v[80:81] op_sel:[1,1,0] op_sel_hi:[0,1,1] neg_hi:[1,0,0]
    v_pk_fma_f32 v[186:187], v[2:3], v[116:117], v[186:187] op_sel_hi:[1,0,1]
    v_pk_fma_f32 v[206:207], v[4:5], v[116:117], v[206:207] op_sel_hi:[1,0,1]
    v_pk_fma_f32 v[226:227], v[2:3], v[118:119], v[226:227] op_sel_hi:[1,0,1]
    v_pk_fma_f32 v[246:247], v[4:5], v[118:119], v[246:247] op_sel_hi:[1,0,1]
    v_pk_mul_f32 v[186:187], v[186:187], v[116:117] op_sel:[0,1] op_sel_hi:[1,1]
    buffer_load_dwordx4 v18, s[96:99], s81 offen offset:3072 lds
    v_pk_mul_f32 v[206:207], v[206:207], v[116:117] op_sel:[0,1] op_sel_hi:[1,1]
    v_pk_mul_f32 v[226:227], v[226:227], v[118:119] op_sel:[0,1] op_sel_hi:[1,1]
    v_pk_mul_f32 v[246:247], v[246:247], v[118:119] op_sel:[0,1] op_sel_hi:[1,1]
    v_pk_fma_f32 v[86:87], v[82:83], v[54:55], v[186:187] op_sel_hi:[1,0,1]
    v_pk_fma_f32 v[88:89], v[84:85], v[56:57], v[206:207] op_sel_hi:[1,0,1]
    v_pk_fma_f32 v[82:83], v[82:83], v[54:55], v[86:87] op_sel:[1,1,0] op_sel_hi:[0,1,1] neg_lo:[1,0,0]
    v_pk_fma_f32 v[84:85], v[84:85], v[56:57], v[88:89] op_sel:[1,1,0] op_sel_hi:[0,1,1] neg_lo:[1,0,0]
    v_pk_fma_f32 v[86:87], v[82:83], v[54:55], v[226:227] op_sel_hi:[1,0,1]
    v_pk_fma_f32 v[88:89], v[84:85], v[56:57], v[246:247] op_sel_hi:[1,0,1]
    v_pk_fma_f32 v[82:83], v[82:83], v[54:55], v[86:87] op_sel:[1,1,0] op_sel_hi:[0,1,1] neg_lo:[1,0,0]
    v_pk_fma_f32 v[84:85], v[84:85], v[56:57], v[88:89] op_sel:[1,1,0] op_sel_hi:[0,1,1] neg_lo:[1,0,0]
    s_waitcnt vmcnt(8)
    s_mov_b32 exec_hi, 0
    buffer_store_dword v29, v94, s[44:47], s77 offen sc1
    s_mov_b32 exec_hi, -1
    s_nop 0
    v_pk_mul_f32 v[74:75], v[50:51], v[188:189] op_sel:[0,0] op_sel_hi:[1,0]
    v_pk_mul_f32 v[76:77], v[52:53], v[208:209] op_sel:[0,0] op_sel_hi:[1,0]
    v_pk_mul_f32 v[78:79], v[50:51], v[188:189] op_sel:[0,1] op_sel_hi:[1,1]
    v_pk_mul_f32 v[80:81], v[52:53], v[208:209] op_sel:[0,1] op_sel_hi:[1,1]
    v_pk_fma_f32 v[188:189], v[50:51], v[228:229], v[74:75] op_sel:[1,0,0] op_sel_hi:[0,0,1] neg_hi:[1,0,0]
    v_pk_fma_f32 v[208:209], v[52:53], v[248:249], v[76:77] op_sel:[1,0,0] op_sel_hi:[0,0,1] neg_hi:[1,0,0]
    v_readlane_b32 s81, v90, 7
    s_waitcnt lgkmcnt(8)
    s_add_u32 m0, s85, 131072
    s_nop 2
    buffer_load_dwordx4 v19, s[52:55], s81 offen offset:0 lds
    v_pk_fma_f32 v[228:229], v[50:51], v[228:229], v[78:79] op_sel:[1,1,0] op_sel_hi:[0,1,1] neg_hi:[1,0,0]
    v_pk_fma_f32 v[248:249], v[52:53], v[248:249], v[80:81] op_sel:[1,1,0] op_sel_hi:[0,1,1] neg_hi:[1,0,0]
    v_pk_fma_f32 v[188:189], v[2:3], v[120:121], v[188:189] op_sel_hi:[1,0,1]
    v_pk_fma_f32 v[208:209], v[4:5], v[120:121], v[208:209] op_sel_hi:[1,0,1]
    v_pk_fma_f32 v[228:229], v[2:3], v[122:123], v[228:229] op_sel_hi:[1,0,1]
    v_pk_fma_f32 v[248:249], v[4:5], v[122:123], v[248:249] op_sel_hi:[1,0,1]
    v_pk_mul_f32 v[188:189], v[188:189], v[120:121] op_sel:[0,1] op_sel_hi:[1,1]
    v_pk_mul_f32 v[208:209], v[208:209], v[120:121] op_sel:[0,1] op_sel_hi:[1,1]
    v_pk_mul_f32 v[228:229], v[228:229], v[122:123] op_sel:[0,1] op_sel_hi:[1,1]
    v_pk_mul_f32 v[248:249], v[248:249], v[122:123] op_sel:[0,1] op_sel_hi:[1,1]
    v_pk_fma_f32 v[86:87], v[82:83], v[54:55], v[188:189] op_sel_hi:[1,0,1]
    v_pk_fma_f32 v[88:89], v[84:85], v[56:57], v[208:209] op_sel_hi:[1,0,1]
    v_pk_fma_f32 v[82:83], v[82:83], v[54:55], v[86:87] op_sel:[1,1,0] op_sel_hi:[0,1,1] neg_lo:[1,0,0]
    v_pk_fma_f32 v[84:85], v[84:85], v[56:57], v[88:89] op_sel:[1,1,0] op_sel_hi:[0,1,1] neg_lo:[1,0,0]
    v_pk_fma_f32 v[86:87], v[82:83], v[54:55], v[228:229] op_sel_hi:[1,0,1]
    v_pk_fma_f32 v[88:89], v[84:85], v[56:57], v[248:249] op_sel_hi:[1,0,1]
    v_pk_fma_f32 v[82:83], v[82:83], v[54:55], v[86:87] op_sel:[1,1,0] op_sel_hi:[0,1,1] neg_lo:[1,0,0]
    v_pk_fma_f32 v[84:85], v[84:85], v[56:57], v[88:89] op_sel:[1,1,0] op_sel_hi:[0,1,1] neg_lo:[1,0,0]
    buffer_load_dwordx4 v20, s[52:55], s81 offen offset:1024 lds
    v_pk_mul_f32 v[74:75], v[50:51], v[190:191] op_sel:[0,0] op_sel_hi:[1,0]
    v_pk_mul_f32 v[76:77], v[52:53], v[210:211] op_sel:[0,0] op_sel_hi:[1,0]
    v_pk_mul_f32 v[78:79], v[50:51], v[190:191] op_sel:[0,1] op_sel_hi:[1,1]
    v_pk_mul_f32 v[80:81], v[52:53], v[210:211] op_sel:[0,1] op_sel_hi:[1,1]
    v_pk_fma_f32 v[190:191], v[50:51], v[230:231], v[74:75] op_sel:[1,0,0] op_sel_hi:[0,0,1] neg_hi:[1,0,0]
    v_pk_fma_f32 v[210:211], v[52:53], v[250:251], v[76:77] op_sel:[1,0,0] op_sel_hi:[0,0,1] neg_hi:[1,0,0]
    v_pk_fma_f32 v[230:231], v[50:51], v[230:231], v[78:79] op_sel:[1,1,0] op_sel_hi:[0,1,1] neg_hi:[1,0,0]
    v_pk_fma_f32 v[250:251], v[52:53], v[250:251], v[80:81] op_sel:[1,1,0] op_sel_hi:[0,1,1] neg_hi:[1,0,0]
    v_pk_fma_f32 v[190:191], v[2:3], v[124:125], v[190:191] op_sel_hi:[1,0,1]
    v_pk_fma_f32 v[210:211], v[4:5], v[124:125], v[210:211] op_sel_hi:[1,0,1]
    v_pk_fma_f32 v[230:231], v[2:3], v[126:127], v[230:231] op_sel_hi:[1,0,1]
    v_pk_fma_f32 v[250:251], v[4:5], v[126:127], v[250:251] op_sel_hi:[1,0,1]
    v_pk_mul_f32 v[190:191], v[190:191], v[124:125] op_sel:[0,1] op_sel_hi:[1,1]
    v_pk_mul_f32 v[210:211], v[210:211], v[124:125] op_sel:[0,1] op_sel_hi:[1,1]
    v_pk_mul_f32 v[230:231], v[230:231], v[126:127] op_sel:[0,1] op_sel_hi:[1,1]
    v_pk_mul_f32 v[250:251], v[250:251], v[126:127] op_sel:[0,1] op_sel_hi:[1,1]
    v_pk_fma_f32 v[86:87], v[82:83], v[54:55], v[190:191] op_sel_hi:[1,0,1]
    v_pk_fma_f32 v[88:89], v[84:85], v[56:57], v[210:211] op_sel_hi:[1,0,1]
    buffer_load_dwordx4 v21, s[52:55], s81 offen offset:2048 lds
    v_pk_fma_f32 v[82:83], v[82:83], v[54:55], v[86:87] op_sel:[1,1,0] op_sel_hi:[0,1,1] neg_lo:[1,0,0]
    v_pk_fma_f32 v[84:85], v[84:85], v[56:57], v[88:89] op_sel:[1,1,0] op_sel_hi:[0,1,1] neg_lo:[1,0,0]
    v_pk_fma_f32 v[86:87], v[82:83], v[54:55], v[230:231] op_sel_hi:[1,0,1]
    v_pk_fma_f32 v[88:89], v[84:85], v[56:57], v[250:251] op_sel_hi:[1,0,1]
    v_pk_fma_f32 v[82:83], v[82:83], v[54:55], v[86:87] op_sel:[1,1,0] op_sel_hi:[0,1,1] neg_lo:[1,0,0]
    v_pk_fma_f32 v[84:85], v[84:85], v[56:57], v[88:89] op_sel:[1,1,0] op_sel_hi:[0,1,1] neg_lo:[1,0,0]
    v_bfe_u32 v23, v0, 2, 2
    v_and_b32_e64 v24, 3, v0
    v_add3_u32 v24, v24, v95, 1
L_pad11:
    s_cbranch_execz L_pad15
    s_nop 0
    v_cmp_eq_u32 vcc, v23, v24
    v_and_b32 v23, 15, v0
    v_mul_u32_u24 v24, 5120, v95
    v_cndmask_b32 v1, 0, 1.0, vcc
    v_pk_mul_f32 v[74:75], v[50:51], v[192:193] op_sel:[0,0] op_sel_hi:[1,0]
    v_pk_mul_f32 v[76:77], v[52:53], v[212:213] op_sel:[0,0] op_sel_hi:[1,0]
    v_pk_mul_f32 v[78:79], v[50:51], v[192:193] op_sel:[0,1] op_sel_hi:[1,1]
    v_pk_mul_f32 v[80:81], v[52:53], v[212:213] op_sel:[0,1] op_sel_hi:[1,1]
    v_pk_fma_f32 v[192:193], v[50:51], v[232:233], v[74:75] op_sel:[1,0,0] op_sel_hi:[0,0,1] neg_hi:[1,0,0]
    buffer_load_dwordx4 v22, s[52:55], s81 offen offset:3072 lds
    v_pk_fma_f32 v[212:213], v[52:53], v[252:253], v[76:77] op_sel:[1,0,0] op_sel_hi:[0,0,1] neg_hi:[1,0,0]
    v_pk_fma_f32 v[232:233], v[50:51], v[232:233], v[78:79] op_sel:[1,1,0] op_sel_hi:[0,1,1] neg_hi:[1,0,0]
    v_pk_fma_f32 v[252:253], v[52:53], v[252:253], v[80:81] op_sel:[1,1,0] op_sel_hi:[0,1,1] neg_hi:[1,0,0]
    v_pk_fma_f32 v[192:193], v[2:3], v[128:129], v[192:193] op_sel_hi:[1,0,1]
    v_pk_fma_f32 v[212:213], v[4:5], v[128:129], v[212:213] op_sel_hi:[1,0,1]
    v_pk_fma_f32 v[232:233], v[2:3], v[130:131], v[232:233] op_sel_hi:[1,0,1]
    v_pk_fma_f32 v[252:253], v[4:5], v[130:131], v[252:253] op_sel_hi:[1,0,1]
    v_pk_mul_f32 v[192:193], v[192:193], v[128:129] op_sel:[0,1] op_sel_hi:[1,1]
    v_pk_mul_f32 v[212:213], v[212:213], v[128:129] op_sel:[0,1] op_sel_hi:[1,1]
    v_pk_mul_f32 v[232:233], v[232:233], v[130:131] op_sel:[0,1] op_sel_hi:[1,1]
    v_pk_mul_f32 v[252:253], v[252:253], v[130:131] op_sel:[0,1] op_sel_hi:[1,1]
    v_pk_fma_f32 v[86:87], v[82:83], v[54:55], v[192:193] op_sel_hi:[1,0,1]
    v_pk_fma_f32 v[88:89], v[84:85], v[56:57], v[212:213] op_sel_hi:[1,0,1]
    v_pk_fma_f32 v[82:83], v[82:83], v[54:55], v[86:87] op_sel:[1,1,0] op_sel_hi:[0,1,1] neg_lo:[1,0,0]
    v_pk_fma_f32 v[84:85], v[84:85], v[56:57], v[88:89] op_sel:[1,1,0] op_sel_hi:[0,1,1] neg_lo:[1,0,0]
    v_pk_fma_f32 v[86:87], v[82:83], v[54:55], v[232:233] op_sel_hi:[1,0,1]
    v_pk_fma_f32 v[88:89], v[84:85], v[56:57], v[252:253] op_sel_hi:[1,0,1]
    v_pk_fma_f32 v[82:83], v[82:83], v[54:55], v[86:87] op_sel:[1,1,0] op_sel_hi:[0,1,1] neg_lo:[1,0,0]
    v_readlane_b32 s81, v90, 23
    s_waitcnt lgkmcnt(0)
    s_add_u32 m0, s85, 135168
    s_nop 2
    buffer_load_dwordx4 v19, s[52:55], s81 offen offset:0 lds
    s_add_u32 s89, s85, 32768
    v_add_u32 v11, s89, v92
    v_xor_b32 v12, 32, v11
    v_xor_b32_e64 v13, 64, v11
    v_xor_b32 v14, 96, v11
    ds_read_b64_tr_b16 a[0:1], v11 offset:0
    ds_read_b64_tr_b16 a[2:3], v11 offset:2048
    ds_read_b64_tr_b16 a[4:5], v12 offset:0
    ds_read_b64_tr_b16 a[6:7], v12 offset:2048
    ds_read_b64_tr_b16 a[8:9], v13 offset:0
    ds_read_b64_tr_b16 a[10:11], v13 offset:2048
    ds_read_b64_tr_b16 a[12:13], v14 offset:0
    ds_read_b64_tr_b16 a[14:15], v14 offset:2048
    ds_read_b64_tr_b16 a[16:17], v11 offset:4096
    ds_read_b64_tr_b16 a[18:19], v11 offset:6144
    ds_read_b64_tr_b16 a[20:21], v12 offset:4096
    ds_read_b64_tr_b16 a[22:23], v12 offset:6144
    ds_read_b64_tr_b16 a[24:25], v13 offset:4096
    ds_read_b64_tr_b16 a[26:27], v13 offset:6144
    ds_read_b64_tr_b16 a[28:29], v14 offset:4096
    ds_read_b64_tr_b16 a[30:31], v14 offset:6144
    v_pk_fma_f32 v[84:85], v[84:85], v[56:57], v[88:89] op_sel:[1,1,0] op_sel_hi:[0,1,1] neg_lo:[1,0,0]
    v_pk_mul_f32 v[74:75], v[50:51], v[194:195] op_sel:[0,0] op_sel_hi:[1,0]
    v_pk_mul_f32 v[76:77], v[52:53], v[214:215] op_sel:[0,0] op_sel_hi:[1,0]
    v_pk_mul_f32 v[78:79], v[50:51], v[194:195] op_sel:[0,1] op_sel_hi:[1,1]
    v_pk_mul_f32 v[80:81], v[52:53], v[214:215] op_sel:[0,1] op_sel_hi:[1,1]
    v_pk_fma_f32 v[194:195], v[50:51], v[234:235], v[74:75] op_sel:[1,0,0] op_sel_hi:[0,0,1] neg_hi:[1,0,0]
    v_pk_fma_f32 v[214:215], v[52:53], v[254:255], v[76:77] op_sel:[1,0,0] op_sel_hi:[0,0,1] neg_hi:[1,0,0]
    v_pk_fma_f32 v[234:235], v[50:51], v[234:235], v[78:79] op_sel:[1,1,0] op_sel_hi:[0,1,1] neg_hi:[1,0,0]
    v_pk_fma_f32 v[254:255], v[52:53], v[254:255], v[80:81] op_sel:[1,1,0] op_sel_hi:[0,1,1] neg_hi:[1,0,0]
    v_pk_fma_f32 v[194:195], v[2:3], v[132:133], v[194:195] op_sel_hi:[1,0,1]
    v_pk_fma_f32 v[214:215], v[4:5], v[132:133], v[214:215] op_sel_hi:[1,0,1]
    v_pk_fma_f32 v[234:235], v[2:3], v[134:135], v[234:235] op_sel_hi:[1,0,1]
    v_pk_fma_f32 v[254:255], v[4:5], v[134:135], v[254:255] op_sel_hi:[1,0,1]
    v_pk_mul_f32 v[194:195], v[194:195], v[132:133] op_sel:[0,1] op_sel_hi:[1,1]
    v_pk_mul_f32 v[214:215], v[214:215], v[132:133] op_sel:[0,1] op_sel_hi:[1,1]
    v_pk_mul_f32 v[234:235], v[234:235], v[134:135] op_sel:[0,1] op_sel_hi:[1,1]
    v_pk_mul_f32 v[254:255], v[254:255], v[134:135] op_sel:[0,1] op_sel_hi:[1,1]
    v_pk_fma_f32 v[86:87], v[82:83], v[54:55], v[194:195] op_sel_hi:[1,0,1]
    buffer_load_dwordx4 v20, s[52:55], s81 offen offset:1024 lds
    v_pk_fma_f32 v[88:89], v[84:85], v[56:57], v[214:215] op_sel_hi:[1,0,1]
    v_pk_fma_f32 v[82:83], v[82:83], v[54:55], v[86:87] op_sel:[1,1,0] op_sel_hi:[0,1,1] neg_lo:[1,0,0]
    v_pk_fma_f32 v[84:85], v[84:85], v[56:57], v[88:89] op_sel:[1,1,0] op_sel_hi:[0,1,1] neg_lo:[1,0,0]
    v_pk_fma_f32 v[86:87], v[82:83], v[54:55], v[234:235] op_sel_hi:[1,0,1]
    v_pk_fma_f32 v[88:89], v[84:85], v[56:57], v[254:255] op_sel_hi:[1,0,1]
    v_pk_fma_f32 v[82:83], v[82:83], v[54:55], v[86:87] op_sel:[1,1,0] op_sel_hi:[0,1,1] neg_lo:[1,0,0]
    v_pk_fma_f32 v[84:85], v[84:85], v[56:57], v[88:89] op_sel:[1,1,0] op_sel_hi:[0,1,1] neg_lo:[1,0,0]
    s_nop 0
    v_mfma_f32_16x16x4_f32 v[58:61], v1, v82, 0
    v_mfma_f32_16x16x4_f32 v[62:65], v1, v83, 0
    v_mfma_f32_16x16x4_f32 v[66:69], v1, v84, 0
    v_mfma_f32_16x16x4_f32 v[70:73], v1, v85, 0
    s_lshl_b32 s93, s68, 1
    s_add_u32 s93, s93, s66
    s_mul_i32 s94, s69, 20
    s_add_u32 s93, s93, s94
    s_lshl_b32 s93, s93, 8
    v_lshl_add_u32 v23, v23, 4, s93
    v_sub_u32_e64 v24, v23, v24
    buffer_load_dwordx4 v21, s[52:55], s81 offen offset:2048 lds
    v_accvgpr_read_b32 v50, a228
    v_accvgpr_read_b32 v51, a229
    v_accvgpr_read_b32 v52, a240
    v_accvgpr_read_b32 v53, a241
    s_add_u32 s56, s44, 65536
    s_addc_u32 s57, s45, 0
    s_nop 0
    s_mov_b32 s58, 133120
    s_mov_b32 s59, 0x20000
    v_fma_f32 v59, v60, v50, v59
    v_fma_f32 v63, v64, v50, v63
    v_fma_f32 v59, -v64, v51, v59
    v_fma_f32 v63, v60, v51, v63
    v_fma_f32 v58, v59, v50, v58
    v_fma_f32 v62, v63, v50, v62
    v_fma_f32 v2, -v63, v51, v58
    v_fma_f32 v3, v59, v51, v62
    v_fma_f32 v67, v68, v52, v67
    v_fma_f32 v71, v72, v52, v71
    v_fma_f32 v67, -v72, v53, v67
    buffer_load_dwordx4 v22, s[52:55], s81 offen offset:3072 lds
    v_fma_f32 v71, v68, v53, v71
    v_fma_f32 v66, v67, v52, v66
    v_fma_f32 v70, v71, v52, v70
    v_fma_f32 v4, -v71, v53, v66
    v_fma_f32 v5, v67, v53, v70
    v_pk_fma_f32 v[74:75], v[2:3], v[50:51], v[82:83] op_sel_hi:[1,0,1]
    v_pk_fma_f32 v[74:75], v[2:3], v[50:51], v[74:75] op_sel:[1,1,0] op_sel_hi:[0,1,1] neg_lo:[1,0,0]
    v_pk_fma_f32 v[76:77], v[4:5], v[52:53], v[84:85] op_sel_hi:[1,0,1]
    v_pk_fma_f32 v[76:77], v[4:5], v[52:53], v[76:77] op_sel:[1,1,0] op_sel_hi:[0,1,1] neg_lo:[1,0,0]
    s_mov_b32 s93, 117835008
    v_perm_b32 v74, v74, v29, s93
    s_mov_b32 s93, 117835009
    v_perm_b32 v75, v75, v29, s93
    s_mov_b32 s93, 117835010
    v_perm_b32 v76, v76, v29, s93
    s_mov_b32 s93, 117835011
    v_perm_b32 v77, v77, v29, s93
    v_readlane_b32 s81, v90, 8
    s_waitcnt lgkmcnt(8)
    s_add_u32 m0, s85, 32768
    s_nop 2
    buffer_load_dwordx4 v19, s[52:55], s81 offen offset:0 lds
    s_mov_b32 exec_lo, 0
    s_mov_b32 exec_hi, 0xffff0000
    buffer_store_dwordx4 v[74:77], v23, s[56:59], 0 offen sc1
    s_mov_b64 exec, -1
    v_subrev_u32 v144, 5120, v24
    v_ashrrev_i32_e64 v152, 31, v144
    v_bfi_b32 v152, v152, 0, v29
    v_subrev_u32 v145, 25600, v24
    v_ashrrev_i32_e64 v153, 31, v145
    v_bfi_b32 v153, v153, 0, v29
    v_subrev_u32 v146, 46080, v24
    v_ashrrev_i32_e64 v154, 31, v146
    v_bfi_b32 v154, v154, 0, v29
    v_subrev_u32 v147, 66560, v24
    v_ashrrev_i32_e64 v155, 31, v147
    v_bfi_b32 v155, v155, 0, v29
    v_subrev_u32 v148, 87040, v24
    v_ashrrev_i32_e64 v156, 31, v148
    v_bfi_b32 v156, v156, 0, v29
    v_subrev_u32 v149, 107520, v24
    v_ashrrev_i32_e64 v157, 31, v149
    v_bfi_b32 v157, v157, 0, v29
    v_subrev_u32 v150, 128000, v24
    v_ashrrev_i32_e64 v158, 31, v150
    v_bfi_b32 v158, v158, 0, v29
    buffer_load_dwordx4 v20, s[52:55], s81 offen offset:1024 lds
    buffer_load_dwordx4 v21, s[52:55], s81 offen offset:2048 lds
    buffer_load_dwordx4 v22, s[52:55], s81 offen offset:3072 lds
    v_readlane_b32 s81, v90, 24
    s_waitcnt lgkmcnt(0)
    s_add_u32 m0, s85, 36864
    s_nop 2
    buffer_load_dwordx4 v19, s[52:55], s81 offen offset:0 lds
    s_add_u32 s89, s85, 0
    v_add_u32 v11, s89, v92
    v_xor_b32 v12, 32, v11
    v_xor_b32 v13, 64, v11
    v_xor_b32 v14, 96, v11
    ds_read_b64_tr_b16 a[32:33], v11 offset:0
    ds_read_b64_tr_b16 a[34:35], v11 offset:2048
    ds_read_b64_tr_b16 a[36:37], v12 offset:0
    ds_read_b64_tr_b16 a[38:39], v12 offset:2048
    ds_read_b64_tr_b16 a[40:41], v13 offset:0
    ds_read_b64_tr_b16 a[42:43], v13 offset:2048
    ds_read_b64_tr_b16 a[44:45], v14 offset:0
    ds_read_b64_tr_b16 a[46:47], v14 offset:2048
    ds_read_b64_tr_b16 a[48:49], v11 offset:4096
    ds_read_b64_tr_b16 a[50:51], v11 offset:6144
    ds_read_b64_tr_b16 a[52:53], v12 offset:4096
    ds_read_b64_tr_b16 a[54:55], v12 offset:6144
    ds_read_b64_tr_b16 a[56:57], v13 offset:4096
    ds_read_b64_tr_b16 a[58:59], v13 offset:6144
    ds_read_b64_tr_b16 a[60:61], v14 offset:4096
    ds_read_b64_tr_b16 a[62:63], v14 offset:6144
    buffer_load_dwordx4 v20, s[52:55], s81 offen offset:1024 lds
    buffer_load_dwordx4 v21, s[52:55], s81 offen offset:2048 lds
    v_accvgpr_read_b32 v64, a224
    v_accvgpr_read_b32 v65, a225
    v_accvgpr_read_b32 v66, a236
    v_accvgpr_read_b32 v67, a237
    v_accvgpr_read_b32 v84, a230
    v_accvgpr_read_b32 v85, a231
    v_accvgpr_read_b32 v86, a242
    v_accvgpr_read_b32 v87, a243
    v_accvgpr_read_b32 v160, a232
    v_accvgpr_read_b32 v161, a233
    v_accvgpr_read_b32 v162, a244
    v_accvgpr_read_b32 v163, a245
    v_accvgpr_read_b32 v164, a234
    v_accvgpr_read_b32 v165, a235
    v_accvgpr_read_b32 v166, a246
    v_accvgpr_read_b32 v167, a247
    v_and_b32 v68, 15, v0
    v_lshlrev_b32 v69, 2, v95
    v_sub_u32_e64 v68, v68, v69
    v_mov_b32 v70, 0x3f80
    v_mov_b32 v1, 1.0
    v_cmp_eq_u32 vcc, 0, v68
    v_cmp_eq_u32 s[92:93], 1, v68
    v_cmp_eq_u32 s[94:95], 3, v68
    v_cndmask_b32 v72, 0, v70, vcc
    v_cmp_eq_u32_e64 vcc, 2, v68
    s_nop 1
    v_cndmask_b32 v72, v72, v1, s[92:93]
    s_mul_i32 s62, s73, 12513280
    v_cndmask_b32_e64 v73, 0, v70, vcc
    v_cndmask_b32 v73, v73, v1, s[94:95]
    v_mov_b32 v26, v95
    v_mov_b32 v27, v93
    v_mov_b32 v39, v94
    v_mov_b32 v28, v91
    s_mul_i32 s93, s70, 481280
    v_lshl_add_u32 v30, v0, 4, s93
    v_add_u32 v31, 4096, v30
    s_lshl_b32 s93, s82, 10
    s_add_u32 s93, s93, 12032000
    s_cmp_lt_u32 s82, 5
    s_cselect_b32 s93, s93, 0x40000000
    v_lshl_add_u32 v32, v0, 4, s93
    v_and_b32 v44, 15, v0
    v_cmp_gt_u32_e64 vcc, 16, v0
    s_mul_i32 s93, s70, 12288
    s_cselect_b32 s94, 307200, s93
    v_mov_b32 v46, s93
    v_mov_b32 v45, s94
    v_min_u32 v47, 13, v44
    v_cndmask_b32 v45, v45, v46, vcc
    v_lshl_add_u32 v33, v47, 7, v45
    s_lshl_b32 s93, s71, 8
    v_lshl_add_u32 v47, v44, 4, s93
    v_mul_u32_u24 v44, 20, v95
    s_mul_i32 s93, s70, 79
    s_add_u32 s93, s93, s64
    s_sub_u32 s93, s93, 1
    s_lshl_b32 s94, s82, 2
    s_add_u32 s94, s94, s64
    s_add_u32 s94, s94, 1974
    v_add_u32 v45, s94, v44
    v_add_u32 v44, s93, v44
    v_mov_b32 v46, 2560
    v_mad_i32_i24 v37, v44, v46, v47
    v_mad_i32_i24 v25, v45, v46, v47
    buffer_load_dwordx4 v22, s[52:55], s81 offen offset:3072 lds
    v_readlane_b32 s81, v90, 9
    s_waitcnt lgkmcnt(8)
    s_add_u32 m0, s85, 0
    s_nop 2
    buffer_load_dwordx4 v19, s[52:55], s81 offen offset:0 lds
    buffer_load_dwordx4 v20, s[52:55], s81 offen offset:1024 lds
    buffer_load_dwordx4 v21, s[52:55], s81 offen offset:2048 lds
    buffer_load_dwordx4 v22, s[52:55], s81 offen offset:3072 lds
    v_readlane_b32 s81, v90, 25
    s_waitcnt lgkmcnt(0)
    s_add_u32 m0, s85, 4096
    s_nop 2
    buffer_load_dwordx4 v19, s[52:55], s81 offen offset:0 lds
    s_add_u32 s89, s85, 65536
    v_add_u32 v11, s89, v92
    v_xor_b32 v12, 32, v11
    v_xor_b32 v13, 64, v11
    v_xor_b32 v14, 96, v11
    ds_read_b64_tr_b16 a[64:65], v11 offset:0
    ds_read_b64_tr_b16 a[66:67], v11 offset:2048
    ds_read_b64_tr_b16 a[68:69], v12 offset:0
    ds_read_b64_tr_b16 a[70:71], v12 offset:2048
    ds_read_b64_tr_b16 a[72:73], v13 offset:0
    ds_read_b64_tr_b16 a[74:75], v13 offset:2048
    ds_read_b64_tr_b16 a[76:77], v14 offset:0
    ds_read_b64_tr_b16 a[78:79], v14 offset:2048
    ds_read_b64_tr_b16 a[80:81], v11 offset:4096
    ds_read_b64_tr_b16 a[82:83], v11 offset:6144
    ds_read_b64_tr_b16 a[84:85], v12 offset:4096
    ds_read_b64_tr_b16 a[86:87], v12 offset:6144
    ds_read_b64_tr_b16 a[88:89], v13 offset:4096
    ds_read_b64_tr_b16 a[90:91], v13 offset:6144
    ds_read_b64_tr_b16 a[92:93], v14 offset:4096
    ds_read_b64_tr_b16 a[94:95], v14 offset:6144
    buffer_load_dwordx4 v[116:119], v144, s[56:59], 0 offen sc1
    buffer_load_dwordx4 v[120:123], v145, s[56:59], 0 offen sc1
    buffer_load_dwordx4 v[124:127], v146, s[56:59], 0 offen sc1
    buffer_load_dwordx4 v[128:131], v147, s[56:59], 0 offen sc1
    buffer_load_dwordx4 v[132:135], v148, s[56:59], 0 offen sc1
    buffer_load_dwordx4 v[136:139], v149, s[56:59], 0 offen sc1
    buffer_load_dwordx4 v[140:143], v150, s[56:59], 0 offen sc1
    v_accvgpr_read_b32 v74, a117
    v_accvgpr_read_b32 v75, a119
    v_accvgpr_read_b32 v76, a121
    v_accvgpr_read_b32 v77, a123
    v_accvgpr_read_b32 v78, a125
    v_accvgpr_read_b32 v79, a127
    v_xor_b32_e64 v74, v74, v29
    v_bitop3_b32 v74, v75, v29, v74 bitop3:0xbe
    v_bitop3_b32 v74, v76, v29, v74 bitop3:0xbe
    v_bitop3_b32 v74, v77, v29, v74 bitop3:0xbe
    v_bitop3_b32 v74, v78, v29, v74 bitop3:0xbe
    v_bitop3_b32 v74, v79, v29, v74 bitop3:0xbe
    v_cmp_ne_u32_e64 vcc, 0, v74
    s_nop 4
    s_cbranch_vccnz L_sp_resS
L_ok_resS:
    v_accvgpr_read_b32 v75, a248
    v_accvgpr_read_b32 v77, a249
    buffer_load_dwordx4 v20, s[52:55], s81 offen offset:1024 lds
    v_lshlrev_b32_e64 v74, 16, v75
    v_and_b32 v75, 0xffff0000, v75
    v_lshlrev_b32_e64 v76, 16, v77
    v_and_b32 v77, 0xffff0000, v77
    v_accvgpr_read_b32 v78, a116
    v_accvgpr_read_b32 v41, a104
    v_accvgpr_read_b32 v43, a105
    v_and_b32 v79, 0xffff0000, v78
    v_lshlrev_b32 v78, 16, v78
    v_rcp_f32 v79, v79
    v_lshlrev_b32_e64 v40, 16, v41
    v_and_b32 v41, 0xffff0000, v41
    v_lshlrev_b32_e64 v42, 16, v43
    v_and_b32 v43, 0xffff0000, v43
    v_pk_add_f32 v[80:81], v[40:41], v[78:79] op_sel_hi:[1,0] neg_lo:[0,1] neg_hi:[0,1]
    v_pk_mul_f32 v[82:83], v[74:75], v[78:79] op_sel:[0,1] op_sel_hi:[1,1]
    v_pk_fma_f32 v[40:41], v[80:81], v[82:83], v[40:41]
    v_pk_add_f32 v[80:81], v[42:43], v[78:79] op_sel_hi:[1,0] neg_lo:[0,1] neg_hi:[0,1]
    buffer_load_dwordx4 v21, s[52:55], s81 offen offset:2048 lds
    v_pk_mul_f32 v[82:83], v[76:77], v[78:79] op_sel:[0,1] op_sel_hi:[1,1]
    v_pk_fma_f32 v[42:43], v[80:81], v[82:83], v[42:43]
    v_accvgpr_read_b32 v78, a118
    v_accvgpr_read_b32 v45, a106
    v_accvgpr_read_b32 v47, a107
    v_and_b32 v79, 0xffff0000, v78
    v_lshlrev_b32 v78, 16, v78
    v_rcp_f32 v79, v79
    v_lshlrev_b32_e64 v44, 16, v45
    v_and_b32 v45, 0xffff0000, v45
    v_lshlrev_b32_e64 v46, 16, v47
    v_and_b32 v47, 0xffff0000, v47
    v_pk_add_f32 v[80:81], v[44:45], v[78:79] op_sel_hi:[1,0] neg_lo:[0,1] neg_hi:[0,1]
    v_pk_mul_f32 v[82:83], v[74:75], v[78:79] op_sel:[0,1] op_sel_hi:[1,1]
    v_pk_fma_f32 v[44:45], v[80:81], v[82:83], v[44:45]
    v_pk_add_f32 v[80:81], v[46:47], v[78:79] op_sel_hi:[1,0] neg_lo:[0,1] neg_hi:[0,1]
    v_pk_mul_f32 v[82:83], v[76:77], v[78:79] op_sel:[0,1] op_sel_hi:[1,1]
    v_pk_fma_f32 v[46:47], v[80:81], v[82:83], v[46:47]
    buffer_load_dwordx4 v22, s[52:55], s81 offen offset:3072 lds
    v_accvgpr_read_b32 v78, a120
    v_accvgpr_read_b32 v49, a108
    v_accvgpr_read_b32 v51, a109
    v_and_b32 v79, 0xffff0000, v78
    v_lshlrev_b32 v78, 16, v78
    v_rcp_f32 v79, v79
    v_lshlrev_b32_e64 v48, 16, v49
    v_and_b32 v49, 0xffff0000, v49
    v_lshlrev_b32_e64 v50, 16, v51
    v_and_b32 v51, 0xffff0000, v51
    v_pk_add_f32 v[80:81], v[48:49], v[78:79] op_sel_hi:[1,0] neg_lo:[0,1] neg_hi:[0,1]
    v_pk_mul_f32 v[82:83], v[74:75], v[78:79] op_sel:[0,1] op_sel_hi:[1,1]
    v_pk_fma_f32 v[48:49], v[80:81], v[82:83], v[48:49]
    v_pk_add_f32 v[80:81], v[50:51], v[78:79] op_sel_hi:[1,0] neg_lo:[0,1] neg_hi:[0,1]
    v_pk_mul_f32 v[82:83], v[76:77], v[78:79] op_sel:[0,1] op_sel_hi:[1,1]
    v_pk_fma_f32 v[50:51], v[80:81], v[82:83], v[50:51]
    v_accvgpr_read_b32 v78, a122
    v_accvgpr_read_b32 v53, a110
    v_readlane_b32 s81, v90, 10
    s_waitcnt lgkmcnt(8)
    s_add_u32 m0, s85, 65536
    s_nop 2
    buffer_load_dwordx4 v19, s[52:55], s81 offen offset:0 lds
    v_accvgpr_read_b32 v55, a111
    v_and_b32 v79, 0xffff0000, v78
    v_lshlrev_b32 v78, 16, v78
    v_rcp_f32 v79, v79
    v_lshlrev_b32_e64 v52, 16, v53
    v_and_b32 v53, 0xffff0000, v53
    v_lshlrev_b32_e64 v54, 16, v55
    v_and_b32 v55, 0xffff0000, v55
    v_pk_add_f32 v[80:81], v[52:53], v[78:79] op_sel_hi:[1,0] neg_lo:[0,1] neg_hi:[0,1]
    v_pk_mul_f32 v[82:83], v[74:75], v[78:79] op_sel:[0,1] op_sel_hi:[1,1]
    v_pk_fma_f32 v[52:53], v[80:81], v[82:83], v[52:53]
    v_pk_add_f32 v[80:81], v[54:55], v[78:79] op_sel_hi:[1,0] neg_lo:[0,1] neg_hi:[0,1]
    v_pk_mul_f32 v[82:83], v[76:77], v[78:79] op_sel:[0,1] op_sel_hi:[1,1]
    v_pk_fma_f32 v[54:55], v[80:81], v[82:83], v[54:55]
    v_accvgpr_read_b32 v78, a124
    v_accvgpr_read_b32 v57, a112
    v_accvgpr_read_b32 v59, a113
    v_and_b32 v79, 0xffff0000, v78
    buffer_load_dwordx4 v20, s[52:55], s81 offen offset:1024 lds
    v_lshlrev_b32 v78, 16, v78
    v_rcp_f32 v79, v79
    v_lshlrev_b32_e64 v56, 16, v57
    v_and_b32 v57, 0xffff0000, v57
    v_lshlrev_b32_e64 v58, 16, v59
    v_and_b32 v59, 0xffff0000, v59
    v_pk_add_f32 v[80:81], v[56:57], v[78:79] op_sel_hi:[1,0] neg_lo:[0,1] neg_hi:[0,1]
    v_pk_mul_f32 v[82:83], v[74:75], v[78:79] op_sel:[0,1] op_sel_hi:[1,1]
    v_pk_fma_f32 v[56:57], v[80:81], v[82:83], v[56:57]
    v_pk_add_f32 v[80:81], v[58:59], v[78:79] op_sel_hi:[1,0] neg_lo:[0,1] neg_hi:[0,1]
    v_pk_mul_f32 v[82:83], v[76:77], v[78:79] op_sel:[0,1] op_sel_hi:[1,1]
    v_pk_fma_f32 v[58:59], v[80:81], v[82:83], v[58:59]
    v_accvgpr_read_b32 v78, a126
    v_accvgpr_read_b32 v61, a114
    v_accvgpr_read_b32 v63, a115
    v_and_b32 v79, 0xffff0000, v78
    v_lshlrev_b32 v78, 16, v78
    v_rcp_f32 v79, v79
    buffer_load_dwordx4 v21, s[52:55], s81 offen offset:2048 lds
    v_lshlrev_b32_e64 v60, 16, v61
    v_and_b32 v61, 0xffff0000, v61
    v_lshlrev_b32_e64 v62, 16, v63
    v_and_b32 v63, 0xffff0000, v63
    v_pk_add_f32 v[80:81], v[60:61], v[78:79] op_sel_hi:[1,0] neg_lo:[0,1] neg_hi:[0,1]
    v_pk_mul_f32 v[82:83], v[74:75], v[78:79] op_sel:[0,1] op_sel_hi:[1,1]
    v_pk_fma_f32 v[60:61], v[80:81], v[82:83], v[60:61]
    v_pk_add_f32 v[80:81], v[62:63], v[78:79] op_sel_hi:[1,0] neg_lo:[0,1] neg_hi:[0,1]
    v_pk_mul_f32 v[82:83], v[76:77], v[78:79] op_sel:[0,1] op_sel_hi:[1,1]
    v_pk_fma_f32 v[62:63], v[80:81], v[82:83], v[62:63]
    buffer_load_dwordx4 v22, s[52:55], s81 offen offset:3072 lds
    v_readlane_b32 s81, v90, 26
    s_waitcnt lgkmcnt(0)
    s_add_u32 m0, s85, 69632
    s_nop 2
    buffer_load_dwordx4 v19, s[52:55], s81 offen offset:0 lds
    buffer_load_dwordx4 v20, s[52:55], s81 offen offset:1024 lds
    buffer_load_dwordx4 v21, s[52:55], s81 offen offset:2048 lds
    s_mov_b32 s92, 0x0c0c0400
    s_mov_b32 s93, 0x04000c0c
    s_waitcnt vmcnt(10)
    v_mov_b32 v68, 0
    v_perm_b32 v69, v117, v116, s92
    v_perm_b32 v70, v119, v118, s93
    v_bitop3_b32 v69, v69, v70, v152 bitop3:0x56
    v_or_b32_e64 v68, v68, v69
    v_perm_b32 v69, v121, v120, s92
    v_perm_b32 v70, v123, v122, s93
    v_bitop3_b32 v69, v69, v70, v153 bitop3:0x56
    v_or_b32_e64 v68, v68, v69
    v_perm_b32 v69, v125, v124, s92
    v_perm_b32 v70, v127, v126, s93
    v_bitop3_b32 v69, v69, v70, v154 bitop3:0x56
    v_or_b32_e64 v68, v68, v69
    v_perm_b32 v69, v129, v128, s92
    v_perm_b32 v70, v131, v130, s93
    v_bitop3_b32 v69, v69, v70, v155 bitop3:0x56
    v_or_b32_e64 v68, v68, v69
    v_perm_b32 v69, v133, v132, s92
    v_perm_b32 v70, v135, v134, s93
    v_bitop3_b32 v69, v69, v70, v156 bitop3:0x56
    v_or_b32_e64 v68, v68, v69
    v_perm_b32 v69, v137, v136, s92
    v_perm_b32 v70, v139, v138, s93
    v_bitop3_b32 v69, v69, v70, v157 bitop3:0x56
    v_or_b32_e64 v68, v68, v69
    v_perm_b32 v69, v141, v140, s92
    v_perm_b32 v70, v143, v142, s93
    v_bitop3_b32 v69, v69, v70, v158 bitop3:0x56
    v_or_b32 v68, v68, v69
    v_cmp_ne_u32 vcc, 0, v68
    s_nop 4
    s_cbranch_vccnz L_sp_car
L_ok_car:
    v_pk_fma_f32 v[136:137], v[140:141], v[164:165], v[136:137] op_sel_hi:[1,0,1]
    v_pk_fma_f32 v[138:139], v[142:143], v[166:167], v[138:139] op_sel_hi:[1,0,1]
    v_pk_fma_f32 v[136:137], v[140:141], v[164:165], v[136:137] op_sel:[1,1,0] op_sel_hi:[0,1,1] neg_lo:[1,0,0]
    buffer_load_dwordx4 v22, s[52:55], s81 offen offset:3072 lds
    v_pk_fma_f32 v[138:139], v[142:143], v[166:167], v[138:139] op_sel:[1,1,0] op_sel_hi:[0,1,1] neg_lo:[1,0,0]
    v_pk_fma_f32 v[132:133], v[136:137], v[164:165], v[132:133] op_sel_hi:[1,0,1]
    v_pk_fma_f32 v[134:135], v[138:139], v[166:167], v[134:135] op_sel_hi:[1,0,1]
    v_pk_fma_f32 v[132:133], v[136:137], v[164:165], v[132:133] op_sel:[1,1,0] op_sel_hi:[0,1,1] neg_lo:[1,0,0]
    v_pk_fma_f32 v[134:135], v[138:139], v[166:167], v[134:135] op_sel:[1,1,0] op_sel_hi:[0,1,1] neg_lo:[1,0,0]
    v_pk_fma_f32 v[128:129], v[132:133], v[164:165], v[128:129] op_sel_hi:[1,0,1]
    v_pk_fma_f32 v[130:131], v[134:135], v[166:167], v[130:131] op_sel_hi:[1,0,1]
    v_pk_fma_f32 v[128:129], v[132:133], v[164:165], v[128:129] op_sel:[1,1,0] op_sel_hi:[0,1,1] neg_lo:[1,0,0]
    v_pk_fma_f32 v[130:131], v[134:135], v[166:167], v[130:131] op_sel:[1,1,0] op_sel_hi:[0,1,1] neg_lo:[1,0,0]
    v_pk_fma_f32 v[124:125], v[128:129], v[164:165], v[124:125] op_sel_hi:[1,0,1]
    v_pk_fma_f32 v[126:127], v[130:131], v[166:167], v[126:127] op_sel_hi:[1,0,1]
    v_pk_fma_f32 v[124:125], v[128:129], v[164:165], v[124:125] op_sel:[1,1,0] op_sel_hi:[0,1,1] neg_lo:[1,0,0]
    v_pk_fma_f32 v[126:127], v[130:131], v[166:167], v[126:127] op_sel:[1,1,0] op_sel_hi:[0,1,1] neg_lo:[1,0,0]
    v_pk_fma_f32 v[120:121], v[124:125], v[164:165], v[120:121] op_sel_hi:[1,0,1]
    s_add_u32 s89, s85, 98304
    v_add_u32 v11, s89, v92
    v_xor_b32 v12, 32, v11
    v_xor_b32_e64 v13, 64, v11
    v_xor_b32 v14, 96, v11
    ds_read_b64_tr_b16 a[96:97], v11 offset:0
    ds_read_b64_tr_b16 a[98:99], v11 offset:2048
    ds_read_b64_tr_b16 a[100:101], v12 offset:0
    ds_read_b64_tr_b16 a[102:103], v12 offset:2048
    ds_read_b64_tr_b16 a[104:105], v13 offset:0
    ds_read_b64_tr_b16 a[106:107], v13 offset:2048
    ds_read_b64_tr_b16 a[108:109], v14 offset:0
    ds_read_b64_tr_b16 a[110:111], v14 offset:2048
    ds_read_b64_tr_b16 a[112:113], v11 offset:4096
    ds_read_b64_tr_b16 a[114:115], v11 offset:6144
    ds_read_b64_tr_b16 a[116:117], v12 offset:4096
    ds_read_b64_tr_b16 a[118:119], v12 offset:6144
    ds_read_b64_tr_b16 a[120:121], v13 offset:4096
    ds_read_b64_tr_b16 a[122:123], v13 offset:6144
    ds_read_b64_tr_b16 a[124:125], v14 offset:4096
    ds_read_b64_tr_b16 a[126:127], v14 offset:6144
    v_readlane_b32 s81, v90, 11
    s_waitcnt lgkmcnt(8)
    s_add_u32 m0, s85, 98304
    s_nop 2
    buffer_load_dwordx4 v19, s[52:55], s81 offen offset:0 lds
    v_pk_fma_f32 v[122:123], v[126:127], v[166:167], v[122:123] op_sel_hi:[1,0,1]
    v_pk_fma_f32 v[120:121], v[124:125], v[164:165], v[120:121] op_sel:[1,1,0] op_sel_hi:[0,1,1] neg_lo:[1,0,0]
    v_pk_fma_f32 v[122:123], v[126:127], v[166:167], v[122:123] op_sel:[1,1,0] op_sel_hi:[0,1,1] neg_lo:[1,0,0]
    v_pk_fma_f32 v[116:117], v[120:121], v[164:165], v[116:117] op_sel_hi:[1,0,1]
    v_pk_fma_f32 v[118:119], v[122:123], v[166:167], v[118:119] op_sel_hi:[1,0,1]
    v_pk_fma_f32 v[116:117], v[120:121], v[164:165], v[116:117] op_sel:[1,1,0] op_sel_hi:[0,1,1] neg_lo:[1,0,0]
    v_pk_fma_f32 v[118:119], v[122:123], v[166:167], v[118:119] op_sel:[1,1,0] op_sel_hi:[0,1,1] neg_lo:[1,0,0]
    v_pk_mul_f32 v[120:121], v[116:117], v[160:161] op_sel_hi:[1,0]
    v_pk_mul_f32 v[122:123], v[118:119], v[162:163] op_sel_hi:[1,0]
    v_pk_fma_f32 v[120:121], v[116:117], v[160:161], v[120:121] op_sel:[1,1,0] op_sel_hi:[0,1,1] neg_lo:[1,0,0]
    v_pk_fma_f32 v[122:123], v[118:119], v[162:163], v[122:123] op_sel:[1,1,0] op_sel_hi:[0,1,1] neg_lo:[1,0,0]
    v_pk_fma_f32 v[176:177], v[2:3], v[64:65], v[176:177] op_sel_hi:[1,0,1]
    v_pk_fma_f32 v[196:197], v[4:5], v[66:67], v[196:197] op_sel_hi:[1,0,1]
    v_pk_fma_f32 v[176:177], v[2:3], v[64:65], v[176:177] op_sel:[1,1,0] op_sel_hi:[0,1,1] neg_lo:[1,0,0]
    buffer_load_dwordx4 v20, s[52:55], s81 offen offset:1024 lds
    v_pk_fma_f32 v[196:197], v[4:5], v[66:67], v[196:197] op_sel:[1,1,0] op_sel_hi:[0,1,1] neg_lo:[1,0,0]
    v_mfma_f32_16x16x4_f32 v[96:99], v1, v120, 0
    v_mfma_f32_16x16x4_f32 v[100:103], v1, v121, 0
    v_mfma_f32_16x16x4_f32 v[104:107], v1, v122, 0
    v_mfma_f32_16x16x4_f32 v[108:111], v1, v123, 0
    s_add_u32 s93, s100, 102400
    s_nop 5
    s_nop 0
    v_pk_fma_f32 v[176:177], v[84:85], v[96:97], v[176:177] op_sel_hi:[1,0,1]
    v_pk_fma_f32 v[176:177], v[84:85], v[100:101], v[176:177] op_sel:[1,0,0] op_sel_hi:[0,0,1] neg_lo:[1,0,0]
    v_pk_fma_f32 v[196:197], v[86:87], v[104:105], v[196:197] op_sel_hi:[1,0,1]
    v_pk_fma_f32 v[196:197], v[86:87], v[108:109], v[196:197] op_sel:[1,0,0] op_sel_hi:[0,0,1] neg_lo:[1,0,0]
    v_pk_fma_f32 v[216:217], v[176:177], v[64:65], v[216:217] op_sel_hi:[1,0,1]
    v_pk_fma_f32 v[236:237], v[196:197], v[66:67], v[236:237] op_sel_hi:[1,0,1]
    v_pk_fma_f32 v[216:217], v[176:177], v[64:65], v[216:217] op_sel:[1,1,0] op_sel_hi:[0,1,1] neg_lo:[1,0,0]
    v_pk_fma_f32 v[236:237], v[196:197], v[66:67], v[236:237] op_sel:[1,1,0] op_sel_hi:[0,1,1] neg_lo:[1,0,0]
    buffer_load_dwordx4 v21, s[52:55], s81 offen offset:2048 lds
    v_pk_fma_f32 v[178:179], v[216:217], v[64:65], v[178:179] op_sel_hi:[1,0,1]
    v_pk_fma_f32 v[198:199], v[236:237], v[66:67], v[198:199] op_sel_hi:[1,0,1]
    v_pk_fma_f32 v[178:179], v[216:217], v[64:65], v[178:179] op_sel:[1,1,0] op_sel_hi:[0,1,1] neg_lo:[1,0,0]
    v_pk_fma_f32 v[198:199], v[236:237], v[66:67], v[198:199] op_sel:[1,1,0] op_sel_hi:[0,1,1] neg_lo:[1,0,0]
    v_pk_fma_f32 v[218:219], v[178:179], v[64:65], v[218:219] op_sel_hi:[1,0,1]
    v_pk_fma_f32 v[238:239], v[198:199], v[66:67], v[238:239] op_sel_hi:[1,0,1]
    v_pk_fma_f32 v[218:219], v[178:179], v[64:65], v[218:219] op_sel:[1,1,0] op_sel_hi:[0,1,1] neg_lo:[1,0,0]
    v_pk_fma_f32 v[238:239], v[198:199], v[66:67], v[238:239] op_sel:[1,1,0] op_sel_hi:[0,1,1] neg_lo:[1,0,0]
    v_cvt_pk_bf16_f32 v128, v176, v216
L_pad12:
    s_cbranch_execz L_hopend
    s_nop 0
    v_cvt_pk_bf16_f32 v129, v178, v218
    v_cvt_pk_bf16_f32 v130, v196, v236
    v_cvt_pk_bf16_f32 v131, v198, v238
    v_cvt_pk_bf16_f32 v132, v177, v217
    v_cvt_pk_bf16_f32 v133, v179, v219
    buffer_load_dwordx4 v22, s[52:55], s81 offen offset:3072 lds
    v_cvt_pk_bf16_f32 v134, v197, v237
    v_cvt_pk_bf16_f32 v135, v199, v239
    v_mfma_f32_16x16x16_bf16 v[136:139], v[128:129], v[72:73], 0
    v_mfma_f32_16x16x16_bf16 v[140:143], v[130:131], v[72:73], 0
    v_mfma_f32_16x16x16_bf16 v[144:147], v[132:133], v[72:73], 0
    v_mfma_f32_16x16x16_bf16 v[148:151], v[134:135], v[72:73], 0
    v_pk_fma_f32 v[180:181], v[218:219], v[64:65], v[180:181] op_sel_hi:[1,0,1]
    v_pk_fma_f32 v[200:201], v[238:239], v[66:67], v[200:201] op_sel_hi:[1,0,1]
    v_pk_fma_f32 v[180:181], v[218:219], v[64:65], v[180:181] op_sel:[1,1,0] op_sel_hi:[0,1,1] neg_lo:[1,0,0]
    v_pk_fma_f32 v[200:201], v[238:239], v[66:67], v[200:201] op_sel:[1,1,0] op_sel_hi:[0,1,1] neg_lo:[1,0,0]
    v_pk_fma_f32 v[220:221], v[180:181], v[64:65], v[220:221] op_sel_hi:[1,0,1]
    v_pk_fma_f32 v[240:241], v[200:201], v[66:67], v[240:241] op_sel_hi:[1,0,1]
    v_pk_fma_f32 v[220:221], v[180:181], v[64:65], v[220:221] op_sel:[1,1,0] op_sel_hi:[0,1,1] neg_lo:[1,0,0]
    v_pk_fma_f32 v[240:241], v[200:201], v[66:67], v[240:241] op_sel:[1,1,0] op_sel_hi:[0,1,1] neg_lo:[1,0,0]
    v_readlane_b32 s81, v90, 27
    s_waitcnt lgkmcnt(0)
    s_add_u32 m0, s85, 102400
    s_nop 2
    buffer_load_dwordx4 v19, s[52:55], s81 offen offset:0 lds
    v_pk_fma_f32 v[182:183], v[220:221], v[64:65], v[182:183] op_sel_hi:[1,0,1]
    v_pk_fma_f32 v[202:203], v[240:241], v[66:67], v[202:203] op_sel_hi:[1,0,1]
    v_pk_fma_f32 v[182:183], v[220:221], v[64:65], v[182:183] op_sel:[1,1,0] op_sel_hi:[0,1,1] neg_lo:[1,0,0]
    v_pk_fma_f32 v[202:203], v[240:241], v[66:67], v[202:203] op_sel:[1,1,0] op_sel_hi:[0,1,1] neg_lo:[1,0,0]
    v_pk_fma_f32 v[222:223], v[182:183], v[64:65], v[222:223] op_sel_hi:[1,0,1]
    v_pk_fma_f32 v[242:243], v[202:203], v[66:67], v[242:243] op_sel_hi:[1,0,1]
    v_pk_fma_f32 v[222:223], v[182:183], v[64:65], v[222:223] op_sel:[1,1,0] op_sel_hi:[0,1,1] neg_lo:[1,0,0]
    v_pk_fma_f32 v[242:243], v[202:203], v[66:67], v[242:243] op_sel:[1,1,0] op_sel_hi:[0,1,1] neg_lo:[1,0,0]
    v_cvt_pk_bf16_f32 v128, v180, v220
    v_cvt_pk_bf16_f32 v129, v182, v222
    v_cvt_pk_bf16_f32 v130, v200, v240
    v_cvt_pk_bf16_f32 v131, v202, v242
    v_cvt_pk_bf16_f32 v132, v181, v221
    v_cvt_pk_bf16_f32 v133, v183, v223
    buffer_load_dwordx4 v20, s[52:55], s81 offen offset:1024 lds
    v_cvt_pk_bf16_f32 v134, v201, v241
    v_cvt_pk_bf16_f32 v135, v203, v243
    v_mfma_f32_16x16x16_bf16 v[152:155], v[128:129], v[72:73], 0
    v_cvt_pk_bf16_f32 v96, v136, v137
    v_cvt_pk_bf16_f32 v97, v138, v139
    v_mfma_f32_16x16x16_bf16 v[156:159], v[130:131], v[72:73], 0
    v_cvt_pk_bf16_f32 v98, v140, v141
    v_cvt_pk_bf16_f32 v99, v142, v143
    v_mfma_f32_16x16x16_bf16 v[160:163], v[132:133], v[72:73], 0
    v_cvt_pk_bf16_f32 v100, v144, v145
    v_cvt_pk_bf16_f32 v101, v146, v147
    v_mfma_f32_16x16x16_bf16 v[164:167], v[134:135], v[72:73], 0
    v_cvt_pk_bf16_f32 v102, v148, v149
    v_cvt_pk_bf16_f32 v103, v150, v151
    buffer_load_dwordx4 v21, s[52:55], s81 offen offset:2048 lds
    buffer_load_dwordx4 v22, s[52:55], s81 offen offset:3072 lds
    s_lshl_b32 s74, s64, 11
    s_nop 0
    s_add_u32 s74, s74, 344064
    buffer_load_dword v34, v33, s[44:47], s74 offen sc1
    buffer_store_dwordx4 v[96:99], v6, s[60:63], s100 offen sc1
    buffer_store_dwordx4 v[100:103], v6, s[60:63], s93 offen sc1
    v_pk_fma_f32 v[184:185], v[222:223], v[64:65], v[184:185] op_sel_hi:[1,0,1]
    v_pk_fma_f32 v[204:205], v[242:243], v[66:67], v[204:205] op_sel_hi:[1,0,1]
    v_pk_fma_f32 v[184:185], v[222:223], v[64:65], v[184:185] op_sel:[1,1,0] op_sel_hi:[0,1,1] neg_lo:[1,0,0]
    v_pk_fma_f32 v[204:205], v[242:243], v[66:67], v[204:205] op_sel:[1,1,0] op_sel_hi:[0,1,1] neg_lo:[1,0,0]
    v_pk_fma_f32 v[224:225], v[184:185], v[64:65], v[224:225] op_sel_hi:[1,0,1]
    v_pk_fma_f32 v[244:245], v[204:205], v[66:67], v[244:245] op_sel_hi:[1,0,1]
    v_pk_fma_f32 v[224:225], v[184:185], v[64:65], v[224:225] op_sel:[1,1,0] op_sel_hi:[0,1,1] neg_lo:[1,0,0]
    v_pk_fma_f32 v[244:245], v[204:205], v[66:67], v[244:245] op_sel:[1,1,0] op_sel_hi:[0,1,1] neg_lo:[1,0,0]
    v_pk_fma_f32 v[186:187], v[224:225], v[64:65], v[186:187] op_sel_hi:[1,0,1]
    v_pk_fma_f32 v[206:207], v[244:245], v[66:67], v[206:207] op_sel_hi:[1,0,1]
    v_pk_fma_f32 v[186:187], v[224:225], v[64:65], v[186:187] op_sel:[1,1,0] op_sel_hi:[0,1,1] neg_lo:[1,0,0]
    v_pk_fma_f32 v[206:207], v[244:245], v[66:67], v[206:207] op_sel:[1,1,0] op_sel_hi:[0,1,1] neg_lo:[1,0,0]
    v_pk_fma_f32 v[226:227], v[186:187], v[64:65], v[226:227] op_sel_hi:[1,0,1]
    v_pk_fma_f32 v[246:247], v[206:207], v[66:67], v[246:247] op_sel_hi:[1,0,1]
    v_pk_fma_f32 v[226:227], v[186:187], v[64:65], v[226:227] op_sel:[1,1,0] op_sel_hi:[0,1,1] neg_lo:[1,0,0]
    v_pk_fma_f32 v[246:247], v[206:207], v[66:67], v[246:247] op_sel:[1,1,0] op_sel_hi:[0,1,1] neg_lo:[1,0,0]
    v_cvt_pk_bf16_f32 v128, v184, v224
    v_cvt_pk_bf16_f32 v129, v186, v226
    v_cvt_pk_bf16_f32 v130, v204, v244
    v_cvt_pk_bf16_f32 v131, v206, v246
    v_cvt_pk_bf16_f32 v132, v185, v225
    v_cvt_pk_bf16_f32 v133, v187, v227
    v_cvt_pk_bf16_f32 v134, v205, v245
    v_cvt_pk_bf16_f32 v135, v207, v247
    v_mfma_f32_16x16x16_bf16 v[136:139], v[128:129], v[72:73], 0
    v_cvt_pk_bf16_f32 v104, v152, v153
    v_cvt_pk_bf16_f32 v105, v154, v155
    v_mfma_f32_16x16x16_bf16 v[140:143], v[130:131], v[72:73], 0
    v_cvt_pk_bf16_f32 v106, v156, v157
    v_cvt_pk_bf16_f32 v107, v158, v159
    v_mfma_f32_16x16x16_bf16 v[144:147], v[132:133], v[72:73], 0
    v_cvt_pk_bf16_f32 v108, v160, v161
    v_cvt_pk_bf16_f32 v109, v162, v163
    v_mfma_f32_16x16x16_bf16 v[148:151], v[134:135], v[72:73], 0
    v_cvt_pk_bf16_f32 v110, v164, v165
    v_cvt_pk_bf16_f32 v111, v166, v167
    buffer_store_dwordx4 v[104:107], v7, s[60:63], s100 offen sc1
    buffer_store_dwordx4 v[108:111], v7, s[60:63], s93 offen sc1
    v_pk_fma_f32 v[188:189], v[226:227], v[64:65], v[188:189] op_sel_hi:[1,0,1]
    v_pk_fma_f32 v[208:209], v[246:247], v[66:67], v[208:209] op_sel_hi:[1,0,1]
    v_pk_fma_f32 v[188:189], v[226:227], v[64:65], v[188:189] op_sel:[1,1,0] op_sel_hi:[0,1,1] neg_lo:[1,0,0]
    v_pk_fma_f32 v[208:209], v[246:247], v[66:67], v[208:209] op_sel:[1,1,0] op_sel_hi:[0,1,1] neg_lo:[1,0,0]
    v_pk_fma_f32 v[228:229], v[188:189], v[64:65], v[228:229] op_sel_hi:[1,0,1]
    v_pk_fma_f32 v[248:249], v[208:209], v[66:67], v[248:249] op_sel_hi:[1,0,1]
    v_pk_fma_f32 v[228:229], v[188:189], v[64:65], v[228:229] op_sel:[1,1,0] op_sel_hi:[0,1,1] neg_lo:[1,0,0]
    v_pk_fma_f32 v[248:249], v[208:209], v[66:67], v[248:249] op_sel:[1,1,0] op_sel_hi:[0,1,1] neg_lo:[1,0,0]
    v_pk_fma_f32 v[190:191], v[228:229], v[64:65], v[190:191] op_sel_hi:[1,0,1]
    v_pk_fma_f32 v[210:211], v[248:249], v[66:67], v[210:211] op_sel_hi:[1,0,1]
    v_pk_fma_f32 v[190:191], v[228:229], v[64:65], v[190:191] op_sel:[1,1,0] op_sel_hi:[0,1,1] neg_lo:[1,0,0]
    v_pk_fma_f32 v[210:211], v[248:249], v[66:67], v[210:211] op_sel:[1,1,0] op_sel_hi:[0,1,1] neg_lo:[1,0,0]
    v_pk_fma_f32 v[230:231], v[190:191], v[64:65], v[230:231] op_sel_hi:[1,0,1]
    v_pk_fma_f32 v[250:251], v[210:211], v[66:67], v[250:251] op_sel_hi:[1,0,1]
    v_pk_fma_f32 v[230:231], v[190:191], v[64:65], v[230:231] op_sel:[1,1,0] op_sel_hi:[0,1,1] neg_lo:[1,0,0]
    v_pk_fma_f32 v[250:251], v[210:211], v[66:67], v[250:251] op_sel:[1,1,0] op_sel_hi:[0,1,1] neg_lo:[1,0,0]
    v_cvt_pk_bf16_f32 v128, v188, v228
    v_cvt_pk_bf16_f32 v129, v190, v230
    v_cvt_pk_bf16_f32 v130, v208, v248
    v_cvt_pk_bf16_f32 v131, v210, v250
    v_cvt_pk_bf16_f32 v132, v189, v229
    v_cvt_pk_bf16_f32 v133, v191, v231
    v_cvt_pk_bf16_f32 v134, v209, v249
    v_cvt_pk_bf16_f32 v135, v211, v251
    v_mfma_f32_16x16x16_bf16 v[152:155], v[128:129], v[72:73], 0
    v_cvt_pk_bf16_f32 v96, v136, v137
    v_cvt_pk_bf16_f32 v97, v138, v139
    v_mfma_f32_16x16x16_bf16 v[156:159], v[130:131], v[72:73], 0
    v_cvt_pk_bf16_f32 v98, v140, v141
    v_cvt_pk_bf16_f32 v99, v142, v143
    v_mfma_f32_16x16x16_bf16 v[160:163], v[132:133], v[72:73], 0
    v_cvt_pk_bf16_f32 v100, v144, v145
    v_cvt_pk_bf16_f32 v101, v146, v147
    v_mfma_f32_16x16x16_bf16 v[164:167], v[134:135], v[72:73], 0
    v_cvt_pk_bf16_f32 v102, v148, v149
    v_cvt_pk_bf16_f32 v103, v150, v151
    buffer_store_dwordx4 v[96:99], v8, s[60:63], s100 offen sc1
    buffer_store_dwordx4 v[100:103], v8, s[60:63], s93 offen sc1
    v_pk_fma_f32 v[192:193], v[230:231], v[64:65], v[192:193] op_sel_hi:[1,0,1]
    v_pk_fma_f32 v[212:213], v[250:251], v[66:67], v[212:213] op_sel_hi:[1,0,1]
    v_pk_fma_f32 v[192:193], v[230:231], v[64:65], v[192:193] op_sel:[1,1,0] op_sel_hi:[0,1,1] neg_lo:[1,0,0]
    v_pk_fma_f32 v[212:213], v[250:251], v[66:67], v[212:213] op_sel:[1,1,0] op_sel_hi:[0,1,1] neg_lo:[1,0,0]
    v_pk_fma_f32 v[232:233], v[192:193], v[64:65], v[232:233] op_sel_hi:[1,0,1]
    v_pk_fma_f32 v[252:253], v[212:213], v[66:67], v[252:253] op_sel_hi:[1,0,1]
    v_pk_fma_f32 v[232:233], v[192:193], v[64:65], v[232:233] op_sel:[1,1,0] op_sel_hi:[0,1,1] neg_lo:[1,0,0]
    v_pk_fma_f32 v[252:253], v[212:213], v[66:67], v[252:253] op_sel:[1,1,0] op_sel_hi:[0,1,1] neg_lo:[1,0,0]
    v_pk_fma_f32 v[194:195], v[232:233], v[64:65], v[194:195] op_sel_hi:[1,0,1]
    v_pk_fma_f32 v[214:215], v[252:253], v[66:67], v[214:215] op_sel_hi:[1,0,1]
    v_pk_fma_f32 v[194:195], v[232:233], v[64:65], v[194:195] op_sel:[1,1,0] op_sel_hi:[0,1,1] neg_lo:[1,0,0]
    v_pk_fma_f32 v[214:215], v[252:253], v[66:67], v[214:215] op_sel:[1,1,0] op_sel_hi:[0,1,1] neg_lo:[1,0,0]
    v_pk_fma_f32 v[234:235], v[194:195], v[64:65], v[234:235] op_sel_hi:[1,0,1]
    v_pk_fma_f32 v[254:255], v[214:215], v[66:67], v[254:255] op_sel_hi:[1,0,1]
    v_pk_fma_f32 v[234:235], v[194:195], v[64:65], v[234:235] op_sel:[1,1,0] op_sel_hi:[0,1,1] neg_lo:[1,0,0]
    v_pk_fma_f32 v[254:255], v[214:215], v[66:67], v[254:255] op_sel:[1,1,0] op_sel_hi:[0,1,1] neg_lo:[1,0,0]
    v_cvt_pk_bf16_f32 v128, v192, v232
    v_cvt_pk_bf16_f32 v129, v194, v234
    v_cvt_pk_bf16_f32 v130, v212, v252
    v_cvt_pk_bf16_f32 v131, v214, v254
    v_cvt_pk_bf16_f32 v132, v193, v233
    v_cvt_pk_bf16_f32 v133, v195, v235
    v_cvt_pk_bf16_f32 v134, v213, v253
    v_cvt_pk_bf16_f32 v135, v215, v255
    v_mfma_f32_16x16x16_bf16 v[136:139], v[128:129], v[72:73], 0
    v_cvt_pk_bf16_f32 v104, v152, v153
    v_cvt_pk_bf16_f32 v105, v154, v155
    v_mfma_f32_16x16x16_bf16 v[140:143], v[130:131], v[72:73], 0
    v_cvt_pk_bf16_f32 v106, v156, v157
    v_cvt_pk_bf16_f32 v107, v158, v159
    v_mfma_f32_16x16x16_bf16 v[144:147], v[132:133], v[72:73], 0
    v_cvt_pk_bf16_f32 v108, v160, v161
    v_cvt_pk_bf16_f32 v109, v162, v163
    v_mfma_f32_16x16x16_bf16 v[148:151], v[134:135], v[72:73], 0
    v_cvt_pk_bf16_f32 v110, v164, v165
    v_cvt_pk_bf16_f32 v111, v166, v167
    buffer_store_dwordx4 v[104:107], v9, s[60:63], s100 offen sc1
    buffer_store_dwordx4 v[108:111], v9, s[60:63], s93 offen sc1
    v_cvt_pk_bf16_f32 v96, v136, v137
    v_cvt_pk_bf16_f32 v97, v138, v139
    v_cvt_pk_bf16_f32 v98, v140, v141
    v_cvt_pk_bf16_f32 v99, v142, v143
    v_cvt_pk_bf16_f32 v100, v144, v145
    v_cvt_pk_bf16_f32 v101, v146, v147
    v_cvt_pk_bf16_f32 v102, v148, v149
    v_cvt_pk_bf16_f32 v103, v150, v151
    buffer_store_dwordx4 v[96:99], v10, s[60:63], s100 offen sc1
    buffer_store_dwordx4 v[100:103], v10, s[60:63], s93 offen sc1
    s_waitcnt vmcnt(10)
L_g2:
L_pad13:
    s_cbranch_execz L_hopend
    s_nop 0
    s_mov_b32 s94, 0x00ff00ff
    s_mov_b32 s95, 0
    v_cmp_ne_u32 vcc, v34, v29
    s_nop 0
    s_and_b64 vcc, vcc, s[94:95]
    s_nop 2
    s_cbranch_vccnz L_sp_fla
L_ok_fla:
    s_cmp_lt_u32 s82, 5
    s_cselect_b64 vcc, -1, 0
    s_cbranch_vccz L_t5_s
    v_readlane_b32 s84, v28, 0
    s_nop 0
    s_cmp_lt_u32 s84, 276480
    s_cselect_b32 s62, 12513280, 0
    s_nop 1
    buffer_load_dwordx4 v[180:183], v32, s[60:63], s84 offen sc1
    s_add_u32 s84, s84, 5120
    buffer_load_dwordx4 v[204:207], v32, s[60:63], s84 offen sc1
    v_readlane_b32 s84, v28, 1
    s_nop 0
    s_cmp_lt_u32 s84, 276480
    s_cselect_b32 s62, 12513280, 0
    s_nop 1
    buffer_load_dwordx4 v[228:231], v32, s[60:63], s84 offen sc1
    s_add_u32 s84, s84, 5120
    buffer_load_dwordx4 v[252:255], v32, s[60:63], s84 offen sc1
L_t5_s:
    v_readlane_b32 s80, v28, 0
    s_nop 0
    s_cmp_lt_u32 s80, 276480
    s_cselect_b32 s50, 12513280, 0
    s_add_u32 s83, s80, 5120
    s_nop 0
    buffer_load_dwordx4 v[160:163], v30, s[48:51], s80 offen offset:0 sc1
    buffer_load_dwordx4 v[164:167], v30, s[48:51], s80 offen offset:1024 sc1
    buffer_load_dwordx4 v[168:171], v30, s[48:51], s80 offen offset:2048 sc1
    buffer_load_dwordx4 v[172:175], v30, s[48:51], s80 offen offset:3072 sc1
    buffer_load_dwordx4 v[176:179], v31, s[48:51], s80 offen offset:0 sc1
    buffer_load_dwordx4 v[184:187], v30, s[48:51], s83 offen offset:0 sc1
    buffer_load_dwordx4 v[188:191], v30, s[48:51], s83 offen offset:1024 sc1
    buffer_load_dwordx4 v[192:195], v30, s[48:51], s83 offen offset:2048 sc1
    buffer_load_dwordx4 v[196:199], v30, s[48:51], s83 offen offset:3072 sc1
    buffer_load_dwordx4 v[200:203], v31, s[48:51], s83 offen offset:0 sc1
    v_readlane_b32 s80, v28, 1
    s_nop 0
    s_cmp_lt_u32 s80, 276480
    s_cselect_b32 s50, 12513280, 0
    s_add_u32 s83, s80, 5120
    s_nop 0
    buffer_load_dwordx4 v[208:211], v30, s[48:51], s80 offen offset:0 sc1
    buffer_load_dwordx4 v[212:215], v30, s[48:51], s80 offen offset:1024 sc1
    buffer_load_dwordx4 v[216:219], v30, s[48:51], s80 offen offset:2048 sc1
    buffer_load_dwordx4 v[220:223], v30, s[48:51], s80 offen offset:3072 sc1
    buffer_load_dwordx4 v[224:227], v31, s[48:51], s80 offen offset:0 sc1
    s_waitcnt lgkmcnt(0)
    s_waitcnt vmcnt(10)
    v_mfma_f32_16x16x32_bf16 v[64:67], v[160:163], a[128:131], 0
    s_mov_b32 exec_hi, 0
    buffer_store_dword v29, v39, s[44:47], s76 offen sc1
    s_mov_b32 exec_hi, -1
    v_mfma_f32_16x16x32_bf16 v[68:71], v[160:163], a[132:135], 0
    v_mfma_f32_16x16x32_bf16 v[72:75], v[160:163], a[136:139], 0
    v_mfma_f32_16x16x32_bf16 v[76:79], v[160:163], a[140:143], 0
    buffer_load_dwordx4 v[232:235], v30, s[48:51], s83 offen offset:0 sc1
    v_mfma_f32_16x16x32_bf16 v[80:83], v[164:167], a[128:131], 0
    v_mfma_f32_16x16x32_bf16 v[84:87], v[164:167], a[132:135], 0
    v_mfma_f32_16x16x32_bf16 v[88:91], v[164:167], a[136:139], 0
    buffer_load_dwordx4 v[236:239], v30, s[48:51], s83 offen offset:1024 sc1
    v_mfma_f32_16x16x32_bf16 v[92:95], v[164:167], a[140:143], 0
    v_mfma_f32_16x16x32_bf16 v[96:99], v[168:171], a[128:131], 0
    v_mfma_f32_16x16x32_bf16 v[100:103], v[168:171], a[132:135], 0
    buffer_load_dwordx4 v[240:243], v30, s[48:51], s83 offen offset:2048 sc1
    v_mfma_f32_16x16x32_bf16 v[104:107], v[168:171], a[136:139], 0
    v_mfma_f32_16x16x32_bf16 v[108:111], v[168:171], a[140:143], 0
    v_mfma_f32_16x16x32_bf16 v[112:115], v[172:175], a[128:131], 0
    buffer_load_dwordx4 v[244:247], v30, s[48:51], s83 offen offset:3072 sc1
    v_mfma_f32_16x16x32_bf16 v[116:119], v[172:175], a[132:135], 0
    v_mfma_f32_16x16x32_bf16 v[120:123], v[172:175], a[136:139], 0
    v_mfma_f32_16x16x32_bf16 v[124:127], v[172:175], a[140:143], 0
    buffer_load_dwordx4 v[248:251], v31, s[48:51], s83 offen offset:0 sc1
    v_mfma_f32_16x16x32_bf16 v[128:131], v[176:179], a[128:131], 0
    v_mfma_f32_16x16x32_bf16 v[132:135], v[176:179], a[132:135], 0
    v_mfma_f32_16x16x32_bf16 v[136:139], v[176:179], a[136:139], 0
    v_mfma_f32_16x16x32_bf16 v[140:143], v[176:179], a[140:143], 0
    s_cbranch_vccz L_t5_0
    v_mfma_f32_16x16x32_bf16 v[144:147], v[180:183], a[128:131], 0
    v_readlane_b32 s84, v28, 2
    v_mfma_f32_16x16x32_bf16 v[148:151], v[180:183], a[132:135], 0
    v_mfma_f32_16x16x32_bf16 v[152:155], v[180:183], a[136:139], 0
    s_cmp_lt_u32 s84, 276480
    s_cselect_b32 s62, 12513280, 0
    v_mfma_f32_16x16x32_bf16 v[156:159], v[180:183], a[140:143], 0
    buffer_load_dwordx4 v[180:183], v32, s[60:63], s84 offen sc1
L_t5_0:
    s_waitcnt vmcnt(11)
    v_mfma_f32_16x16x32_bf16 v[64:67], v[184:187], a[144:147], v[64:67]
    s_mov_b32 s94, 0x3fff3fff
    s_cmp_eq_u32 s64, 3
    s_cselect_b32 s94, 0x0fff0fff, s94
    v_mfma_f32_16x16x32_bf16 v[68:71], v[184:187], a[148:151], v[68:71]
    s_mov_b32 s95, 0
    v_cmp_ne_u32_e64 vcc, v34, v29
    v_mfma_f32_16x16x32_bf16 v[72:75], v[184:187], a[152:155], v[72:75]
    v_mfma_f32_16x16x32_bf16 v[76:79], v[184:187], a[156:159], v[76:79]
    s_and_b64 vcc, vcc, s[94:95]
    v_mfma_f32_16x16x32_bf16 v[80:83], v[188:191], a[144:147], v[80:83]
    s_nop 0
    s_cbranch_vccz L_nopoll
    buffer_load_dword v34, v33, s[44:47], s74 offen sc1
L_nopoll:
    s_nop 0
    v_mfma_f32_16x16x32_bf16 v[84:87], v[188:191], a[148:151], v[84:87]
    s_cmp_lt_u32 s82, 5
    s_cselect_b64 vcc, -1, 0
    v_readlane_b32 s80, v28, 2
    v_mfma_f32_16x16x32_bf16 v[88:91], v[188:191], a[152:155], v[88:91]
    v_mfma_f32_16x16x32_bf16 v[92:95], v[188:191], a[156:159], v[92:95]
    s_cmp_lt_u32 s80, 276480
    s_cselect_b32 s50, 12513280, 0
    v_mfma_f32_16x16x32_bf16 v[96:99], v[192:195], a[144:147], v[96:99]
    s_add_u32 s83, s80, 5120
    v_mfma_f32_16x16x32_bf16 v[100:103], v[192:195], a[148:151], v[100:103]
    buffer_load_dwordx4 v[160:163], v30, s[48:51], s80 offen offset:0 sc1
    v_mfma_f32_16x16x32_bf16 v[104:107], v[192:195], a[152:155], v[104:107]
    buffer_load_dwordx4 v[164:167], v30, s[48:51], s80 offen offset:1024 sc1
    v_mfma_f32_16x16x32_bf16 v[108:111], v[192:195], a[156:159], v[108:111]
    v_mfma_f32_16x16x32_bf16 v[112:115], v[196:199], a[144:147], v[112:115]
    buffer_load_dwordx4 v[168:171], v30, s[48:51], s80 offen offset:2048 sc1
    v_mfma_f32_16x16x32_bf16 v[116:119], v[196:199], a[148:151], v[116:119]
    v_mfma_f32_16x16x32_bf16 v[120:123], v[196:199], a[152:155], v[120:123]
    buffer_load_dwordx4 v[172:175], v30, s[48:51], s80 offen offset:3072 sc1
    v_mfma_f32_16x16x32_bf16 v[124:127], v[196:199], a[156:159], v[124:127]
    v_mfma_f32_16x16x32_bf16 v[128:131], v[200:203], a[144:147], v[128:131]
    buffer_load_dwordx4 v[176:179], v31, s[48:51], s80 offen offset:0 sc1
    v_mfma_f32_16x16x32_bf16 v[132:135], v[200:203], a[148:151], v[132:135]
    v_mfma_f32_16x16x32_bf16 v[136:139], v[200:203], a[152:155], v[136:139]
    v_mfma_f32_16x16x32_bf16 v[140:143], v[200:203], a[156:159], v[140:143]
    s_cbranch_vccz L_t5_1
    v_mfma_f32_16x16x32_bf16 v[144:147], v[204:207], a[144:147], v[144:147]
    s_add_u32 s84, s84, 5120
    v_mfma_f32_16x16x32_bf16 v[148:151], v[204:207], a[148:151], v[148:151]
    v_mfma_f32_16x16x32_bf16 v[152:155], v[204:207], a[152:155], v[152:155]
    v_mfma_f32_16x16x32_bf16 v[156:159], v[204:207], a[156:159], v[156:159]
    buffer_load_dwordx4 v[204:207], v32, s[60:63], s84 offen sc1
L_t5_1:
    s_waitcnt vmcnt(11)
    v_mfma_f32_16x16x32_bf16 v[64:67], v[208:211], a[160:163], v[64:67]
    buffer_load_dwordx4 v[184:187], v30, s[48:51], s83 offen offset:0 sc1
    v_mfma_f32_16x16x32_bf16 v[68:71], v[208:211], a[164:167], v[68:71]
    v_mfma_f32_16x16x32_bf16 v[72:75], v[208:211], a[168:171], v[72:75]
    v_mfma_f32_16x16x32_bf16 v[76:79], v[208:211], a[172:175], v[76:79]
    buffer_load_dwordx4 v[188:191], v30, s[48:51], s83 offen offset:1024 sc1
    v_mfma_f32_16x16x32_bf16 v[80:83], v[212:215], a[160:163], v[80:83]
    v_mfma_f32_16x16x32_bf16 v[84:87], v[212:215], a[164:167], v[84:87]
    v_mfma_f32_16x16x32_bf16 v[88:91], v[212:215], a[168:171], v[88:91]
    v_mfma_f32_16x16x32_bf16 v[92:95], v[212:215], a[172:175], v[92:95]
    buffer_load_dwordx4 v[192:195], v30, s[48:51], s83 offen offset:2048 sc1
    v_mfma_f32_16x16x32_bf16 v[96:99], v[216:219], a[160:163], v[96:99]
    v_mfma_f32_16x16x32_bf16 v[100:103], v[216:219], a[164:167], v[100:103]
    v_mfma_f32_16x16x32_bf16 v[104:107], v[216:219], a[168:171], v[104:107]
    v_mfma_f32_16x16x32_bf16 v[108:111], v[216:219], a[172:175], v[108:111]
    buffer_load_dwordx4 v[196:199], v30, s[48:51], s83 offen offset:3072 sc1
    v_mfma_f32_16x16x32_bf16 v[112:115], v[220:223], a[160:163], v[112:115]
    v_mfma_f32_16x16x32_bf16 v[116:119], v[220:223], a[164:167], v[116:119]
    v_mfma_f32_16x16x32_bf16 v[120:123], v[220:223], a[168:171], v[120:123]
    v_mfma_f32_16x16x32_bf16 v[124:127], v[220:223], a[172:175], v[124:127]
    buffer_load_dwordx4 v[200:203], v31, s[48:51], s83 offen offset:0 sc1
    v_mfma_f32_16x16x32_bf16 v[128:131], v[224:227], a[160:163], v[128:131]
    v_mfma_f32_16x16x32_bf16 v[132:135], v[224:227], a[164:167], v[132:135]
    v_mfma_f32_16x16x32_bf16 v[136:139], v[224:227], a[168:171], v[136:139]
    v_mfma_f32_16x16x32_bf16 v[140:143], v[224:227], a[172:175], v[140:143]
    s_cbranch_vccz L_t5_2
    v_mfma_f32_16x16x32_bf16 v[144:147], v[228:231], a[160:163], v[144:147]
    v_readlane_b32 s84, v28, 3
    v_mfma_f32_16x16x32_bf16 v[148:151], v[228:231], a[164:167], v[148:151]
    v_mfma_f32_16x16x32_bf16 v[152:155], v[228:231], a[168:171], v[152:155]
    s_cmp_lt_u32 s84, 276480
    s_cselect_b32 s62, 12513280, 0
    v_mfma_f32_16x16x32_bf16 v[156:159], v[228:231], a[172:175], v[156:159]
    buffer_load_dwordx4 v[228:231], v32, s[60:63], s84 offen sc1
L_t5_2:
    s_waitcnt vmcnt(10)
    v_mfma_f32_16x16x32_bf16 v[64:67], v[232:235], a[176:179], v[64:67]
    v_readlane_b32 s80, v28, 3
    v_mfma_f32_16x16x32_bf16 v[68:71], v[232:235], a[180:183], v[68:71]
    v_mfma_f32_16x16x32_bf16 v[72:75], v[232:235], a[184:187], v[72:75]
    s_cmp_lt_u32 s80, 276480
    s_cselect_b32 s50, 12513280, 0
    v_mfma_f32_16x16x32_bf16 v[76:79], v[232:235], a[188:191], v[76:79]
    s_add_u32 s83, s80, 5120
    v_mfma_f32_16x16x32_bf16 v[80:83], v[236:239], a[176:179], v[80:83]
    buffer_load_dwordx4 v[208:211], v30, s[48:51], s80 offen offset:0 sc1
    v_mfma_f32_16x16x32_bf16 v[84:87], v[236:239], a[180:183], v[84:87]
    v_mfma_f32_16x16x32_bf16 v[88:91], v[236:239], a[184:187], v[88:91]
    v_mfma_f32_16x16x32_bf16 v[92:95], v[236:239], a[188:191], v[92:95]
    buffer_load_dwordx4 v[212:215], v30, s[48:51], s80 offen offset:1024 sc1
    v_mfma_f32_16x16x32_bf16 v[96:99], v[240:243], a[176:179], v[96:99]
    v_mfma_f32_16x16x32_bf16 v[100:103], v[240:243], a[180:183], v[100:103]
    v_mfma_f32_16x16x32_bf16 v[104:107], v[240:243], a[184:187], v[104:107]
    buffer_load_dwordx4 v[216:219], v30, s[48:51], s80 offen offset:2048 sc1
    v_mfma_f32_16x16x32_bf16 v[108:111], v[240:243], a[188:191], v[108:111]
    v_mfma_f32_16x16x32_bf16 v[112:115], v[244:247], a[176:179], v[112:115]
    v_mfma_f32_16x16x32_bf16 v[116:119], v[244:247], a[180:183], v[116:119]
    buffer_load_dwordx4 v[220:223], v30, s[48:51], s80 offen offset:3072 sc1
    v_mfma_f32_16x16x32_bf16 v[120:123], v[244:247], a[184:187], v[120:123]
    v_mfma_f32_16x16x32_bf16 v[124:127], v[244:247], a[188:191], v[124:127]
    v_mfma_f32_16x16x32_bf16 v[128:131], v[248:251], a[176:179], v[128:131]
    buffer_load_dwordx4 v[224:227], v31, s[48:51], s80 offen offset:0 sc1
    v_mfma_f32_16x16x32_bf16 v[132:135], v[248:251], a[180:183], v[132:135]
    v_mfma_f32_16x16x32_bf16 v[136:139], v[248:251], a[184:187], v[136:139]
    v_mfma_f32_16x16x32_bf16 v[140:143], v[248:251], a[188:191], v[140:143]
    s_cbranch_vccz L_t5_3
    v_mfma_f32_16x16x32_bf16 v[144:147], v[252:255], a[176:179], v[144:147]
    s_add_u32 s84, s84, 5120
    v_mfma_f32_16x16x32_bf16 v[148:151], v[252:255], a[180:183], v[148:151]
    v_mfma_f32_16x16x32_bf16 v[152:155], v[252:255], a[184:187], v[152:155]
    v_mfma_f32_16x16x32_bf16 v[156:159], v[252:255], a[188:191], v[156:159]
    buffer_load_dwordx4 v[252:255], v32, s[60:63], s84 offen sc1
L_t5_3:
    s_waitcnt vmcnt(10)
    v_mfma_f32_16x16x32_bf16 v[64:67], v[160:163], a[192:195], v[64:67]
    v_cmp_ne_u32_e64 vcc, v34, v29
    v_mfma_f32_16x16x32_bf16 v[68:71], v[160:163], a[196:199], v[68:71]
    v_mfma_f32_16x16x32_bf16 v[72:75], v[160:163], a[200:203], v[72:75]
    s_and_b64 vcc, vcc, s[94:95]
    v_mfma_f32_16x16x32_bf16 v[76:79], v[160:163], a[204:207], v[76:79]
    s_nop 0
    s_cbranch_vccnz L_sp_fl0
L_ok_fl0:
    v_mfma_f32_16x16x32_bf16 v[80:83], v[164:167], a[192:195], v[80:83]
    s_cmp_lt_u32 s82, 5
    s_cselect_b64 vcc, -1, 0
    v_mfma_f32_16x16x32_bf16 v[84:87], v[164:167], a[196:199], v[84:87]
    buffer_load_dwordx4 v[232:235], v30, s[48:51], s83 offen offset:0 sc1
    v_mfma_f32_16x16x32_bf16 v[88:91], v[164:167], a[200:203], v[88:91]
    v_mfma_f32_16x16x32_bf16 v[92:95], v[164:167], a[204:207], v[92:95]
    buffer_load_dwordx4 v[236:239], v30, s[48:51], s83 offen offset:1024 sc1
    v_mfma_f32_16x16x32_bf16 v[96:99], v[168:171], a[192:195], v[96:99]
    v_mfma_f32_16x16x32_bf16 v[100:103], v[168:171], a[196:199], v[100:103]
    v_mfma_f32_16x16x32_bf16 v[104:107], v[168:171], a[200:203], v[104:107]
    buffer_load_dwordx4 v[240:243], v30, s[48:51], s83 offen offset:2048 sc1
    v_mfma_f32_16x16x32_bf16 v[108:111], v[168:171], a[204:207], v[108:111]
    v_mfma_f32_16x16x32_bf16 v[112:115], v[172:175], a[192:195], v[112:115]
    v_mfma_f32_16x16x32_bf16 v[116:119], v[172:175], a[196:199], v[116:119]
    buffer_load_dwordx4 v[244:247], v30, s[48:51], s83 offen offset:3072 sc1
    v_mfma_f32_16x16x32_bf16 v[120:123], v[172:175], a[200:203], v[120:123]
    v_mfma_f32_16x16x32_bf16 v[124:127], v[172:175], a[204:207], v[124:127]
    v_mfma_f32_16x16x32_bf16 v[128:131], v[176:179], a[192:195], v[128:131]
    buffer_load_dwordx4 v[248:251], v31, s[48:51], s83 offen offset:0 sc1
    v_mfma_f32_16x16x32_bf16 v[132:135], v[176:179], a[196:199], v[132:135]
    v_mfma_f32_16x16x32_bf16 v[136:139], v[176:179], a[200:203], v[136:139]
    v_mfma_f32_16x16x32_bf16 v[140:143], v[176:179], a[204:207], v[140:143]
    s_cbranch_vccz L_t5_4
    v_mfma_f32_16x16x32_bf16 v[144:147], v[180:183], a[192:195], v[144:147]
    v_readlane_b32 s84, v28, 4
    v_mfma_f32_16x16x32_bf16 v[148:151], v[180:183], a[196:199], v[148:151]
    v_mfma_f32_16x16x32_bf16 v[152:155], v[180:183], a[200:203], v[152:155]
    s_cmp_lt_u32 s84, 276480
    s_cselect_b32 s62, 12513280, 0
    v_mfma_f32_16x16x32_bf16 v[156:159], v[180:183], a[204:207], v[156:159]
    buffer_load_dwordx4 v[180:183], v32, s[60:63], s84 offen sc1
L_t5_4:
    s_waitcnt vmcnt(10)
    v_mfma_f32_16x16x32_bf16 v[64:67], v[184:187], a[208:211], v[64:67]
    v_readlane_b32 s80, v28, 4
    v_bfe_u32 v16, v0, 2, 2
    v_mfma_f32_16x16x32_bf16 v[68:71], v[184:187], a[212:215], v[68:71]
    v_lshlrev_b32 v17, 8, v16
    v_mfma_f32_16x16x32_bf16 v[72:75], v[184:187], a[216:219], v[72:75]
    s_cmp_lt_u32 s80, 276480
    s_cselect_b32 s50, 12513280, 0
    v_mfma_f32_16x16x32_bf16 v[76:79], v[184:187], a[220:223], v[76:79]
    s_add_u32 s83, s80, 5120
    v_and_b32_e64 v16, 2, v16
    v_mfma_f32_16x16x32_bf16 v[80:83], v[188:191], a[208:211], v[80:83]
    buffer_load_dwordx4 v[160:163], v30, s[48:51], s80 offen offset:0 sc1
    v_mfma_f32_16x16x32_bf16 v[84:87], v[188:191], a[212:215], v[84:87]
    v_lshl_add_u32 v17, v16, 6, v17
    v_mfma_f32_16x16x32_bf16 v[88:91], v[188:191], a[216:219], v[88:91]
    v_mfma_f32_16x16x32_bf16 v[92:95], v[188:191], a[220:223], v[92:95]
    buffer_load_dwordx4 v[164:167], v30, s[48:51], s80 offen offset:1024 sc1
    v_mfma_f32_16x16x32_bf16 v[96:99], v[192:195], a[208:211], v[96:99]
    v_lshl_add_u32 v17, v26, 6, v17
    v_mfma_f32_16x16x32_bf16 v[100:103], v[192:195], a[212:215], v[100:103]
    v_and_b32_e64 v16, 3, v0
    v_mfma_f32_16x16x32_bf16 v[104:107], v[192:195], a[216:219], v[104:107]
    buffer_load_dwordx4 v[168:171], v30, s[48:51], s80 offen offset:2048 sc1
    v_mfma_f32_16x16x32_bf16 v[108:111], v[192:195], a[220:223], v[108:111]
    v_lshl_add_u32 v17, v16, 4, v17
    v_mfma_f32_16x16x32_bf16 v[112:115], v[196:199], a[208:211], v[112:115]
    v_mfma_f32_16x16x32_bf16 v[116:119], v[196:199], a[212:215], v[116:119]
    s_add_u32 s93, s64, 0
    s_mul_i32 s94, s93, 37
    v_mfma_f32_16x16x32_bf16 v[120:123], v[196:199], a[216:219], v[120:123]
    buffer_load_dwordx4 v[172:175], v30, s[48:51], s80 offen offset:3072 sc1
    v_mfma_f32_16x16x32_bf16 v[124:127], v[196:199], a[220:223], v[124:127]
    s_lshr_b32 s94, s94, 8
    s_mul_i32 s94, s94, 24704
    s_mul_i32 s93, s93, 1152
    v_mfma_f32_16x16x32_bf16 v[128:131], v[200:203], a[208:211], v[128:131]
    s_add_u32 s93, s93, s94
    v_add_u32_e64 v3, s93, v17
    v_mfma_f32_16x16x32_bf16 v[132:135], v[200:203], a[212:215], v[132:135]
    buffer_load_dwordx4 v[176:179], v31, s[48:51], s80 offen offset:0 sc1
    v_mfma_f32_16x16x32_bf16 v[136:139], v[200:203], a[216:219], v[136:139]
    s_add_u32 s93, s64, 4
    v_mfma_f32_16x16x32_bf16 v[140:143], v[200:203], a[220:223], v[140:143]
    s_cbranch_vccz L_t5_5
    v_mfma_f32_16x16x32_bf16 v[144:147], v[204:207], a[208:211], v[144:147]
    s_add_u32 s84, s84, 5120
    v_mfma_f32_16x16x32_bf16 v[148:151], v[204:207], a[212:215], v[148:151]
    v_mfma_f32_16x16x32_bf16 v[152:155], v[204:207], a[216:219], v[152:155]
    v_mfma_f32_16x16x32_bf16 v[156:159], v[204:207], a[220:223], v[156:159]
    buffer_load_dwordx4 v[204:207], v32, s[60:63], s84 offen sc1
L_t5_5:
    s_waitcnt vmcnt(10)
    v_mfma_f32_16x16x32_bf16 v[64:67], v[208:211], a[0:3], v[64:67]
    buffer_load_dwordx4 v[184:187], v30, s[48:51], s83 offen offset:0 sc1
    v_mfma_f32_16x16x32_bf16 v[68:71], v[208:211], a[4:7], v[68:71]
    s_mul_i32 s94, s93, 37
    s_lshr_b32 s94, s94, 8
    s_mul_i32 s94, s94, 24704
    v_mfma_f32_16x16x32_bf16 v[72:75], v[208:211], a[8:11], v[72:75]
    s_mul_i32 s93, s93, 1152
    v_mfma_f32_16x16x32_bf16 v[76:79], v[208:211], a[12:15], v[76:79]
    buffer_load_dwordx4 v[188:191], v30, s[48:51], s83 offen offset:1024 sc1
    v_mfma_f32_16x16x32_bf16 v[80:83], v[212:215], a[0:3], v[80:83]
    s_add_u32 s93, s93, s94
    v_add_u32_e64 v4, s93, v17
    v_mfma_f32_16x16x32_bf16 v[84:87], v[212:215], a[4:7], v[84:87]
    v_mfma_f32_16x16x32_bf16 v[88:91], v[212:215], a[8:11], v[88:91]
    v_mfma_f32_16x16x32_bf16 v[92:95], v[212:215], a[12:15], v[92:95]
    buffer_load_dwordx4 v[192:195], v30, s[48:51], s83 offen offset:2048 sc1
    v_mfma_f32_16x16x32_bf16 v[96:99], v[216:219], a[0:3], v[96:99]
    s_add_u32 s93, s64, 8
    v_mfma_f32_16x16x32_bf16 v[100:103], v[216:219], a[4:7], v[100:103]
    s_mul_i32 s94, s93, 37
    s_lshr_b32 s94, s94, 8
    v_mfma_f32_16x16x32_bf16 v[104:107], v[216:219], a[8:11], v[104:107]
    s_mul_i32 s94, s94, 24704
    v_mfma_f32_16x16x32_bf16 v[108:111], v[216:219], a[12:15], v[108:111]
    buffer_load_dwordx4 v[196:199], v30, s[48:51], s83 offen offset:3072 sc1
    v_mfma_f32_16x16x32_bf16 v[112:115], v[220:223], a[0:3], v[112:115]
    s_mul_i32 s93, s93, 1152
    s_add_u32 s93, s93, s94
    v_mfma_f32_16x16x32_bf16 v[116:119], v[220:223], a[4:7], v[116:119]
    v_add_u32_e64 v5, s93, v17
    v_mfma_f32_16x16x32_bf16 v[120:123], v[220:223], a[8:11], v[120:123]
    v_mfma_f32_16x16x32_bf16 v[124:127], v[220:223], a[12:15], v[124:127]
    buffer_load_dwordx4 v[200:203], v31, s[48:51], s83 offen offset:0 sc1
    v_mfma_f32_16x16x32_bf16 v[128:131], v[224:227], a[0:3], v[128:131]
    v_mfma_f32_16x16x32_bf16 v[132:135], v[224:227], a[4:7], v[132:135]
    s_add_u32 s93, s64, 12
    v_mfma_f32_16x16x32_bf16 v[136:139], v[224:227], a[8:11], v[136:139]
    s_mul_i32 s94, s93, 37
    v_mfma_f32_16x16x32_bf16 v[140:143], v[224:227], a[12:15], v[140:143]
    s_cbranch_vccz L_t5_6
    v_mfma_f32_16x16x32_bf16 v[144:147], v[228:231], a[0:3], v[144:147]
    v_readlane_b32 s84, v28, 5
    v_mfma_f32_16x16x32_bf16 v[148:151], v[228:231], a[4:7], v[148:151]
    v_mfma_f32_16x16x32_bf16 v[152:155], v[228:231], a[8:11], v[152:155]
    s_cmp_lt_u32 s84, 276480
    s_cselect_b32 s62, 12513280, 0
    v_mfma_f32_16x16x32_bf16 v[156:159], v[228:231], a[12:15], v[156:159]
    buffer_load_dwordx4 v[228:231], v32, s[60:63], s84 offen sc1
L_t5_6:
    s_waitcnt vmcnt(10)
L_pad14:
    s_cbranch_execz L_hopend
    s_nop 0
    v_mfma_f32_16x16x32_bf16 v[64:67], v[232:235], a[16:19], v[64:67]
    v_readlane_b32 s80, v28, 5
    v_mfma_f32_16x16x32_bf16 v[68:71], v[232:235], a[20:23], v[68:71]
    s_lshr_b32 s94, s94, 8
    s_mul_i32 s94, s94, 24704
    s_mul_i32 s93, s93, 1152
    v_mfma_f32_16x16x32_bf16 v[72:75], v[232:235], a[24:27], v[72:75]
    s_cmp_lt_u32 s80, 276480
    s_cselect_b32 s50, 12513280, 0
    s_add_u32 s93, s93, s94
    v_mfma_f32_16x16x32_bf16 v[76:79], v[232:235], a[28:31], v[76:79]
    s_add_u32 s83, s80, 5120
    v_add_u32_e64 v6, s93, v17
    v_mfma_f32_16x16x32_bf16 v[80:83], v[236:239], a[16:19], v[80:83]
    buffer_load_dwordx4 v[208:211], v30, s[48:51], s80 offen offset:0 sc1
    v_mfma_f32_16x16x32_bf16 v[84:87], v[236:239], a[20:23], v[84:87]
    v_mfma_f32_16x16x32_bf16 v[88:91], v[236:239], a[24:27], v[88:91]
    v_mfma_f32_16x16x32_bf16 v[92:95], v[236:239], a[28:31], v[92:95]
    s_add_u32 s93, s64, 16
    v_mfma_f32_16x16x32_bf16 v[96:99], v[240:243], a[16:19], v[96:99]
    buffer_load_dwordx4 v[212:215], v30, s[48:51], s80 offen offset:1024 sc1
    v_mfma_f32_16x16x32_bf16 v[100:103], v[240:243], a[20:23], v[100:103]
    s_mul_i32 s94, s93, 37
    s_lshr_b32 s94, s94, 8
    s_mul_i32 s94, s94, 24704
    v_mfma_f32_16x16x32_bf16 v[104:107], v[240:243], a[24:27], v[104:107]
    buffer_load_dwordx4 v[216:219], v30, s[48:51], s80 offen offset:2048 sc1
    v_mfma_f32_16x16x32_bf16 v[108:111], v[240:243], a[28:31], v[108:111]
    s_mul_i32 s93, s93, 1152
    s_add_u32 s93, s93, s94
    v_mfma_f32_16x16x32_bf16 v[112:115], v[244:247], a[16:19], v[112:115]
    v_add_u32_e64 v7, s93, v17
    v_mfma_f32_16x16x32_bf16 v[116:119], v[244:247], a[20:23], v[116:119]
    buffer_load_dwordx4 v[220:223], v30, s[48:51], s80 offen offset:3072 sc1
    v_mfma_f32_16x16x32_bf16 v[120:123], v[244:247], a[24:27], v[120:123]
    v_mfma_f32_16x16x32_bf16 v[124:127], v[244:247], a[28:31], v[124:127]
    v_mfma_f32_16x16x32_bf16 v[128:131], v[248:251], a[16:19], v[128:131]
    s_add_u32 s93, s64, 20
    v_mfma_f32_16x16x32_bf16 v[132:135], v[248:251], a[20:23], v[132:135]
    buffer_load_dwordx4 v[224:227], v31, s[48:51], s80 offen offset:0 sc1
    v_mfma_f32_16x16x32_bf16 v[136:139], v[248:251], a[24:27], v[136:139]
    s_mul_i32 s94, s93, 37
    s_lshr_b32 s94, s94, 8
    v_mfma_f32_16x16x32_bf16 v[140:143], v[248:251], a[28:31], v[140:143]
    s_cbranch_vccz L_t5_7
    v_mfma_f32_16x16x32_bf16 v[144:147], v[252:255], a[16:19], v[144:147]
    s_add_u32 s84, s84, 5120
    v_mfma_f32_16x16x32_bf16 v[148:151], v[252:255], a[20:23], v[148:151]
    v_mfma_f32_16x16x32_bf16 v[152:155], v[252:255], a[24:27], v[152:155]
    v_mfma_f32_16x16x32_bf16 v[156:159], v[252:255], a[28:31], v[156:159]
    buffer_load_dwordx4 v[252:255], v32, s[60:63], s84 offen sc1
L_t5_7:
    s_waitcnt vmcnt(10)
    v_mfma_f32_16x16x32_bf16 v[64:67], v[160:163], a[32:35], v[64:67]
    buffer_load_dwordx4 v[232:235], v30, s[48:51], s83 offen offset:0 sc1
    v_mfma_f32_16x16x32_bf16 v[68:71], v[160:163], a[36:39], v[68:71]
    s_mul_i32 s94, s94, 24704
    s_mul_i32 s93, s93, 1152
    s_add_u32 s93, s93, s94
    v_mfma_f32_16x16x32_bf16 v[72:75], v[160:163], a[40:43], v[72:75]
    v_add_u32_e64 v8, s93, v17
    v_mfma_f32_16x16x32_bf16 v[76:79], v[160:163], a[44:47], v[76:79]
    buffer_load_dwordx4 v[236:239], v30, s[48:51], s83 offen offset:1024 sc1
    v_mfma_f32_16x16x32_bf16 v[80:83], v[164:167], a[32:35], v[80:83]
    v_add_u32 v11, 10240, v37
    v_mfma_f32_16x16x32_bf16 v[84:87], v[164:167], a[36:39], v[84:87]
    v_mfma_f32_16x16x32_bf16 v[88:91], v[164:167], a[40:43], v[88:91]
    v_mfma_f32_16x16x32_bf16 v[92:95], v[164:167], a[44:47], v[92:95]
    v_add_u32 v12, 20480, v37
    v_mfma_f32_16x16x32_bf16 v[96:99], v[168:171], a[32:35], v[96:99]
    buffer_load_dwordx4 v[240:243], v30, s[48:51], s83 offen offset:2048 sc1
    v_mfma_f32_16x16x32_bf16 v[100:103], v[168:171], a[36:39], v[100:103]
    v_add_u32 v13, 30720, v37
    v_mfma_f32_16x16x32_bf16 v[104:107], v[168:171], a[40:43], v[104:107]
    v_mfma_f32_16x16x32_bf16 v[108:111], v[168:171], a[44:47], v[108:111]
    buffer_load_dwordx4 v[244:247], v30, s[48:51], s83 offen offset:3072 sc1
    v_mfma_f32_16x16x32_bf16 v[112:115], v[172:175], a[32:35], v[112:115]
    v_add_u32 v14, 40960, v37
    v_mfma_f32_16x16x32_bf16 v[116:119], v[172:175], a[36:39], v[116:119]
    v_mfma_f32_16x16x32_bf16 v[120:123], v[172:175], a[40:43], v[120:123]
    s_mov_b64 s[56:57], s[30:31]
    v_mfma_f32_16x16x32_bf16 v[124:127], v[172:175], a[44:47], v[124:127]
    buffer_load_dwordx4 v[248:251], v31, s[48:51], s83 offen offset:0 sc1
    v_mfma_f32_16x16x32_bf16 v[128:131], v[176:179], a[32:35], v[128:131]
    s_mov_b32 s58, 5242880
    s_mov_b32 m0, s85
    v_mfma_f32_16x16x32_bf16 v[132:135], v[176:179], a[36:39], v[132:135]
    s_cmp_eq_u32 s64, 0
    s_cselect_b32 s92, 0xffff0000, -1
    s_add_u32 s93, s64, s82
    v_mfma_f32_16x16x32_bf16 v[136:139], v[176:179], a[40:43], v[136:139]
    s_cmp_eq_u32 s93, 0
    s_cselect_b32 s93, 0xffff0000, -1
    v_mfma_f32_16x16x32_bf16 v[140:143], v[176:179], a[44:47], v[140:143]
    s_cbranch_vccz L_t5_8
    v_mfma_f32_16x16x32_bf16 v[144:147], v[180:183], a[32:35], v[144:147]
    v_readlane_b32 s84, v28, 6
    v_mfma_f32_16x16x32_bf16 v[148:151], v[180:183], a[36:39], v[148:151]
    v_mfma_f32_16x16x32_bf16 v[152:155], v[180:183], a[40:43], v[152:155]
    s_cmp_lt_u32 s84, 276480
    s_cselect_b32 s62, 12513280, 0
    v_mfma_f32_16x16x32_bf16 v[156:159], v[180:183], a[44:47], v[156:159]
    buffer_load_dwordx4 v[180:183], v32, s[60:63], s84 offen sc1
L_t5_8:
    s_waitcnt vmcnt(10)
    v_mfma_f32_16x16x32_bf16 v[64:67], v[184:187], a[48:51], v[64:67]
    v_readlane_b32 s80, v28, 6
    v_mfma_f32_16x16x32_bf16 v[68:71], v[184:187], a[52:55], v[68:71]
    v_mfma_f32_16x16x32_bf16 v[72:75], v[184:187], a[56:59], v[72:75]
    s_cmp_lt_u32 s80, 276480
    s_cselect_b32 s50, 12513280, 0
    v_mfma_f32_16x16x32_bf16 v[76:79], v[184:187], a[60:63], v[76:79]
    s_add_u32 s83, s80, 5120
    v_mfma_f32_16x16x32_bf16 v[80:83], v[188:191], a[48:51], v[80:83]
    buffer_load_dwordx4 v[160:163], v30, s[48:51], s80 offen offset:0 sc1
    v_mfma_f32_16x16x32_bf16 v[84:87], v[188:191], a[52:55], v[84:87]
    v_mfma_f32_16x16x32_bf16 v[88:91], v[188:191], a[56:59], v[88:91]
    buffer_load_dwordx4 v[164:167], v30, s[48:51], s80 offen offset:1024 sc1
    v_mfma_f32_16x16x32_bf16 v[92:95], v[188:191], a[60:63], v[92:95]
    v_mfma_f32_16x16x32_bf16 v[96:99], v[192:195], a[48:51], v[96:99]
    buffer_load_dwordx4 v[168:171], v30, s[48:51], s80 offen offset:2048 sc1
    v_mfma_f32_16x16x32_bf16 v[100:103], v[192:195], a[52:55], v[100:103]
    v_mfma_f32_16x16x32_bf16 v[104:107], v[192:195], a[56:59], v[104:107]
    buffer_load_dwordx4 v[172:175], v30, s[48:51], s80 offen offset:3072 sc1
    v_mfma_f32_16x16x32_bf16 v[108:111], v[192:195], a[60:63], v[108:111]
    v_mfma_f32_16x16x32_bf16 v[112:115], v[196:199], a[48:51], v[112:115]
    buffer_load_dwordx4 v[176:179], v31, s[48:51], s80 offen offset:0 sc1
    v_mfma_f32_16x16x32_bf16 v[116:119], v[196:199], a[52:55], v[116:119]
    v_mfma_f32_16x16x32_bf16 v[120:123], v[196:199], a[56:59], v[120:123]
    v_mfma_f32_16x16x32_bf16 v[124:127], v[196:199], a[60:63], v[124:127]
    s_lshl_b32 s74, s65, 11
    s_add_u32 s74, s74, 352256
    v_mfma_f32_16x16x32_bf16 v[128:131], v[200:203], a[48:51], v[128:131]
    buffer_load_dword v34, v33, s[44:47], s74 offen sc1
    v_mfma_f32_16x16x32_bf16 v[132:135], v[200:203], a[52:55], v[132:135]
    v_mfma_f32_16x16x32_bf16 v[136:139], v[200:203], a[56:59], v[136:139]
    v_mfma_f32_16x16x32_bf16 v[140:143], v[200:203], a[60:63], v[140:143]
    s_cbranch_vccz L_t5_9
    v_mfma_f32_16x16x32_bf16 v[144:147], v[204:207], a[48:51], v[144:147]
    s_add_u32 s84, s84, 5120
    v_mfma_f32_16x16x32_bf16 v[148:151], v[204:207], a[52:55], v[148:151]
    v_mfma_f32_16x16x32_bf16 v[152:155], v[204:207], a[56:59], v[152:155]
    v_mfma_f32_16x16x32_bf16 v[156:159], v[204:207], a[60:63], v[156:159]
    buffer_load_dwordx4 v[204:207], v32, s[60:63], s84 offen sc1
L_t5_9:
    s_waitcnt vmcnt(11)
    v_mfma_f32_16x16x32_bf16 v[64:67], v[208:211], a[64:67], v[64:67]
    buffer_load_dwordx4 v[184:187], v30, s[48:51], s83 offen offset:0 sc1
    v_mfma_f32_16x16x32_bf16 v[68:71], v[208:211], a[68:71], v[68:71]
    v_mfma_f32_16x16x32_bf16 v[72:75], v[208:211], a[72:75], v[72:75]
    v_mfma_f32_16x16x32_bf16 v[76:79], v[208:211], a[76:79], v[76:79]
    buffer_load_dwordx4 v[188:191], v30, s[48:51], s83 offen offset:1024 sc1
    v_mfma_f32_16x16x32_bf16 v[80:83], v[212:215], a[64:67], v[80:83]
    v_mfma_f32_16x16x32_bf16 v[84:87], v[212:215], a[68:71], v[84:87]
    v_mfma_f32_16x16x32_bf16 v[88:91], v[212:215], a[72:75], v[88:91]
    v_mfma_f32_16x16x32_bf16 v[92:95], v[212:215], a[76:79], v[92:95]
    buffer_load_dwordx4 v[192:195], v30, s[48:51], s83 offen offset:2048 sc1
    v_mfma_f32_16x16x32_bf16 v[96:99], v[216:219], a[64:67], v[96:99]
    v_mfma_f32_16x16x32_bf16 v[100:103], v[216:219], a[68:71], v[100:103]
    v_mfma_f32_16x16x32_bf16 v[104:107], v[216:219], a[72:75], v[104:107]
    v_mfma_f32_16x16x32_bf16 v[108:111], v[216:219], a[76:79], v[108:111]
    buffer_load_dwordx4 v[196:199], v30, s[48:51], s83 offen offset:3072 sc1
    v_mfma_f32_16x16x32_bf16 v[112:115], v[220:223], a[64:67], v[112:115]
    v_mfma_f32_16x16x32_bf16 v[116:119], v[220:223], a[68:71], v[116:119]
    v_mfma_f32_16x16x32_bf16 v[120:123], v[220:223], a[72:75], v[120:123]
    v_mfma_f32_16x16x32_bf16 v[124:127], v[220:223], a[76:79], v[124:127]
    buffer_load_dwordx4 v[200:203], v31, s[48:51], s83 offen offset:0 sc1
    v_mfma_f32_16x16x32_bf16 v[128:131], v[224:227], a[64:67], v[128:131]
    v_mfma_f32_16x16x32_bf16 v[132:135], v[224:227], a[68:71], v[132:135]
    v_mfma_f32_16x16x32_bf16 v[136:139], v[224:227], a[72:75], v[136:139]
    v_mfma_f32_16x16x32_bf16 v[140:143], v[224:227], a[76:79], v[140:143]
    s_cbranch_vccz L_t5_10
    v_mfma_f32_16x16x32_bf16 v[144:147], v[228:231], a[64:67], v[144:147]
    v_mfma_f32_16x16x32_bf16 v[148:151], v[228:231], a[68:71], v[148:151]
    v_mfma_f32_16x16x32_bf16 v[152:155], v[228:231], a[72:75], v[152:155]
    v_mfma_f32_16x16x32_bf16 v[156:159], v[228:231], a[76:79], v[156:159]
L_t5_10:
    s_waitcnt vmcnt(11)
    v_mfma_f32_16x16x32_bf16 v[64:67], v[232:235], a[80:83], v[64:67]
    s_waitcnt vmcnt(5)
    s_mov_b32 s94, 0x03ff03ff
    v_mfma_f32_16x16x32_bf16 v[68:71], v[232:235], a[84:87], v[68:71]
    s_mov_b32 s95, 0
    v_cmp_ne_u32_e64 vcc, v34, v29
    v_mfma_f32_16x16x32_bf16 v[72:75], v[232:235], a[88:91], v[72:75]
    v_mfma_f32_16x16x32_bf16 v[76:79], v[232:235], a[92:95], v[76:79]
    s_and_b64 vcc, vcc, s[94:95]
    v_mfma_f32_16x16x32_bf16 v[80:83], v[236:239], a[80:83], v[80:83]
    s_nop 0
    s_cbranch_vccnz L_sp_fl1
L_ok_fl1:
    v_mfma_f32_16x16x32_bf16 v[84:87], v[236:239], a[84:87], v[84:87]
    s_cmp_lt_u32 s82, 5
    s_cselect_b64 vcc, -1, 0
    v_mfma_f32_16x16x32_bf16 v[88:91], v[236:239], a[88:91], v[88:91]
    s_cbranch_vccz L_t5_g
    v_readlane_b32 s84, v28, 7
    s_mov_b32 s62, 12513280
    s_nop 3
    buffer_load_dwordx4 v[228:231], v32, s[60:63], s84 offen sc1
L_t5_g:
    s_nop 0
    v_readlane_b32 s80, v28, 7
    v_mfma_f32_16x16x32_bf16 v[92:95], v[236:239], a[92:95], v[92:95]
    v_mfma_f32_16x16x32_bf16 v[96:99], v[240:243], a[80:83], v[96:99]
    s_mov_b32 s50, 12513280
    s_add_u32 s83, s80, 5120
    v_mfma_f32_16x16x32_bf16 v[100:103], v[240:243], a[84:87], v[100:103]
    buffer_load_dwordx4 v[208:211], v30, s[48:51], s80 offen offset:0 sc1
    v_mfma_f32_16x16x32_bf16 v[104:107], v[240:243], a[88:91], v[104:107]
    v_mfma_f32_16x16x32_bf16 v[108:111], v[240:243], a[92:95], v[108:111]
    buffer_load_dwordx4 v[212:215], v30, s[48:51], s80 offen offset:1024 sc1
    v_mfma_f32_16x16x32_bf16 v[112:115], v[244:247], a[80:83], v[112:115]
    v_mfma_f32_16x16x32_bf16 v[116:119], v[244:247], a[84:87], v[116:119]
    buffer_load_dwordx4 v[216:219], v30, s[48:51], s80 offen offset:2048 sc1
    v_mfma_f32_16x16x32_bf16 v[120:123], v[244:247], a[88:91], v[120:123]
    v_mfma_f32_16x16x32_bf16 v[124:127], v[244:247], a[92:95], v[124:127]
    buffer_load_dwordx4 v[220:223], v30, s[48:51], s80 offen offset:3072 sc1
    v_mfma_f32_16x16x32_bf16 v[128:131], v[248:251], a[80:83], v[128:131]
    v_mfma_f32_16x16x32_bf16 v[132:135], v[248:251], a[84:87], v[132:135]
    buffer_load_dwordx4 v[224:227], v31, s[48:51], s80 offen offset:0 sc1
    v_mfma_f32_16x16x32_bf16 v[136:139], v[248:251], a[88:91], v[136:139]
    v_mfma_f32_16x16x32_bf16 v[140:143], v[248:251], a[92:95], v[140:143]
    s_cbranch_vccz L_t5_11
    v_mfma_f32_16x16x32_bf16 v[144:147], v[252:255], a[80:83], v[144:147]
    s_add_u32 s84, s84, 5120
    v_mfma_f32_16x16x32_bf16 v[148:151], v[252:255], a[84:87], v[148:151]
    v_mfma_f32_16x16x32_bf16 v[152:155], v[252:255], a[88:91], v[152:155]
    v_mfma_f32_16x16x32_bf16 v[156:159], v[252:255], a[92:95], v[156:159]
    buffer_load_dwordx4 v[252:255], v32, s[60:63], s84 offen sc1
L_t5_11:
    v_mfma_f32_16x16x32_bf16 v[64:67], v[160:163], a[96:99], v[64:67]
    buffer_load_dwordx4 v[232:235], v30, s[48:51], s83 offen offset:0 sc1
    v_mfma_f32_16x16x32_bf16 v[68:71], v[160:163], a[100:103], v[68:71]
    v_mfma_f32_16x16x32_bf16 v[72:75], v[160:163], a[104:107], v[72:75]
    v_mfma_f32_16x16x32_bf16 v[76:79], v[160:163], a[108:111], v[76:79]
    buffer_load_dwordx4 v[236:239], v30, s[48:51], s83 offen offset:1024 sc1
    v_mfma_f32_16x16x32_bf16 v[80:83], v[164:167], a[96:99], v[80:83]
    v_mfma_f32_16x16x32_bf16 v[84:87], v[164:167], a[100:103], v[84:87]
    v_mfma_f32_16x16x32_bf16 v[88:91], v[164:167], a[104:107], v[88:91]
    v_mfma_f32_16x16x32_bf16 v[92:95], v[164:167], a[108:111], v[92:95]
    buffer_load_dwordx4 v[240:243], v30, s[48:51], s83 offen offset:2048 sc1
    v_mfma_f32_16x16x32_bf16 v[96:99], v[168:171], a[96:99], v[96:99]
    v_mfma_f32_16x16x32_bf16 v[100:103], v[168:171], a[100:103], v[100:103]
    v_mfma_f32_16x16x32_bf16 v[104:107], v[168:171], a[104:107], v[104:107]
    v_mfma_f32_16x16x32_bf16 v[108:111], v[168:171], a[108:111], v[108:111]
    buffer_load_dwordx4 v[244:247], v30, s[48:51], s83 offen offset:3072 sc1
    v_mfma_f32_16x16x32_bf16 v[112:115], v[172:175], a[96:99], v[112:115]
    v_mfma_f32_16x16x32_bf16 v[116:119], v[172:175], a[100:103], v[116:119]
    v_mfma_f32_16x16x32_bf16 v[120:123], v[172:175], a[104:107], v[120:123]
    v_mfma_f32_16x16x32_bf16 v[124:127], v[172:175], a[108:111], v[124:127]
    buffer_load_dwordx4 v[248:251], v31, s[48:51], s83 offen offset:0 sc1
    v_mfma_f32_16x16x32_bf16 v[128:131], v[176:179], a[96:99], v[128:131]
    v_mfma_f32_16x16x32_bf16 v[132:135], v[176:179], a[100:103], v[132:135]
    v_mfma_f32_16x16x32_bf16 v[136:139], v[176:179], a[104:107], v[136:139]
    v_mfma_f32_16x16x32_bf16 v[140:143], v[176:179], a[108:111], v[140:143]
    s_cbranch_vccz L_t5_12
    v_mfma_f32_16x16x32_bf16 v[144:147], v[180:183], a[96:99], v[144:147]
    v_readlane_b32 s84, v28, 8
    v_mfma_f32_16x16x32_bf16 v[148:151], v[180:183], a[100:103], v[148:151]
    v_mfma_f32_16x16x32_bf16 v[152:155], v[180:183], a[104:107], v[152:155]
    v_mfma_f32_16x16x32_bf16 v[156:159], v[180:183], a[108:111], v[156:159]
    s_nop 1
    buffer_load_dwordx4 v[180:183], v32, s[60:63], s84 offen sc1
L_t5_12:
    s_waitcnt vmcnt(10)
    v_mfma_f32_16x16x32_bf16 v[64:67], v[184:187], a[112:115], v[64:67]
    v_readlane_b32 s80, v28, 8
    v_mfma_f32_16x16x32_bf16 v[68:71], v[184:187], a[116:119], v[68:71]
    v_mfma_f32_16x16x32_bf16 v[72:75], v[184:187], a[120:123], v[72:75]
    s_add_u32 s89, s85, 131072
    v_add_u32_e64 v1, s89, v27
    v_mfma_f32_16x16x32_bf16 v[76:79], v[184:187], a[124:127], v[76:79]
    s_add_u32 s83, s80, 5120
    v_mfma_f32_16x16x32_bf16 v[80:83], v[188:191], a[112:115], v[80:83]
    buffer_load_dwordx4 v[160:163], v30, s[48:51], s80 offen offset:0 sc1
    v_mfma_f32_16x16x32_bf16 v[84:87], v[188:191], a[116:119], v[84:87]
    v_xor_b32_e64 v2, 64, v1
    v_mfma_f32_16x16x32_bf16 v[88:91], v[188:191], a[120:123], v[88:91]
    ds_read_b128 a[224:227], v1 offset:0
    v_mfma_f32_16x16x32_bf16 v[92:95], v[188:191], a[124:127], v[92:95]
    buffer_load_dwordx4 v[164:167], v30, s[48:51], s80 offen offset:1024 sc1
    v_mfma_f32_16x16x32_bf16 v[96:99], v[192:195], a[112:115], v[96:99]
    ds_read_b128 a[228:231], v1 offset:2048
    v_mfma_f32_16x16x32_bf16 v[100:103], v[192:195], a[116:119], v[100:103]
    buffer_load_dwordx4 v[168:171], v30, s[48:51], s80 offen offset:2048 sc1
    v_mfma_f32_16x16x32_bf16 v[104:107], v[192:195], a[120:123], v[104:107]
    ds_read_b128 a[232:235], v1 offset:4096
    v_mfma_f32_16x16x32_bf16 v[108:111], v[192:195], a[124:127], v[108:111]
    v_mfma_f32_16x16x32_bf16 v[112:115], v[196:199], a[112:115], v[112:115]
    ds_read_b128 a[236:239], v1 offset:6144
    v_mfma_f32_16x16x32_bf16 v[116:119], v[196:199], a[116:119], v[116:119]
    buffer_load_dwordx4 v[172:175], v30, s[48:51], s80 offen offset:3072 sc1
    v_mfma_f32_16x16x32_bf16 v[120:123], v[196:199], a[120:123], v[120:123]
    v_mfma_f32_16x16x32_bf16 v[124:127], v[196:199], a[124:127], v[124:127]
    buffer_load_dwordx4 v[176:179], v31, s[48:51], s80 offen offset:0 sc1
    v_mfma_f32_16x16x32_bf16 v[128:131], v[200:203], a[112:115], v[128:131]
    v_mfma_f32_16x16x32_bf16 v[132:135], v[200:203], a[116:119], v[132:135]
    v_mfma_f32_16x16x32_bf16 v[136:139], v[200:203], a[120:123], v[136:139]
    v_mfma_f32_16x16x32_bf16 v[140:143], v[200:203], a[124:127], v[140:143]
    s_cbranch_vccz L_t5_13
    v_mfma_f32_16x16x32_bf16 v[144:147], v[204:207], a[112:115], v[144:147]
    s_add_u32 s84, s84, 5120
    v_mfma_f32_16x16x32_bf16 v[148:151], v[204:207], a[116:119], v[148:151]
    v_mfma_f32_16x16x32_bf16 v[152:155], v[204:207], a[120:123], v[152:155]
    v_mfma_f32_16x16x32_bf16 v[156:159], v[204:207], a[124:127], v[156:159]
    buffer_load_dwordx4 v[204:207], v32, s[60:63], s84 offen sc1
L_t5_13:
    s_waitcnt vmcnt(10) lgkmcnt(0)
    v_mfma_f32_16x16x32_bf16 v[64:67], v[208:211], a[224:227], v[64:67]
    buffer_load_dwordx4 v[184:187], v30, s[48:51], s83 offen offset:0 sc1
    v_mfma_f32_16x16x32_bf16 v[68:71], v[208:211], a[228:231], v[68:71]
    v_mfma_f32_16x16x32_bf16 v[72:75], v[208:211], a[232:235], v[72:75]
    ds_read_b128 a[240:243], v2 offset:0
    v_mfma_f32_16x16x32_bf16 v[76:79], v[208:211], a[236:239], v[76:79]
    buffer_load_dwordx4 v[188:191], v30, s[48:51], s83 offen offset:1024 sc1
    v_mfma_f32_16x16x32_bf16 v[80:83], v[212:215], a[224:227], v[80:83]
    v_mfma_f32_16x16x32_bf16 v[84:87], v[212:215], a[228:231], v[84:87]
    ds_read_b128 a[244:247], v2 offset:2048
    v_mfma_f32_16x16x32_bf16 v[88:91], v[212:215], a[232:235], v[88:91]
    v_mfma_f32_16x16x32_bf16 v[92:95], v[212:215], a[236:239], v[92:95]
    buffer_load_dwordx4 v[192:195], v30, s[48:51], s83 offen offset:2048 sc1
    v_mfma_f32_16x16x32_bf16 v[96:99], v[216:219], a[224:227], v[96:99]
    ds_read_b128 a[248:251], v2 offset:4096
    v_mfma_f32_16x16x32_bf16 v[100:103], v[216:219], a[228:231], v[100:103]
    v_mfma_f32_16x16x32_bf16 v[104:107], v[216:219], a[232:235], v[104:107]
    v_mfma_f32_16x16x32_bf16 v[108:111], v[216:219], a[236:239], v[108:111]
    ds_read_b128 a[252:255], v2 offset:6144
    v_mfma_f32_16x16x32_bf16 v[112:115], v[220:223], a[224:227], v[112:115]
    buffer_load_dwordx4 v[196:199], v30, s[48:51], s83 offen offset:3072 sc1
    v_mfma_f32_16x16x32_bf16 v[116:119], v[220:223], a[228:231], v[116:119]
    v_mfma_f32_16x16x32_bf16 v[120:123], v[220:223], a[232:235], v[120:123]
    v_mfma_f32_16x16x32_bf16 v[124:127], v[220:223], a[236:239], v[124:127]
    buffer_load_dwordx4 v[200:203], v31, s[48:51], s83 offen offset:0 sc1
    v_mfma_f32_16x16x32_bf16 v[128:131], v[224:227], a[224:227], v[128:131]
    v_mfma_f32_16x16x32_bf16 v[132:135], v[224:227], a[228:231], v[132:135]
    v_mfma_f32_16x16x32_bf16 v[136:139], v[224:227], a[232:235], v[136:139]
    v_mfma_f32_16x16x32_bf16 v[140:143], v[224:227], a[236:239], v[140:143]
    s_cbranch_vccz L_t5_14
    v_mfma_f32_16x16x32_bf16 v[144:147], v[228:231], a[224:227], v[144:147]
    v_readlane_b32 s84, v28, 9
    v_mfma_f32_16x16x32_bf16 v[148:151], v[228:231], a[228:231], v[148:151]
    v_mfma_f32_16x16x32_bf16 v[152:155], v[228:231], a[232:235], v[152:155]
    v_mfma_f32_16x16x32_bf16 v[156:159], v[228:231], a[236:239], v[156:159]
    s_nop 1
    buffer_load_dwordx4 v[228:231], v32, s[60:63], s84 offen sc1
L_t5_14:
    s_waitcnt vmcnt(10) lgkmcnt(0)
    v_mfma_f32_16x16x32_bf16 v[64:67], v[232:235], a[240:243], v[64:67]
    v_readlane_b32 s80, v28, 9
    v_mfma_f32_16x16x32_bf16 v[68:71], v[232:235], a[244:247], v[68:71]
    v_mfma_f32_16x16x32_bf16 v[72:75], v[232:235], a[248:251], v[72:75]
    s_add_u32 s89, s85, 32768
    v_add_u32 v1, s89, v27
    v_mfma_f32_16x16x32_bf16 v[76:79], v[232:235], a[252:255], v[76:79]
    s_add_u32 s83, s80, 5120
    v_mfma_f32_16x16x32_bf16 v[80:83], v[236:239], a[240:243], v[80:83]
    buffer_load_dwordx4 v[208:211], v30, s[48:51], s80 offen offset:0 sc1
    v_mfma_f32_16x16x32_bf16 v[84:87], v[236:239], a[244:247], v[84:87]
    v_xor_b32_e64 v2, 64, v1
    v_mfma_f32_16x16x32_bf16 v[88:91], v[236:239], a[248:251], v[88:91]
    ds_read_b128 a[224:227], v1 offset:0
    v_mfma_f32_16x16x32_bf16 v[92:95], v[236:239], a[252:255], v[92:95]
    buffer_load_dwordx4 v[212:215], v30, s[48:51], s80 offen offset:1024 sc1
    v_mfma_f32_16x16x32_bf16 v[96:99], v[240:243], a[240:243], v[96:99]
    ds_read_b128 a[228:231], v1 offset:2048
    v_mfma_f32_16x16x32_bf16 v[100:103], v[240:243], a[244:247], v[100:103]
    buffer_load_dwordx4 v[216:219], v30, s[48:51], s80 offen offset:2048 sc1
    v_mfma_f32_16x16x32_bf16 v[104:107], v[240:243], a[248:251], v[104:107]
    ds_read_b128 a[232:235], v1 offset:4096
    v_mfma_f32_16x16x32_bf16 v[108:111], v[240:243], a[252:255], v[108:111]
    v_mfma_f32_16x16x32_bf16 v[112:115], v[244:247], a[240:243], v[112:115]
    ds_read_b128 a[236:239], v1 offset:6144
    v_mfma_f32_16x16x32_bf16 v[116:119], v[244:247], a[244:247], v[116:119]
    buffer_load_dwordx4 v[220:223], v30, s[48:51], s80 offen offset:3072 sc1
    v_mfma_f32_16x16x32_bf16 v[120:123], v[244:247], a[248:251], v[120:123]
    v_mfma_f32_16x16x32_bf16 v[124:127], v[244:247], a[252:255], v[124:127]
    buffer_load_dwordx4 v[224:227], v31, s[48:51], s80 offen offset:0 sc1
    v_mfma_f32_16x16x32_bf16 v[128:131], v[248:251], a[240:243], v[128:131]
    v_mfma_f32_16x16x32_bf16 v[132:135], v[248:251], a[244:247], v[132:135]
    v_mfma_f32_16x16x32_bf16 v[136:139], v[248:251], a[248:251], v[136:139]
    v_mfma_f32_16x16x32_bf16 v[140:143], v[248:251], a[252:255], v[140:143]
    s_cbranch_vccz L_t5_15
    v_mfma_f32_16x16x32_bf16 v[144:147], v[252:255], a[240:243], v[144:147]
    s_add_u32 s84, s84, 5120
    v_mfma_f32_16x16x32_bf16 v[148:151], v[252:255], a[244:247], v[148:151]
    v_mfma_f32_16x16x32_bf16 v[152:155], v[252:255], a[248:251], v[152:155]
    v_mfma_f32_16x16x32_bf16 v[156:159], v[252:255], a[252:255], v[156:159]
    buffer_load_dwordx4 v[252:255], v32, s[60:63], s84 offen sc1
L_t5_15:
    s_waitcnt vmcnt(10) lgkmcnt(0)
    v_mfma_f32_16x16x32_bf16 v[64:67], v[160:163], a[224:227], v[64:67]
    buffer_load_dwordx4 v[232:235], v30, s[48:51], s83 offen offset:0 sc1
    v_mfma_f32_16x16x32_bf16 v[68:71], v[160:163], a[228:231], v[68:71]
    v_mfma_f32_16x16x32_bf16 v[72:75], v[160:163], a[232:235], v[72:75]
    ds_read_b128 a[240:243], v2 offset:0
    v_mfma_f32_16x16x32_bf16 v[76:79], v[160:163], a[236:239], v[76:79]
    buffer_load_dwordx4 v[236:239], v30, s[48:51], s83 offen offset:1024 sc1
    v_mfma_f32_16x16x32_bf16 v[80:83], v[164:167], a[224:227], v[80:83]
    v_mfma_f32_16x16x32_bf16 v[84:87], v[164:167], a[228:231], v[84:87]
    ds_read_b128 a[244:247], v2 offset:2048
    v_mfma_f32_16x16x32_bf16 v[88:91], v[164:167], a[232:235], v[88:91]
    v_mfma_f32_16x16x32_bf16 v[92:95], v[164:167], a[236:239], v[92:95]
    buffer_load_dwordx4 v[240:243], v30, s[48:51], s83 offen offset:2048 sc1
    v_mfma_f32_16x16x32_bf16 v[96:99], v[168:171], a[224:227], v[96:99]
    ds_read_b128 a[248:251], v2 offset:4096
    v_mfma_f32_16x16x32_bf16 v[100:103], v[168:171], a[228:231], v[100:103]
    v_mfma_f32_16x16x32_bf16 v[104:107], v[168:171], a[232:235], v[104:107]
    v_mfma_f32_16x16x32_bf16 v[108:111], v[168:171], a[236:239], v[108:111]
    ds_read_b128 a[252:255], v2 offset:6144
    v_mfma_f32_16x16x32_bf16 v[112:115], v[172:175], a[224:227], v[112:115]
    buffer_load_dwordx4 v[244:247], v30, s[48:51], s83 offen offset:3072 sc1
    v_mfma_f32_16x16x32_bf16 v[116:119], v[172:175], a[228:231], v[116:119]
    v_mfma_f32_16x16x32_bf16 v[120:123], v[172:175], a[232:235], v[120:123]
    v_mfma_f32_16x16x32_bf16 v[124:127], v[172:175], a[236:239], v[124:127]
    buffer_load_dwordx4 v[248:251], v31, s[48:51], s83 offen offset:0 sc1
    v_mfma_f32_16x16x32_bf16 v[128:131], v[176:179], a[224:227], v[128:131]
    v_mfma_f32_16x16x32_bf16 v[132:135], v[176:179], a[228:231], v[132:135]
    v_mfma_f32_16x16x32_bf16 v[136:139], v[176:179], a[232:235], v[136:139]
    v_mfma_f32_16x16x32_bf16 v[140:143], v[176:179], a[236:239], v[140:143]
    s_cbranch_vccz L_t5_16
    v_mfma_f32_16x16x32_bf16 v[144:147], v[180:183], a[224:227], v[144:147]
    v_readlane_b32 s84, v28, 10
    v_mfma_f32_16x16x32_bf16 v[148:151], v[180:183], a[228:231], v[148:151]
    v_mfma_f32_16x16x32_bf16 v[152:155], v[180:183], a[232:235], v[152:155]
    v_mfma_f32_16x16x32_bf16 v[156:159], v[180:183], a[236:239], v[156:159]
    s_nop 1
    buffer_load_dwordx4 v[180:183], v32, s[60:63], s84 offen sc1
L_t5_16:
    s_waitcnt vmcnt(10) lgkmcnt(0)
    v_mfma_f32_16x16x32_bf16 v[64:67], v[184:187], a[240:243], v[64:67]
    v_readlane_b32 s80, v28, 10
    v_mfma_f32_16x16x32_bf16 v[68:71], v[184:187], a[244:247], v[68:71]
    v_mfma_f32_16x16x32_bf16 v[72:75], v[184:187], a[248:251], v[72:75]
    s_add_u32 s89, s85, 0
    v_add_u32_e64 v1, s89, v27
    v_mfma_f32_16x16x32_bf16 v[76:79], v[184:187], a[252:255], v[76:79]
    s_add_u32 s83, s80, 5120
    v_mfma_f32_16x16x32_bf16 v[80:83], v[188:191], a[240:243], v[80:83]
    buffer_load_dwordx4 v[160:163], v30, s[48:51], s80 offen offset:0 sc1
    v_mfma_f32_16x16x32_bf16 v[84:87], v[188:191], a[244:247], v[84:87]
    v_xor_b32_e64 v2, 64, v1
    v_mfma_f32_16x16x32_bf16 v[88:91], v[188:191], a[248:251], v[88:91]
    ds_read_b128 a[224:227], v1 offset:0
    v_mfma_f32_16x16x32_bf16 v[92:95], v[188:191], a[252:255], v[92:95]
    buffer_load_dwordx4 v[164:167], v30, s[48:51], s80 offen offset:1024 sc1
    v_mfma_f32_16x16x32_bf16 v[96:99], v[192:195], a[240:243], v[96:99]
    ds_read_b128 a[228:231], v1 offset:2048
    v_mfma_f32_16x16x32_bf16 v[100:103], v[192:195], a[244:247], v[100:103]
    buffer_load_dwordx4 v[168:171], v30, s[48:51], s80 offen offset:2048 sc1
    v_mfma_f32_16x16x32_bf16 v[104:107], v[192:195], a[248:251], v[104:107]
    ds_read_b128 a[232:235], v1 offset:4096
    v_mfma_f32_16x16x32_bf16 v[108:111], v[192:195], a[252:255], v[108:111]
    v_mfma_f32_16x16x32_bf16 v[112:115], v[196:199], a[240:243], v[112:115]
    ds_read_b128 a[236:239], v1 offset:6144
    v_mfma_f32_16x16x32_bf16 v[116:119], v[196:199], a[244:247], v[116:119]
    buffer_load_dwordx4 v[172:175], v30, s[48:51], s80 offen offset:3072 sc1
    v_mfma_f32_16x16x32_bf16 v[120:123], v[196:199], a[248:251], v[120:123]
    v_mfma_f32_16x16x32_bf16 v[124:127], v[196:199], a[252:255], v[124:127]
    buffer_load_dwordx4 v[176:179], v31, s[48:51], s80 offen offset:0 sc1
    v_mfma_f32_16x16x32_bf16 v[128:131], v[200:203], a[240:243], v[128:131]
    v_mfma_f32_16x16x32_bf16 v[132:135], v[200:203], a[244:247], v[132:135]
    v_mfma_f32_16x16x32_bf16 v[136:139], v[200:203], a[248:251], v[136:139]
    v_mfma_f32_16x16x32_bf16 v[140:143], v[200:203], a[252:255], v[140:143]
    s_cbranch_vccz L_t5_17
    v_mfma_f32_16x16x32_bf16 v[144:147], v[204:207], a[240:243], v[144:147]
    s_add_u32 s84, s84, 5120
    v_mfma_f32_16x16x32_bf16 v[148:151], v[204:207], a[244:247], v[148:151]
    v_mfma_f32_16x16x32_bf16 v[152:155], v[204:207], a[248:251], v[152:155]
    v_mfma_f32_16x16x32_bf16 v[156:159], v[204:207], a[252:255], v[156:159]
    buffer_load_dwordx4 v[204:207], v32, s[60:63], s84 offen sc1
L_t5_17:
    s_waitcnt vmcnt(10) lgkmcnt(0)
    v_mfma_f32_16x16x32_bf16 v[64:67], v[208:211], a[224:227], v[64:67]
    buffer_load_dwordx4 v[184:187], v30, s[48:51], s83 offen offset:0 sc1
    v_mfma_f32_16x16x32_bf16 v[68:71], v[208:211], a[228:231], v[68:71]
    v_mfma_f32_16x16x32_bf16 v[72:75], v[208:211], a[232:235], v[72:75]
    ds_read_b128 a[240:243], v2 offset:0
    v_mfma_f32_16x16x32_bf16 v[76:79], v[208:211], a[236:239], v[76:79]
    buffer_load_dwordx4 v[188:191], v30, s[48:51], s83 offen offset:1024 sc1
    v_mfma_f32_16x16x32_bf16 v[80:83], v[212:215], a[224:227], v[80:83]
    v_mfma_f32_16x16x32_bf16 v[84:87], v[212:215], a[228:231], v[84:87]
    ds_read_b128 a[244:247], v2 offset:2048
    v_mfma_f32_16x16x32_bf16 v[88:91], v[212:215], a[232:235], v[88:91]
    v_mfma_f32_16x16x32_bf16 v[92:95], v[212:215], a[236:239], v[92:95]
    buffer_load_dwordx4 v[192:195], v30, s[48:51], s83 offen offset:2048 sc1
    v_mfma_f32_16x16x32_bf16 v[96:99], v[216:219], a[224:227], v[96:99]
    ds_read_b128 a[248:251], v2 offset:4096
    v_mfma_f32_16x16x32_bf16 v[100:103], v[216:219], a[228:231], v[100:103]
    v_mfma_f32_16x16x32_bf16 v[104:107], v[216:219], a[232:235], v[104:107]
    v_mfma_f32_16x16x32_bf16 v[108:111], v[216:219], a[236:239], v[108:111]
    ds_read_b128 a[252:255], v2 offset:6144
    v_mfma_f32_16x16x32_bf16 v[112:115], v[220:223], a[224:227], v[112:115]
    buffer_load_dwordx4 v[196:199], v30, s[48:51], s83 offen offset:3072 sc1
    v_mfma_f32_16x16x32_bf16 v[116:119], v[220:223], a[228:231], v[116:119]
    v_mfma_f32_16x16x32_bf16 v[120:123], v[220:223], a[232:235], v[120:123]
    v_mfma_f32_16x16x32_bf16 v[124:127], v[220:223], a[236:239], v[124:127]
    buffer_load_dwordx4 v[200:203], v31, s[48:51], s83 offen offset:0 sc1
    v_mfma_f32_16x16x32_bf16 v[128:131], v[224:227], a[224:227], v[128:131]
    v_mfma_f32_16x16x32_bf16 v[132:135], v[224:227], a[228:231], v[132:135]
    v_mfma_f32_16x16x32_bf16 v[136:139], v[224:227], a[232:235], v[136:139]
    v_mfma_f32_16x16x32_bf16 v[140:143], v[224:227], a[236:239], v[140:143]
    s_cbranch_vccz L_t5_18
    v_mfma_f32_16x16x32_bf16 v[144:147], v[228:231], a[224:227], v[144:147]
    v_readlane_b32 s84, v28, 11
    v_mfma_f32_16x16x32_bf16 v[148:151], v[228:231], a[228:231], v[148:151]
    v_mfma_f32_16x16x32_bf16 v[152:155], v[228:231], a[232:235], v[152:155]
    v_mfma_f32_16x16x32_bf16 v[156:159], v[228:231], a[236:239], v[156:159]
    s_nop 1
    buffer_load_dwordx4 v[228:231], v32, s[60:63], s84 offen sc1
L_t5_18:
    s_waitcnt vmcnt(10) lgkmcnt(0)
    v_mfma_f32_16x16x32_bf16 v[64:67], v[232:235], a[240:243], v[64:67]
    v_readlane_b32 s80, v28, 11
    v_mfma_f32_16x16x32_bf16 v[68:71], v[232:235], a[244:247], v[68:71]
    v_mfma_f32_16x16x32_bf16 v[72:75], v[232:235], a[248:251], v[72:75]
    s_add_u32 s89, s85, 65536
    v_add_u32 v1, s89, v27
    v_mfma_f32_16x16x32_bf16 v[76:79], v[232:235], a[252:255], v[76:79]
    s_add_u32 s83, s80, 5120
    v_mfma_f32_16x16x32_bf16 v[80:83], v[236:239], a[240:243], v[80:83]
    buffer_load_dwordx4 v[208:211], v30, s[48:51], s80 offen offset:0 sc1
    v_mfma_f32_16x16x32_bf16 v[84:87], v[236:239], a[244:247], v[84:87]
    v_xor_b32_e64 v2, 64, v1
    v_mfma_f32_16x16x32_bf16 v[88:91], v[236:239], a[248:251], v[88:91]
    ds_read_b128 a[224:227], v1 offset:0
    v_mfma_f32_16x16x32_bf16 v[92:95], v[236:239], a[252:255], v[92:95]
    buffer_load_dwordx4 v[212:215], v30, s[48:51], s80 offen offset:1024 sc1
    v_mfma_f32_16x16x32_bf16 v[96:99], v[240:243], a[240:243], v[96:99]
    ds_read_b128 a[228:231], v1 offset:2048
    v_mfma_f32_16x16x32_bf16 v[100:103], v[240:243], a[244:247], v[100:103]
    buffer_load_dwordx4 v[216:219], v30, s[48:51], s80 offen offset:2048 sc1
    v_mfma_f32_16x16x32_bf16 v[104:107], v[240:243], a[248:251], v[104:107]
    ds_read_b128 a[232:235], v1 offset:4096
    v_mfma_f32_16x16x32_bf16 v[108:111], v[240:243], a[252:255], v[108:111]
    v_mfma_f32_16x16x32_bf16 v[112:115], v[244:247], a[240:243], v[112:115]
    ds_read_b128 a[236:239], v1 offset:6144
    v_mfma_f32_16x16x32_bf16 v[116:119], v[244:247], a[244:247], v[116:119]
    buffer_load_dwordx4 v[220:223], v30, s[48:51], s80 offen offset:3072 sc1
    v_mfma_f32_16x16x32_bf16 v[120:123], v[244:247], a[248:251], v[120:123]
    v_mfma_f32_16x16x32_bf16 v[124:127], v[244:247], a[252:255], v[124:127]
    buffer_load_dwordx4 v[224:227], v31, s[48:51], s80 offen offset:0 sc1
    v_mfma_f32_16x16x32_bf16 v[128:131], v[248:251], a[240:243], v[128:131]
    v_mfma_f32_16x16x32_bf16 v[132:135], v[248:251], a[244:247], v[132:135]
    v_mfma_f32_16x16x32_bf16 v[136:139], v[248:251], a[248:251], v[136:139]
    v_mfma_f32_16x16x32_bf16 v[140:143], v[248:251], a[252:255], v[140:143]
    s_cbranch_vccz L_t5_19
    v_mfma_f32_16x16x32_bf16 v[144:147], v[252:255], a[240:243], v[144:147]
    s_add_u32 s84, s84, 5120
    v_mfma_f32_16x16x32_bf16 v[148:151], v[252:255], a[244:247], v[148:151]
    v_mfma_f32_16x16x32_bf16 v[152:155], v[252:255], a[248:251], v[152:155]
    v_mfma_f32_16x16x32_bf16 v[156:159], v[252:255], a[252:255], v[156:159]
    buffer_load_dwordx4 v[252:255], v32, s[60:63], s84 offen sc1
L_t5_19:
    s_waitcnt vmcnt(10) lgkmcnt(0)
L_pad15:
    s_cbranch_execz L_hopend
    s_nop 0
    v_mfma_f32_16x16x32_bf16 v[64:67], v[160:163], a[224:227], v[64:67]
    buffer_load_dwordx4 v[232:235], v30, s[48:51], s83 offen offset:0 sc1
    v_mfma_f32_16x16x32_bf16 v[68:71], v[160:163], a[228:231], v[68:71]
    v_mfma_f32_16x16x32_bf16 v[72:75], v[160:163], a[232:235], v[72:75]
    ds_read_b128 a[240:243], v2 offset:0
    v_mfma_f32_16x16x32_bf16 v[76:79], v[160:163], a[236:239], v[76:79]
    buffer_load_dwordx4 v[236:239], v30, s[48:51], s83 offen offset:1024 sc1
    v_mfma_f32_16x16x32_bf16 v[80:83], v[164:167], a[224:227], v[80:83]
    v_mfma_f32_16x16x32_bf16 v[84:87], v[164:167], a[228:231], v[84:87]
    ds_read_b128 a[244:247], v2 offset:2048
    v_mfma_f32_16x16x32_bf16 v[88:91], v[164:167], a[232:235], v[88:91]
    v_mfma_f32_16x16x32_bf16 v[92:95], v[164:167], a[236:239], v[92:95]
    buffer_load_dwordx4 v[240:243], v30, s[48:51], s83 offen offset:2048 sc1
    v_mfma_f32_16x16x32_bf16 v[96:99], v[168:171], a[224:227], v[96:99]
    ds_read_b128 a[248:251], v2 offset:4096
    v_mfma_f32_16x16x32_bf16 v[100:103], v[168:171], a[228:231], v[100:103]
    v_mfma_f32_16x16x32_bf16 v[104:107], v[168:171], a[232:235], v[104:107]
    v_mfma_f32_16x16x32_bf16 v[108:111], v[168:171], a[236:239], v[108:111]
    ds_read_b128 a[252:255], v2 offset:6144
    v_mfma_f32_16x16x32_bf16 v[112:115], v[172:175], a[224:227], v[112:115]
    buffer_load_dwordx4 v[244:247], v30, s[48:51], s83 offen offset:3072 sc1
    v_mfma_f32_16x16x32_bf16 v[116:119], v[172:175], a[228:231], v[116:119]
    v_mfma_f32_16x16x32_bf16 v[120:123], v[172:175], a[232:235], v[120:123]
    v_mfma_f32_16x16x32_bf16 v[124:127], v[172:175], a[236:239], v[124:127]
    buffer_load_dwordx4 v[248:251], v31, s[48:51], s83 offen offset:0 sc1
    v_mfma_f32_16x16x32_bf16 v[128:131], v[176:179], a[224:227], v[128:131]
    v_mfma_f32_16x16x32_bf16 v[132:135], v[176:179], a[228:231], v[132:135]
    v_mfma_f32_16x16x32_bf16 v[136:139], v[176:179], a[232:235], v[136:139]
    v_mfma_f32_16x16x32_bf16 v[140:143], v[176:179], a[236:239], v[140:143]
    s_cbranch_vccz L_t5_20
    v_mfma_f32_16x16x32_bf16 v[144:147], v[180:183], a[224:227], v[144:147]
    v_mfma_f32_16x16x32_bf16 v[148:151], v[180:183], a[228:231], v[148:151]
    v_mfma_f32_16x16x32_bf16 v[152:155], v[180:183], a[232:235], v[152:155]
    v_mfma_f32_16x16x32_bf16 v[156:159], v[180:183], a[236:239], v[156:159]
L_t5_20:
    s_waitcnt vmcnt(10) lgkmcnt(0)
    v_mfma_f32_16x16x32_bf16 v[64:67], v[184:187], a[240:243], v[64:67]
    v_mfma_f32_16x16x32_bf16 v[68:71], v[184:187], a[244:247], v[68:71]
    v_mfma_f32_16x16x32_bf16 v[72:75], v[184:187], a[248:251], v[72:75]
    s_add_u32 s89, s85, 98304
    v_add_u32_e64 v1, s89, v27
    v_mfma_f32_16x16x32_bf16 v[76:79], v[184:187], a[252:255], v[76:79]
    v_mfma_f32_16x16x32_bf16 v[80:83], v[188:191], a[240:243], v[80:83]
    v_xor_b32_e64 v2, 64, v1
    v_mfma_f32_16x16x32_bf16 v[84:87], v[188:191], a[244:247], v[84:87]
    v_mfma_f32_16x16x32_bf16 v[88:91], v[188:191], a[248:251], v[88:91]
    ds_read_b128 a[224:227], v1 offset:0
    v_mfma_f32_16x16x32_bf16 v[92:95], v[188:191], a[252:255], v[92:95]
    v_mfma_f32_16x16x32_bf16 v[96:99], v[192:195], a[240:243], v[96:99]
    ds_read_b128 a[228:231], v1 offset:2048
    v_mfma_f32_16x16x32_bf16 v[100:103], v[192:195], a[244:247], v[100:103]
    v_mfma_f32_16x16x32_bf16 v[104:107], v[192:195], a[248:251], v[104:107]
    ds_read_b128 a[232:235], v1 offset:4096
    v_mfma_f32_16x16x32_bf16 v[108:111], v[192:195], a[252:255], v[108:111]
    v_mfma_f32_16x16x32_bf16 v[112:115], v[196:199], a[240:243], v[112:115]
    ds_read_b128 a[236:239], v1 offset:6144
    v_mfma_f32_16x16x32_bf16 v[116:119], v[196:199], a[244:247], v[116:119]
    v_mfma_f32_16x16x32_bf16 v[120:123], v[196:199], a[248:251], v[120:123]
    v_mfma_f32_16x16x32_bf16 v[124:127], v[196:199], a[252:255], v[124:127]
    v_mfma_f32_16x16x32_bf16 v[128:131], v[200:203], a[240:243], v[128:131]
    v_mfma_f32_16x16x32_bf16 v[132:135], v[200:203], a[244:247], v[132:135]
    v_mfma_f32_16x16x32_bf16 v[136:139], v[200:203], a[248:251], v[136:139]
    v_mfma_f32_16x16x32_bf16 v[140:143], v[200:203], a[252:255], v[140:143]
    s_cbranch_vccz L_t5_21
    v_mfma_f32_16x16x32_bf16 v[144:147], v[204:207], a[240:243], v[144:147]
    v_mfma_f32_16x16x32_bf16 v[148:151], v[204:207], a[244:247], v[148:151]
    v_mfma_f32_16x16x32_bf16 v[152:155], v[204:207], a[248:251], v[152:155]
    v_mfma_f32_16x16x32_bf16 v[156:159], v[204:207], a[252:255], v[156:159]
L_t5_21:
    s_waitcnt vmcnt(5) lgkmcnt(0)
    v_mfma_f32_16x16x32_bf16 v[64:67], v[208:211], a[224:227], v[64:67]
    v_mfma_f32_16x16x32_bf16 v[68:71], v[208:211], a[228:231], v[68:71]
    v_mfma_f32_16x16x32_bf16 v[72:75], v[208:211], a[232:235], v[72:75]
    ds_read_b128 a[240:243], v2 offset:0
    v_mfma_f32_16x16x32_bf16 v[76:79], v[208:211], a[236:239], v[76:79]
    v_mfma_f32_16x16x32_bf16 v[80:83], v[212:215], a[224:227], v[80:83]
    v_mfma_f32_16x16x32_bf16 v[84:87], v[212:215], a[228:231], v[84:87]
    ds_read_b128 a[244:247], v2 offset:2048
    v_mfma_f32_16x16x32_bf16 v[88:91], v[212:215], a[232:235], v[88:91]
    v_mfma_f32_16x16x32_bf16 v[92:95], v[212:215], a[236:239], v[92:95]
    v_mfma_f32_16x16x32_bf16 v[96:99], v[216:219], a[224:227], v[96:99]
    ds_read_b128 a[248:251], v2 offset:4096
    v_mfma_f32_16x16x32_bf16 v[100:103], v[216:219], a[228:231], v[100:103]
    v_mfma_f32_16x16x32_bf16 v[104:107], v[216:219], a[232:235], v[104:107]
    v_mfma_f32_16x16x32_bf16 v[108:111], v[216:219], a[236:239], v[108:111]
    ds_read_b128 a[252:255], v2 offset:6144
    v_mfma_f32_16x16x32_bf16 v[112:115], v[220:223], a[224:227], v[112:115]
    v_mfma_f32_16x16x32_bf16 v[116:119], v[220:223], a[228:231], v[116:119]
    v_mfma_f32_16x16x32_bf16 v[120:123], v[220:223], a[232:235], v[120:123]
    v_mfma_f32_16x16x32_bf16 v[124:127], v[220:223], a[236:239], v[124:127]
    v_mfma_f32_16x16x32_bf16 v[128:131], v[224:227], a[224:227], v[128:131]
    v_mfma_f32_16x16x32_bf16 v[132:135], v[224:227], a[228:231], v[132:135]
    v_mfma_f32_16x16x32_bf16 v[136:139], v[224:227], a[232:235], v[136:139]
    v_mfma_f32_16x16x32_bf16 v[140:143], v[224:227], a[236:239], v[140:143]
    s_cbranch_vccz L_t5_22
    v_mfma_f32_16x16x32_bf16 v[144:147], v[228:231], a[224:227], v[144:147]
    v_mfma_f32_16x16x32_bf16 v[148:151], v[228:231], a[228:231], v[148:151]
    v_mfma_f32_16x16x32_bf16 v[152:155], v[228:231], a[232:235], v[152:155]
    v_mfma_f32_16x16x32_bf16 v[156:159], v[228:231], a[236:239], v[156:159]
L_t5_22:
    s_waitcnt vmcnt(0) lgkmcnt(0)
    s_cbranch_vccz L_t5_23
    v_mfma_f32_16x16x32_bf16 v[144:147], v[252:255], a[240:243], v[144:147]
    v_mfma_f32_16x16x32_bf16 v[148:151], v[252:255], a[244:247], v[148:151]
    v_mfma_f32_16x16x32_bf16 v[152:155], v[252:255], a[248:251], v[152:155]
    v_mfma_f32_16x16x32_bf16 v[156:159], v[252:255], a[252:255], v[156:159]
L_t5_23:
    v_mfma_f32_16x16x32_bf16 v[64:67], v[232:235], a[240:243], v[64:67]
    v_mfma_f32_16x16x32_bf16 v[68:71], v[232:235], a[244:247], v[68:71]
    v_mfma_f32_16x16x32_bf16 v[72:75], v[232:235], a[248:251], v[72:75]
    v_mfma_f32_16x16x32_bf16 v[76:79], v[232:235], a[252:255], v[76:79]
    v_mfma_f32_16x16x32_bf16 v[80:83], v[236:239], a[240:243], v[80:83]
    v_mfma_f32_16x16x32_bf16 v[84:87], v[236:239], a[244:247], v[84:87]
    v_mfma_f32_16x16x32_bf16 v[88:91], v[236:239], a[248:251], v[88:91]
    v_mfma_f32_16x16x32_bf16 v[92:95], v[236:239], a[252:255], v[92:95]
    s_nop 0
    ds_write_addtid_b32 v64 offset:0
    ds_write_addtid_b32 v68 offset:256
    v_mfma_f32_16x16x32_bf16 v[96:99], v[240:243], a[240:243], v[96:99]
    ds_write_addtid_b32 v72 offset:640
    ds_write_addtid_b32 v76 offset:896
    v_mfma_f32_16x16x32_bf16 v[100:103], v[240:243], a[244:247], v[100:103]
    ds_write_addtid_b32 v65 offset:1152
    ds_write_addtid_b32 v69 offset:1408
    v_mfma_f32_16x16x32_bf16 v[104:107], v[240:243], a[248:251], v[104:107]
    ds_write_addtid_b32 v73 offset:1792
    ds_write_addtid_b32 v77 offset:2048
    v_mfma_f32_16x16x32_bf16 v[108:111], v[240:243], a[252:255], v[108:111]
    ds_write_addtid_b32 v66 offset:2304
    ds_write_addtid_b32 v70 offset:2560
    v_mfma_f32_16x16x32_bf16 v[112:115], v[244:247], a[240:243], v[112:115]
    ds_write_addtid_b32 v74 offset:2944
    ds_write_addtid_b32 v78 offset:3200
    v_mfma_f32_16x16x32_bf16 v[116:119], v[244:247], a[244:247], v[116:119]
    ds_write_addtid_b32 v67 offset:3456
    ds_write_addtid_b32 v71 offset:3712
    v_mfma_f32_16x16x32_bf16 v[120:123], v[244:247], a[248:251], v[120:123]
    ds_write_addtid_b32 v75 offset:4096
    ds_write_addtid_b32 v79 offset:4352
    v_mfma_f32_16x16x32_bf16 v[124:127], v[244:247], a[252:255], v[124:127]
    ds_write_addtid_b32 v80 offset:4608
    ds_write_addtid_b32 v84 offset:4864
    v_mfma_f32_16x16x32_bf16 v[128:131], v[248:251], a[240:243], v[128:131]
    ds_write_addtid_b32 v88 offset:5248
    ds_write_addtid_b32 v92 offset:5504
    v_mfma_f32_16x16x32_bf16 v[132:135], v[248:251], a[244:247], v[132:135]
    ds_write_addtid_b32 v81 offset:5760
    ds_write_addtid_b32 v85 offset:6016
    v_mfma_f32_16x16x32_bf16 v[136:139], v[248:251], a[248:251], v[136:139]
    ds_write_addtid_b32 v89 offset:6400
    ds_write_addtid_b32 v93 offset:6656
    v_mfma_f32_16x16x32_bf16 v[140:143], v[248:251], a[252:255], v[140:143]
    ds_write_addtid_b32 v82 offset:6912
    ds_write_addtid_b32 v86 offset:7168
    ds_write_addtid_b32 v90 offset:7552
    ds_write_addtid_b32 v94 offset:7808
    ds_write_addtid_b32 v83 offset:32768
    ds_write_addtid_b32 v87 offset:33024
    ds_write_addtid_b32 v91 offset:33408
    ds_write_addtid_b32 v95 offset:33664
    ds_write_addtid_b32 v96 offset:33920
    ds_write_addtid_b32 v100 offset:34176
    ds_write_addtid_b32 v104 offset:34560
    ds_write_addtid_b32 v108 offset:34816
    ds_write_addtid_b32 v97 offset:35072
    ds_write_addtid_b32 v101 offset:35328
    ds_write_addtid_b32 v105 offset:35712
    ds_write_addtid_b32 v109 offset:35968
    ds_write_addtid_b32 v98 offset:36224
    ds_write_addtid_b32 v102 offset:36480
    ds_write_addtid_b32 v106 offset:36864
    ds_write_addtid_b32 v110 offset:37120
    ds_write_addtid_b32 v99 offset:37376
    ds_write_addtid_b32 v103 offset:37632
    ds_write_addtid_b32 v107 offset:38016
    ds_write_addtid_b32 v111 offset:38272
    ds_write_addtid_b32 v112 offset:38528
    ds_write_addtid_b32 v116 offset:38784
    ds_write_addtid_b32 v120 offset:39168
    ds_write_addtid_b32 v124 offset:39424
    ds_write_addtid_b32 v113 offset:39680
    ds_write_addtid_b32 v117 offset:39936
    ds_write_addtid_b32 v121 offset:40320
    ds_write_addtid_b32 v125 offset:40576
    s_add_u32 m0, s85, 36864
    s_nop 0
    s_nop 0
    ds_write_addtid_b32 v114 offset:28672
    ds_write_addtid_b32 v118 offset:28928
    ds_write_addtid_b32 v122 offset:29312
    ds_write_addtid_b32 v126 offset:29568
    ds_write_addtid_b32 v115 offset:29824
    ds_write_addtid_b32 v119 offset:30080
    ds_write_addtid_b32 v123 offset:30464
    ds_write_addtid_b32 v127 offset:30720
    ds_write_addtid_b32 v128 offset:30976
    ds_write_addtid_b32 v132 offset:31232
    ds_write_addtid_b32 v136 offset:31616
    ds_write_addtid_b32 v140 offset:31872
    ds_write_addtid_b32 v129 offset:32128
    ds_write_addtid_b32 v133 offset:32384
    ds_write_addtid_b32 v137 offset:32768
    ds_write_addtid_b32 v141 offset:33024
    ds_write_addtid_b32 v130 offset:33280
    ds_write_addtid_b32 v134 offset:33536
    ds_write_addtid_b32 v138 offset:33920
    ds_write_addtid_b32 v142 offset:34176
    ds_write_addtid_b32 v131 offset:34432
    ds_write_addtid_b32 v135 offset:34688
    ds_write_addtid_b32 v139 offset:35072
    ds_write_addtid_b32 v143 offset:35328
    s_cbranch_vccz L_t5_w
    s_nop 0
    ds_write_addtid_b32 v144 offset:35584
    ds_write_addtid_b32 v148 offset:35840
    ds_write_addtid_b32 v152 offset:36224
    ds_write_addtid_b32 v156 offset:36480
    ds_write_addtid_b32 v145 offset:61440
    ds_write_addtid_b32 v149 offset:61696
    ds_write_addtid_b32 v153 offset:62080
    ds_write_addtid_b32 v157 offset:62336
    ds_write_addtid_b32 v146 offset:62592
    ds_write_addtid_b32 v150 offset:62848
    ds_write_addtid_b32 v154 offset:63232
    ds_write_addtid_b32 v158 offset:63488
    ds_write_addtid_b32 v147 offset:63744
    ds_write_addtid_b32 v151 offset:64000
    ds_write_addtid_b32 v155 offset:64384
    ds_write_addtid_b32 v159 offset:64640
L_t5_w:
    s_waitcnt lgkmcnt(0)
    s_barrier
    ds_read_b128 v[160:163], v3 offset:0
    ds_read_b128 v[164:167], v3 offset:8192
    ds_read_b128 v[168:171], v3 offset:16384
    ds_read_b128 v[172:175], v3 offset:24576
    ds_read_b128 v[176:179], v4 offset:0
    ds_read_b128 v[180:183], v4 offset:8192
    ds_read_b128 v[184:187], v4 offset:16384
    ds_read_b128 v[188:191], v4 offset:24576
    ds_read_b128 v[192:195], v5 offset:0
    ds_read_b128 v[196:199], v5 offset:8192
    ds_read_b128 v[200:203], v5 offset:16384
    ds_read_b128 v[204:207], v5 offset:24576
    s_waitcnt lgkmcnt(8)
    s_nop 0
    v_pk_add_f32 v[40:41], v[40:41], v[160:161]
    v_pk_add_f32 v[42:43], v[42:43], v[162:163]
    v_pk_add_f32 v[40:41], v[40:41], v[164:165]
    v_pk_add_f32 v[42:43], v[42:43], v[166:167]
    v_pk_add_f32 v[40:41], v[40:41], v[168:169]
    v_pk_add_f32 v[42:43], v[42:43], v[170:171]
    v_pk_add_f32 v[40:41], v[40:41], v[172:173]
    v_pk_add_f32 v[42:43], v[42:43], v[174:175]
    s_mov_b32 exec_lo, s92
    buffer_store_dwordx4 v[40:43], v37, s[56:59], 0 offen sc1
    s_mov_b32 exec_lo, -1
    ds_read_b128 v[208:211], v6 offset:0
    ds_read_b128 v[212:215], v6 offset:8192
    ds_read_b128 v[216:219], v6 offset:16384
    ds_read_b128 v[220:223], v6 offset:24576
    s_waitcnt lgkmcnt(8)
    s_nop 0
    v_pk_add_f32 v[44:45], v[44:45], v[176:177]
    v_pk_add_f32 v[46:47], v[46:47], v[178:179]
    v_pk_add_f32 v[44:45], v[44:45], v[180:181]
    v_pk_add_f32 v[46:47], v[46:47], v[182:183]
    v_pk_add_f32 v[44:45], v[44:45], v[184:185]
    v_pk_add_f32 v[46:47], v[46:47], v[186:187]
    v_pk_add_f32 v[44:45], v[44:45], v[188:189]
    v_pk_add_f32 v[46:47], v[46:47], v[190:191]
    buffer_store_dwordx4 v[44:47], v11, s[56:59], 0 offen sc1
    ds_read_b128 v[224:227], v7 offset:0
    ds_read_b128 v[228:231], v7 offset:8192
    ds_read_b128 v[232:235], v7 offset:16384
    ds_read_b128 v[236:239], v7 offset:24576
    s_waitcnt lgkmcnt(8)
    s_nop 0
    v_pk_add_f32 v[48:49], v[48:49], v[192:193]
    v_pk_add_f32 v[50:51], v[50:51], v[194:195]
    v_pk_add_f32 v[48:49], v[48:49], v[196:197]
    v_pk_add_f32 v[50:51], v[50:51], v[198:199]
    v_pk_add_f32 v[48:49], v[48:49], v[200:201]
    v_pk_add_f32 v[50:51], v[50:51], v[202:203]
    v_pk_add_f32 v[48:49], v[48:49], v[204:205]
    v_pk_add_f32 v[50:51], v[50:51], v[206:207]
    buffer_store_dwordx4 v[48:51], v12, s[56:59], 0 offen sc1
    s_waitcnt lgkmcnt(4)
    s_nop 0
    v_pk_add_f32 v[52:53], v[52:53], v[208:209]
    v_pk_add_f32 v[54:55], v[54:55], v[210:211]
    v_pk_add_f32 v[52:53], v[52:53], v[212:213]
    v_pk_add_f32 v[54:55], v[54:55], v[214:215]
    v_pk_add_f32 v[52:53], v[52:53], v[216:217]
    v_pk_add_f32 v[54:55], v[54:55], v[218:219]
    v_pk_add_f32 v[52:53], v[52:53], v[220:221]
    v_pk_add_f32 v[54:55], v[54:55], v[222:223]
    buffer_store_dwordx4 v[52:55], v13, s[56:59], 0 offen sc1
    s_waitcnt lgkmcnt(0)
    s_nop 0
    v_pk_add_f32 v[56:57], v[56:57], v[224:225]
    v_pk_add_f32 v[58:59], v[58:59], v[226:227]
    v_pk_add_f32 v[56:57], v[56:57], v[228:229]
    v_pk_add_f32 v[58:59], v[58:59], v[230:231]
    v_pk_add_f32 v[56:57], v[56:57], v[232:233]
    v_pk_add_f32 v[58:59], v[58:59], v[234:235]
    v_pk_add_f32 v[56:57], v[56:57], v[236:237]
    v_pk_add_f32 v[58:59], v[58:59], v[238:239]
    buffer_store_dwordx4 v[56:59], v14, s[56:59], 0 offen sc1
    s_cbranch_vccz L_done
    ds_read_b128 v[240:243], v8 offset:0
    ds_read_b128 v[244:247], v8 offset:8192
    ds_read_b128 v[248:251], v8 offset:16384
    ds_read_b128 v[252:255], v8 offset:24576
    s_waitcnt lgkmcnt(0)
    v_pk_add_f32 v[60:61], v[60:61], v[240:241]
    v_pk_add_f32 v[62:63], v[62:63], v[242:243]
    v_pk_add_f32 v[60:61], v[60:61], v[244:245]
    v_pk_add_f32 v[62:63], v[62:63], v[246:247]
    v_pk_add_f32 v[60:61], v[60:61], v[248:249]
    v_pk_add_f32 v[62:63], v[62:63], v[250:251]
    v_pk_add_f32 v[60:61], v[60:61], v[252:253]
    v_pk_add_f32 v[62:63], v[62:63], v[254:255]
    s_mov_b32 exec_lo, s93
    buffer_store_dwordx4 v[60:63], v25, s[56:59], 0 offen sc1
    s_mov_b32 exec_lo, -1
L_done:
L_end:
    s_endpgm
L_sp_statF:
    s_mov_b32 s75, 20000
L_spl_statF:
    s_sleep 16
    buffer_load_dwordx2 v[30:31], v33, s[44:47], s87 offen sc1
    buffer_load_dwordx2 v[34:35], v37, s[44:47], s87 offen sc1
    buffer_load_dwordx2 v[38:39], v41, s[44:47], s87 offen sc1
    buffer_load_dwordx2 v[42:43], v45, s[44:47], s87 offen sc1
    buffer_load_dwordx2 v[46:47], v49, s[44:47], s87 offen sc1
    s_waitcnt vmcnt(0)
    v_xor_b32 v66, v31, v29
    v_bitop3_b32 v66, v35, v29, v66 bitop3:0xbe
    v_bitop3_b32 v66, v39, v29, v66 bitop3:0xbe
    v_bitop3_b32 v66, v43, v29, v66 bitop3:0xbe
    v_bitop3_b32 v66, v47, v29, v66 bitop3:0xbe
    v_cmp_ne_u32_e64 vcc, 0, v66
    s_cmp_eq_u32 s73, 1
    s_cselect_b64 vcc, vcc, 0
    s_nop 2
    s_cbranch_vccz L_ok_statF
    s_sub_u32 s75, s75, 1
    s_cmp_lg_u32 s75, 0
    s_cbranch_scc1 L_spl_statF
    s_branch L_ok_statF
L_sp_resF:
    s_mov_b32 s75, 20000
L_spl_resF:
    s_sleep 16
    s_nop 0
    v_accvgpr_read_b32 v74, a250
    v_accvgpr_read_b32 v75, a251
    v_accvgpr_read_b32 v76, a252
    buffer_load_dwordx2 a[116:117], v76, s[44:47], 0 offen offset:0 sc1
    buffer_load_dwordx2 a[118:119], v74, s[44:47], 0 offen offset:32 sc1
    buffer_load_dwordx2 a[120:121], v74, s[44:47], 0 offen offset:64 sc1
    buffer_load_dwordx2 a[122:123], v74, s[44:47], 0 offen offset:96 sc1
    buffer_load_dwordx2 a[124:125], v74, s[44:47], 0 offen offset:128 sc1
    buffer_load_dwordx2 a[126:127], v75, s[44:47], 0 offen offset:0 sc1
    s_waitcnt vmcnt(0)
    s_nop 0
    v_accvgpr_read_b32 v74, a117
    v_accvgpr_read_b32 v75, a119
    v_accvgpr_read_b32 v76, a121
    v_accvgpr_read_b32 v77, a123
    v_accvgpr_read_b32 v78, a125
    v_accvgpr_read_b32 v79, a127
    v_xor_b32_e64 v74, v74, v29
    v_bitop3_b32 v74, v75, v29, v74 bitop3:0xbe
    v_bitop3_b32 v74, v76, v29, v74 bitop3:0xbe
    v_bitop3_b32 v74, v77, v29, v74 bitop3:0xbe
    v_bitop3_b32 v74, v78, v29, v74 bitop3:0xbe
    v_bitop3_b32 v74, v79, v29, v74 bitop3:0xbe
    v_cmp_ne_u32_e64 vcc, 0, v74
    s_nop 4
    s_cbranch_vccz L_ok_resF
    s_sub_u32 s75, s75, 1
    s_cmp_lg_u32 s75, 0
    s_cbranch_scc1 L_spl_resF
    s_branch L_ok_resF
L_sp_statS:
    s_mov_b32 s75, 20000
L_spl_statS:
    s_sleep 16
    s_nop 0
    buffer_load_dwordx2 v[30:31], v33, s[44:47], s87 offen sc1
    buffer_load_dwordx2 v[34:35], v37, s[44:47], s87 offen sc1
    buffer_load_dwordx2 v[38:39], v41, s[44:47], s87 offen sc1
    buffer_load_dwordx2 v[42:43], v45, s[44:47], s87 offen sc1
    buffer_load_dwordx2 v[46:47], v49, s[44:47], s87 offen sc1
    buffer_load_dword v67, off, s[44:47], s93 sc1
    s_waitcnt vmcnt(0)
    v_xor_b32 v66, v31, v29
    v_bitop3_b32 v66, v35, v29, v66 bitop3:0xbe
    v_bitop3_b32 v66, v39, v29, v66 bitop3:0xbe
    v_bitop3_b32 v66, v43, v29, v66 bitop3:0xbe
    v_bitop3_b32 v66, v47, v29, v66 bitop3:0xbe
    v_bitop3_b32 v66, v67, v29, v66 bitop3:0xbe
    v_cmp_ne_u32_e64 vcc, 0, v66
    s_nop 4
    s_cbranch_vccz L_ok_statS
    s_sub_u32 s75, s75, 1
    s_cmp_lg_u32 s75, 0
    s_cbranch_scc1 L_spl_statS
    s_branch L_ok_statS
L_sp_resS:
    s_mov_b32 s75, 20000
L_spl_resS:
    s_sleep 16
    s_nop 0
    v_accvgpr_read_b32 v74, a250
    v_accvgpr_read_b32 v75, a251
    v_accvgpr_read_b32 v76, a252
    buffer_load_dwordx2 a[116:117], v76, s[44:47], 0 offen offset:0 sc1
    buffer_load_dwordx2 a[118:119], v74, s[44:47], 0 offen offset:32 sc1
    buffer_load_dwordx2 a[120:121], v74, s[44:47], 0 offen offset:64 sc1
    buffer_load_dwordx2 a[122:123], v74, s[44:47], 0 offen offset:96 sc1
    buffer_load_dwordx2 a[124:125], v74, s[44:47], 0 offen offset:128 sc1
    buffer_load_dwordx2 a[126:127], v75, s[44:47], 0 offen offset:0 sc1
    s_waitcnt vmcnt(0)
    s_nop 0
    v_accvgpr_read_b32 v74, a117
    v_accvgpr_read_b32 v75, a119
    v_accvgpr_read_b32 v76, a121
    v_accvgpr_read_b32 v77, a123
    v_accvgpr_read_b32 v78, a125
    v_accvgpr_read_b32 v79, a127
    v_xor_b32_e64 v74, v74, v29
    v_bitop3_b32 v74, v75, v29, v74 bitop3:0xbe
    v_bitop3_b32 v74, v76, v29, v74 bitop3:0xbe
    v_bitop3_b32 v74, v77, v29, v74 bitop3:0xbe
    v_bitop3_b32 v74, v78, v29, v74 bitop3:0xbe
    v_bitop3_b32 v74, v79, v29, v74 bitop3:0xbe
    v_cmp_ne_u32_e64 vcc, 0, v74
    s_nop 4
    s_cbranch_vccz L_ok_resS
    s_sub_u32 s75, s75, 1
    s_cmp_lg_u32 s75, 0
    s_cbranch_scc1 L_spl_resS
    s_branch L_ok_resS
L_sp_car:
    s_mov_b32 s75, 20000
L_spl_car:
    s_sleep 2
    s_nop 0
    buffer_load_dwordx4 v[116:119], v144, s[56:59], 0 offen sc1
    buffer_load_dwordx4 v[120:123], v145, s[56:59], 0 offen sc1
    buffer_load_dwordx4 v[124:127], v146, s[56:59], 0 offen sc1
    buffer_load_dwordx4 v[128:131], v147, s[56:59], 0 offen sc1
    buffer_load_dwordx4 v[132:135], v148, s[56:59], 0 offen sc1
    buffer_load_dwordx4 v[136:139], v149, s[56:59], 0 offen sc1
    buffer_load_dwordx4 v[140:143], v150, s[56:59], 0 offen sc1
    s_waitcnt vmcnt(0)
    v_mov_b32 v68, 0
    v_perm_b32 v69, v117, v116, s92
    v_perm_b32 v70, v119, v118, s93
    v_bitop3_b32 v69, v69, v70, v152 bitop3:0x56
    v_or_b32_e64 v68, v68, v69
    v_perm_b32 v69, v121, v120, s92
    v_perm_b32 v70, v123, v122, s93
    v_bitop3_b32 v69, v69, v70, v153 bitop3:0x56
    v_or_b32_e64 v68, v68, v69
    v_perm_b32 v69, v125, v124, s92
    v_perm_b32 v70, v127, v126, s93
    v_bitop3_b32 v69, v69, v70, v154 bitop3:0x56
    v_or_b32_e64 v68, v68, v69
    v_perm_b32 v69, v129, v128, s92
    v_perm_b32 v70, v131, v130, s93
    v_bitop3_b32 v69, v69, v70, v155 bitop3:0x56
    v_or_b32_e64 v68, v68, v69
    v_perm_b32 v69, v133, v132, s92
    v_perm_b32 v70, v135, v134, s93
    v_bitop3_b32 v69, v69, v70, v156 bitop3:0x56
    v_or_b32_e64 v68, v68, v69
    v_perm_b32 v69, v137, v136, s92
    v_perm_b32 v70, v139, v138, s93
    v_bitop3_b32 v69, v69, v70, v157 bitop3:0x56
    v_or_b32_e64 v68, v68, v69
    v_perm_b32 v69, v141, v140, s92
    v_perm_b32 v70, v143, v142, s93
    v_bitop3_b32 v69, v69, v70, v158 bitop3:0x56
    v_or_b32 v68, v68, v69
    v_cmp_ne_u32 vcc, 0, v68
    s_nop 4
    s_cbranch_vccz L_ok_car
    s_sub_u32 s75, s75, 1
    s_cmp_lg_u32 s75, 0
    s_cbranch_scc1 L_spl_car
    s_branch L_ok_car
L_sp_fla:
    s_mov_b32 s75, 20000
L_spl_fla:
    s_sleep 2
    buffer_load_dword v34, v33, s[44:47], s74 offen sc1
    s_waitcnt vmcnt(0)
    v_cmp_ne_u32_e64 vcc, v34, v29
    s_nop 0
    s_and_b64 vcc, vcc, s[94:95]
    s_nop 2
    s_cbranch_vccz L_ok_fla
    s_sub_u32 s75, s75, 1
    s_cmp_lg_u32 s75, 0
    s_cbranch_scc1 L_spl_fla
    s_branch L_ok_fla
L_sp_fl0:
    s_mov_b32 s75, 20000
L_spl_fl0:
    s_sleep 2
    buffer_load_dword v34, v33, s[44:47], s74 offen sc1
    s_waitcnt vmcnt(0)
    v_cmp_ne_u32_e64 vcc, v34, v29
    s_nop 0
    s_and_b64 vcc, vcc, s[94:95]
    s_nop 2
    s_cbranch_vccz L_ok_fl0
    s_sub_u32 s75, s75, 1
    s_cmp_lg_u32 s75, 0
    s_cbranch_scc1 L_spl_fl0
    s_branch L_ok_fl0
L_sp_fl1:
    s_mov_b32 s75, 20000
L_spl_fl1:
    s_sleep 2
    buffer_load_dword v34, v33, s[44:47], s74 offen sc1
    s_waitcnt vmcnt(0)
    v_cmp_ne_u32_e64 vcc, v34, v29
    s_nop 0
    s_and_b64 vcc, vcc, s[94:95]
    s_nop 2
    s_cbranch_vccz L_ok_fl1
    s_sub_u32 s75, s75, 1
    s_cmp_lg_u32 s75, 0
    s_cbranch_scc1 L_spl_fl1
    s_branch L_ok_fl1
L_helper:
    buffer_load_dwordx2 v[50:51], v88, s[36:39], 0 offen offset:0
    buffer_load_dwordx2 v[52:53], v88, s[36:39], 0 offen offset:256
    buffer_load_dwordx2 v[54:55], v88, s[36:39], 0 offen offset:512
    buffer_load_dwordx2 v[56:57], v88, s[36:39], 0 offen offset:768
    buffer_load_dwordx2 v[58:59], v88, s[36:39], 0 offen offset:1024
    s_sub_u32 s92, s2, 248
    s_min_u32 s92, s92, 8
    s_lshl_b32 s92, s92, 2
    s_add_u32 s3, s92, s64
    v_lshl_add_u32 v83, v74, 3, v75
    s_lshl_b32 s93, s3, 6
    v_lshl_add_u32 v83, v83, 1, s93
    s_mov_b32 s56, s6
    s_mov_b32 s57, s7
    s_mov_b32 s58, 1280
    s_mov_b32 s59, 0x20000
    buffer_load_ushort v176, v83, s[56:59], 0 offen offset:0
    buffer_load_ushort v216, v83, s[56:59], 0 offen offset:8
    s_mov_b32 s56, s8
    s_mov_b32 s57, s9
    s_mov_b32 s58, 1280
    s_mov_b32 s59, 0x20000
    buffer_load_ushort v177, v83, s[56:59], 0 offen offset:0
    buffer_load_ushort v217, v83, s[56:59], 0 offen offset:8
    s_mov_b32 s56, s18
    s_mov_b32 s57, s19
    s_mov_b32 s58, 1280
    s_mov_b32 s59, 0x20000
    buffer_load_ushort v178, v83, s[56:59], 0 offen offset:0
    buffer_load_ushort v218, v83, s[56:59], 0 offen offset:8
    s_waitcnt vmcnt(0) lgkmcnt(0)
    s_mul_i32 s72, s72, 1664525
    s_add_u32 s72, s72, 1013904223
    v_mov_b32 v29, s72
    v_lshlrev_b32_e64 v60, 16, v50
    v_and_b32 v61, 0xffff0000, v50
    v_lshlrev_b32_e64 v62, 16, v51
    v_and_b32 v63, 0xffff0000, v51
    v_lshlrev_b32_e64 v64, 16, v52
    v_and_b32 v65, 0xffff0000, v52
    v_lshlrev_b32_e64 v66, 16, v53
    v_and_b32 v67, 0xffff0000, v53
    v_lshlrev_b32_e64 v68, 16, v54
    v_and_b32 v69, 0xffff0000, v54
    v_lshlrev_b32_e64 v70, 16, v55
    v_and_b32 v71, 0xffff0000, v55
    v_lshlrev_b32_e64 v72, 16, v56
    v_and_b32 v73, 0xffff0000, v56
    v_lshlrev_b32_e64 v74, 16, v57
    v_and_b32 v75, 0xffff0000, v57
    v_lshlrev_b32_e64 v76, 16, v58
    v_and_b32 v77, 0xffff0000, v58
    v_lshlrev_b32_e64 v78, 16, v59
    v_and_b32 v79, 0xffff0000, v59
    v_add_f32 v50, v60, v61
    v_add_f32 v50, v50, v62
    v_add_f32 v50, v50, v63
    v_add_f32 v50, v50, v64
    v_add_f32 v50, v50, v65
    v_add_f32 v50, v50, v66
    v_add_f32 v50, v50, v67
    v_add_f32 v50, v50, v68
    v_add_f32 v50, v50, v69
    v_add_f32 v50, v50, v70
    v_add_f32 v50, v50, v71
    v_add_f32 v50, v50, v72
    v_add_f32 v50, v50, v73
    v_add_f32 v50, v50, v74
    v_add_f32 v50, v50, v75
    v_add_f32 v50, v50, v76
    v_add_f32 v50, v50, v77
    v_add_f32 v50, v50, v78
    v_add_f32 v50, v50, v79
    s_nop 1
    v_add_f32_dpp v50, v50, v50 quad_perm:[1,0,3,2] row_mask:0xf bank_mask:0xf
    s_nop 1
    v_add_f32_dpp v50, v50, v50 quad_perm:[2,3,0,1] row_mask:0xf bank_mask:0xf
    s_nop 1
    v_add_f32_dpp v50, v50, v50 row_half_mirror row_mask:0xf bank_mask:0xf
    s_nop 1
    v_add_f32_dpp v50, v50, v50 row_mirror row_mask:0xf bank_mask:0xf
    v_mov_b32 v51, v50
    s_nop 1
    v_permlane16_swap_b32 v50, v51
    v_add_f32_e64 v50, v50, v51
    v_mul_f32 v54, 0x3acccccd, v50
    v_sub_f32 v60, v60, v54
    v_sub_f32 v61, v61, v54
    v_sub_f32 v62, v62, v54
    v_sub_f32 v63, v63, v54
    v_sub_f32 v64, v64, v54
    v_sub_f32 v65, v65, v54
    v_sub_f32 v66, v66, v54
    v_sub_f32 v67, v67, v54
    v_sub_f32 v68, v68, v54
    v_sub_f32 v69, v69, v54
    v_sub_f32 v70, v70, v54
    v_sub_f32 v71, v71, v54
    v_sub_f32 v72, v72, v54
    v_sub_f32 v73, v73, v54
    v_sub_f32 v74, v74, v54
    v_sub_f32 v75, v75, v54
    v_sub_f32 v76, v76, v54
    v_sub_f32 v77, v77, v54
    v_sub_f32 v78, v78, v54
    v_sub_f32 v79, v79, v54
    v_mul_f32 v50, v60, v60
    v_fmac_f32 v50, v61, v61
    v_fmac_f32 v50, v62, v62
    v_fmac_f32 v50, v63, v63
    v_fmac_f32 v50, v64, v64
    v_fmac_f32 v50, v65, v65
    v_fmac_f32 v50, v66, v66
    v_fmac_f32 v50, v67, v67
    v_fmac_f32 v50, v68, v68
    v_fmac_f32 v50, v69, v69
    v_fmac_f32 v50, v70, v70
    v_fmac_f32 v50, v71, v71
    v_fmac_f32 v50, v72, v72
    v_fmac_f32 v50, v73, v73
    v_fmac_f32 v50, v74, v74
    v_fmac_f32 v50, v75, v75
    v_fmac_f32 v50, v76, v76
    v_fmac_f32 v50, v77, v77
    v_fmac_f32 v50, v78, v78
    v_fmac_f32_e64 v50, v79, v79
    s_nop 1
    v_add_f32_dpp v50, v50, v50 quad_perm:[1,0,3,2] row_mask:0xf bank_mask:0xf
    s_nop 1
    v_add_f32_dpp v50, v50, v50 quad_perm:[2,3,0,1] row_mask:0xf bank_mask:0xf
    s_nop 1
    v_add_f32_dpp v50, v50, v50 row_half_mirror row_mask:0xf bank_mask:0xf
    s_nop 1
    v_add_f32_dpp v50, v50, v50 row_mirror row_mask:0xf bank_mask:0xf
    v_mov_b32 v51, v50
    s_nop 1
    v_permlane16_swap_b32 v50, v51
    v_add_f32_e64 v50, v50, v51
    v_mul_f32 v50, 0x3acccccd, v50
    v_cvt_pk_bf16_f32 v50, v50, v50
    v_lshlrev_b32_e64 v50, 16, v50
    v_add_f32 v50, 0x3727c5ac, v50
    v_cvt_pk_bf16_f32 v50, v50, v50
    v_lshlrev_b32 v50, 16, v50
    v_sqrt_f32 v50, v50
    v_lshlrev_b32 v52, 3, v94
    v_mov_b32 v57, s72
    v_lshlrev_b32_e64 v94, 2, v0
    v_cvt_pk_bf16_f32 v56, v54, v50
    v_and_b32_e64 v53, 31, v0
    v_lshl_add_u32 v52, v53, 3, v52
    s_movk_i32 s93, 4096
    s_mov_b32 s94, 1
    s_mov_b32 s95, 1
    s_cmp_eq_u32 s3, 31
    s_cselect_b32 s95, 0xff, 1
    s_mov_b64 exec, s[94:95]
    buffer_store_dwordx2 v[56:57], v52, s[44:47], s93 offen sc1
    s_mov_b64 exec, -1
    s_cmp_ge_u32 s3, 20
    s_cbranch_scc1 L_nolam
    v_cmp_eq_u32 s[92:93], 1, v95
    v_cmp_eq_u32 s[94:95], 2, v95
    v_cmp_eq_u32 s[88:89], 3, v95
    v_lshlrev_b32 v176, 16, v176
    v_lshlrev_b32 v216, 16, v216
    v_lshlrev_b32 v177, 16, v177
    v_lshlrev_b32 v217, 16, v217
    v_lshlrev_b32 v178, 16, v178
    v_lshlrev_b32 v218, 16, v218
    v_mul_f32 v178, 0x3fb8aa3b, v178
    v_mul_f32 v218, 0x3fb8aa3b, v218
    v_exp_f32 v178, v178
    v_exp_f32 v218, v218
    v_mul_f32 v181, v176, v176
    v_mul_f32 v221, v216, v216
    v_cvt_pk_bf16_f32 v178, v178, v178
    v_cvt_pk_bf16_f32 v218, v218, v218
    v_fmac_f32 v181, v177, v177
    v_fmac_f32 v221, v217, v217
    v_lshlrev_b32 v178, 16, v178
    v_lshlrev_b32 v218, 16, v218
    v_rcp_f32 v181, v181
    v_rcp_f32 v221, v221
    v_mul_f32 v179, v178, v176
    v_mul_f32 v219, v218, v216
    v_mul_f32 v180, v178, v177
    v_mul_f32 v220, v218, v217
    v_mul_f32 v179, 0x3fb8aa3b, v179
    v_mul_f32 v219, 0x3fb8aa3b, v219
    v_mul_f32 v180, 0.15915494, v180
    v_mul_f32 v220, 0.15915494, v220
    v_exp_f32 v179, v179
    v_exp_f32 v219, v219
    v_rndne_f32 v178, v180
    v_rndne_f32 v218, v220
    v_sub_f32 v180, v180, v178
    v_sub_f32 v220, v220, v218
    v_cos_f32 v182, v180
    v_cos_f32 v222, v220
    v_sin_f32 v183, v180
    v_sin_f32 v223, v220
    v_add_f32 v181, v181, v181
    v_add_f32 v221, v221, v221
    v_mul_f32 v182, v182, v179
    v_mul_f32 v222, v222, v219
    v_mul_f32 v183, -v183, v179
    v_mul_f32 v223, -v223, v219
    v_add_f32 v178, -1.0, v182
    v_add_f32 v218, -1.0, v222
    v_mul_f32 v184, v178, v176
    v_mul_f32 v224, v218, v216
    v_mul_f32 v185, v178, v177
    v_mul_f32 v225, v218, v217
    v_fma_f32 v184, -v183, v177, v184
    v_fma_f32 v224, -v223, v217, v224
    v_fmac_f32 v185, v183, v176
    v_fmac_f32 v225, v223, v216
    v_mul_f32 v184, v184, v181
    v_mul_f32 v224, v224, v221
    v_mul_f32 v185, v185, v181
    v_mul_f32 v225, v225, v221
    v_pk_mul_f32 v[186:187], v[182:183], v[182:183] op_sel_hi:[1,0]
    v_pk_mul_f32 v[226:227], v[222:223], v[222:223] op_sel_hi:[1,0]
    v_pk_fma_f32 v[186:187], v[182:183], v[182:183], v[186:187] op_sel:[1,1,0] op_sel_hi:[0,1,1] neg_lo:[1,0,0]
    v_pk_fma_f32 v[226:227], v[222:223], v[222:223], v[226:227] op_sel:[1,1,0] op_sel_hi:[0,1,1] neg_lo:[1,0,0]
    v_pk_mul_f32 v[188:189], v[186:187], v[186:187] op_sel_hi:[1,0]
    v_pk_mul_f32 v[228:229], v[226:227], v[226:227] op_sel_hi:[1,0]
    v_pk_fma_f32 v[188:189], v[186:187], v[186:187], v[188:189] op_sel:[1,1,0] op_sel_hi:[0,1,1] neg_lo:[1,0,0]
    v_pk_fma_f32 v[228:229], v[226:227], v[226:227], v[228:229] op_sel:[1,1,0] op_sel_hi:[0,1,1] neg_lo:[1,0,0]
    v_pk_mul_f32 v[190:191], v[188:189], v[182:183] op_sel_hi:[1,0]
    v_pk_mul_f32 v[230:231], v[228:229], v[222:223] op_sel_hi:[1,0]
    v_pk_fma_f32 v[190:191], v[188:189], v[182:183], v[190:191] op_sel:[1,1,0] op_sel_hi:[0,1,1] neg_lo:[1,0,0]
    v_pk_fma_f32 v[230:231], v[228:229], v[222:223], v[230:231] op_sel:[1,1,0] op_sel_hi:[0,1,1] neg_lo:[1,0,0]
    v_pk_mul_f32 v[192:193], v[190:191], v[190:191] op_sel_hi:[1,0]
    v_pk_mul_f32 v[232:233], v[230:231], v[230:231] op_sel_hi:[1,0]
    v_pk_fma_f32 v[192:193], v[190:191], v[190:191], v[192:193] op_sel:[1,1,0] op_sel_hi:[0,1,1] neg_lo:[1,0,0]
    v_pk_fma_f32 v[232:233], v[230:231], v[230:231], v[232:233] op_sel:[1,1,0] op_sel_hi:[0,1,1] neg_lo:[1,0,0]
    v_pk_mul_f32 v[200:201], v[190:191], v[188:189] op_sel_hi:[1,0]
    v_pk_mul_f32 v[240:241], v[230:231], v[228:229] op_sel_hi:[1,0]
    v_pk_fma_f32 v[200:201], v[190:191], v[188:189], v[200:201] op_sel:[1,1,0] op_sel_hi:[0,1,1] neg_lo:[1,0,0]
    v_pk_fma_f32 v[240:241], v[230:231], v[228:229], v[240:241] op_sel:[1,1,0] op_sel_hi:[0,1,1] neg_lo:[1,0,0]
    v_pk_mul_f32 v[194:195], v[192:193], v[192:193] op_sel_hi:[1,0]
    v_pk_mul_f32 v[234:235], v[232:233], v[232:233] op_sel_hi:[1,0]
    v_pk_fma_f32 v[194:195], v[192:193], v[192:193], v[194:195] op_sel:[1,1,0] op_sel_hi:[0,1,1] neg_lo:[1,0,0]
    v_pk_fma_f32 v[234:235], v[232:233], v[232:233], v[234:235] op_sel:[1,1,0] op_sel_hi:[0,1,1] neg_lo:[1,0,0]
    v_pk_mul_f32 v[202:203], v[192:193], v[200:201] op_sel_hi:[1,0]
    v_pk_mul_f32 v[242:243], v[232:233], v[240:241] op_sel_hi:[1,0]
    v_pk_fma_f32 v[202:203], v[192:193], v[200:201], v[202:203] op_sel:[1,1,0] op_sel_hi:[0,1,1] neg_lo:[1,0,0]
    v_pk_fma_f32 v[242:243], v[232:233], v[240:241], v[242:243] op_sel:[1,1,0] op_sel_hi:[0,1,1] neg_lo:[1,0,0]
    v_pk_mul_f32 v[196:197], v[194:195], v[194:195] op_sel_hi:[1,0]
    v_pk_mul_f32 v[236:237], v[234:235], v[234:235] op_sel_hi:[1,0]
    v_pk_fma_f32 v[196:197], v[194:195], v[194:195], v[196:197] op_sel:[1,1,0] op_sel_hi:[0,1,1] neg_lo:[1,0,0]
    v_pk_fma_f32 v[236:237], v[234:235], v[234:235], v[236:237] op_sel:[1,1,0] op_sel_hi:[0,1,1] neg_lo:[1,0,0]
    v_pk_mul_f32 v[198:199], v[196:197], v[194:195] op_sel_hi:[1,0]
    v_pk_mul_f32 v[238:239], v[236:237], v[234:235] op_sel_hi:[1,0]
    v_pk_fma_f32 v[198:199], v[196:197], v[194:195], v[198:199] op_sel:[1,1,0] op_sel_hi:[0,1,1] neg_lo:[1,0,0]
    v_pk_fma_f32 v[238:239], v[236:237], v[234:235], v[238:239] op_sel:[1,1,0] op_sel_hi:[0,1,1] neg_lo:[1,0,0]
    v_pk_mul_f32 v[204:205], v[198:199], v[202:203] op_sel_hi:[1,0]
    v_pk_mul_f32 v[244:245], v[238:239], v[242:243] op_sel_hi:[1,0]
    v_pk_fma_f32 v[204:205], v[198:199], v[202:203], v[204:205] op_sel:[1,1,0] op_sel_hi:[0,1,1] neg_lo:[1,0,0]
    v_pk_fma_f32 v[244:245], v[238:239], v[242:243], v[244:245] op_sel:[1,1,0] op_sel_hi:[0,1,1] neg_lo:[1,0,0]
    v_pk_mul_f32 v[206:207], v[204:205], v[204:205] op_sel_hi:[1,0]
    v_pk_mul_f32 v[246:247], v[244:245], v[244:245] op_sel_hi:[1,0]
    v_pk_fma_f32 v[206:207], v[204:205], v[204:205], v[206:207] op_sel:[1,1,0] op_sel_hi:[0,1,1] neg_lo:[1,0,0]
    v_pk_fma_f32 v[246:247], v[244:245], v[244:245], v[246:247] op_sel:[1,1,0] op_sel_hi:[0,1,1] neg_lo:[1,0,0]
    v_pk_mul_f32 v[208:209], v[206:207], v[204:205] op_sel_hi:[1,0]
    v_pk_mul_f32 v[248:249], v[246:247], v[244:245] op_sel_hi:[1,0]
    v_pk_fma_f32 v[208:209], v[206:207], v[204:205], v[208:209] op_sel:[1,1,0] op_sel_hi:[0,1,1] neg_lo:[1,0,0]
    v_pk_fma_f32 v[248:249], v[246:247], v[244:245], v[248:249] op_sel:[1,1,0] op_sel_hi:[0,1,1] neg_lo:[1,0,0]
    v_pk_mul_f32 v[210:211], v[206:207], v[206:207] op_sel_hi:[1,0]
    v_pk_mul_f32 v[250:251], v[246:247], v[246:247] op_sel_hi:[1,0]
    v_pk_fma_f32 v[210:211], v[206:207], v[206:207], v[210:211] op_sel:[1,1,0] op_sel_hi:[0,1,1] neg_lo:[1,0,0]
    v_pk_fma_f32 v[250:251], v[246:247], v[246:247], v[250:251] op_sel:[1,1,0] op_sel_hi:[0,1,1] neg_lo:[1,0,0]
    v_cndmask_b32 v186, 1.0, v194, s[92:93]
    v_cndmask_b32 v226, 1.0, v234, s[92:93]
    v_cndmask_b32 v186, v186, v196, s[94:95]
    v_cndmask_b32 v226, v226, v236, s[94:95]
    v_cndmask_b32 v186, v186, v198, s[88:89]
    v_cndmask_b32 v226, v226, v238, s[88:89]
    v_cndmask_b32 v187, 0, v195, s[92:93]
    v_cndmask_b32 v227, 0, v235, s[92:93]
    v_cndmask_b32 v187, v187, v197, s[94:95]
    v_cndmask_b32 v227, v227, v237, s[94:95]
    v_cndmask_b32 v187, v187, v199, s[88:89]
    v_cndmask_b32 v227, v227, v239, s[88:89]
    v_cndmask_b32 v188, 1.0, v204, s[92:93]
    v_cndmask_b32 v228, 1.0, v244, s[92:93]
    v_cndmask_b32 v188, v188, v206, s[94:95]
    v_cndmask_b32 v228, v228, v246, s[94:95]
    v_cndmask_b32 v188, v188, v208, s[88:89]
    v_cndmask_b32 v228, v228, v248, s[88:89]
    v_cndmask_b32 v189, 0, v205, s[92:93]
    v_cndmask_b32 v229, 0, v245, s[92:93]
    v_cndmask_b32 v189, v189, v207, s[94:95]
    v_cndmask_b32 v229, v229, v247, s[94:95]
    v_cndmask_b32 v189, v189, v209, s[88:89]
    v_cndmask_b32 v229, v229, v249, s[88:89]
    v_mov_b32 v96, v182
    v_mov_b32 v108, v222
    v_mov_b32 v97, v183
    v_mov_b32 v109, v223
    v_mov_b32 v98, v184
    v_mov_b32 v110, v224
    v_mov_b32 v99, v185
    v_mov_b32 v111, v225
    v_mov_b32 v100, v194
    v_mov_b32 v112, v234
    v_mov_b32 v101, v195
    v_mov_b32 v113, v235
    v_mov_b32 v102, v186
    v_mov_b32 v114, v226
    v_mov_b32 v103, v187
    v_mov_b32 v115, v227
    v_mov_b32 v104, v188
    v_mov_b32 v116, v228
    v_mov_b32 v105, v189
    v_mov_b32 v117, v229
    v_mov_b32 v106, v210
    v_mov_b32 v118, v250
    v_mov_b32 v107, v211
    v_mov_b32 v119, v251
    s_mul_i32 s94, s3, 6144
    s_add_u32 s94, s94, 724992
    s_add_u32 s95, s94, 4096
    s_lshl_b32 s93, s3, 7
    s_add_u32 s93, s93, 720896
    v_lshlrev_b32 v68, 4, v0
    buffer_store_dwordx4 v[96:99], v68, s[44:47], s94 offen offset:0 sc1
    buffer_store_dwordx4 v[100:103], v68, s[44:47], s94 offen offset:1024 sc1
    buffer_store_dwordx4 v[104:107], v68, s[44:47], s94 offen offset:2048 sc1
    buffer_store_dwordx4 v[108:111], v68, s[44:47], s94 offen offset:3072 sc1
    buffer_store_dwordx4 v[112:115], v68, s[44:47], s95 offen offset:0 sc1
    buffer_store_dwordx4 v[116:119], v68, s[44:47], s95 offen offset:1024 sc1
    s_waitcnt vmcnt(0)
    s_mov_b32 exec_hi, 0
    buffer_store_dword v29, v94, s[44:47], s93 offen sc1
    s_mov_b32 exec_hi, -1
L_nolam:
    s_lshl_b32 s92, s3, 13
    v_lshl_add_u32 v66, v0, 7, s92
    v_add_u32 v67, 737280, v66
    buffer_load_dword v68, v67, s[96:99], 0 offen
    v_add_u32 v67, 1032192, v66
    buffer_load_dword v68, v67, s[96:99], 0 offen
    v_add_u32 v67, 1327104, v66
    buffer_load_dword v68, v67, s[96:99], 0 offen
    v_add_u32 v67, 1622016, v66
    buffer_load_dword v68, v67, s[96:99], 0 offen
    v_add_u32 v67, 1916928, v66
    buffer_load_dword v68, v67, s[96:99], 0 offen
    v_add_u32_e64 v67, 0, v66
    buffer_load_dword v68, v67, s[96:99], 0 offen
    v_add_u32 v67, 294912, v66
    buffer_load_dword v68, v67, s[96:99], 0 offen
    v_add_u32 v67, 589824, v66
    buffer_load_dword v68, v67, s[96:99], 0 offen
    s_waitcnt vmcnt(0)
    s_mov_b32 s56, s20
    s_mov_b32 s57, s21
    s_mov_b32 s58, 1280
    s_mov_b32 s59, 0x20000
    s_mov_b32 s80, 0
    s_mov_b32 s81, 0
    s_mov_b32 m0, s85
    s_branch L_kjoin
L_janitor:
    v_lshlrev_b32 v1, 4, v0
    v_add_u32 v1, 4096, v1
    s_mov_b32 s75, 20000
L_jan:
    s_mov_b32 s92, 0
    s_nop 0
    buffer_load_dwordx4 v[96:99], v1, s[44:47], s92 offen offset:0 sc1
    buffer_load_dwordx4 v[100:103], v1, s[44:47], s92 offen offset:1024 sc1
    buffer_load_dwordx4 v[104:107], v1, s[44:47], s92 offen offset:2048 sc1
    buffer_load_dwordx4 v[108:111], v1, s[44:47], s92 offen offset:3072 sc1
    s_add_u32 s92, s92, 4096
    buffer_load_dwordx4 v[112:115], v1, s[44:47], s92 offen offset:0 sc1
    buffer_load_dwordx4 v[116:119], v1, s[44:47], s92 offen offset:1024 sc1
    buffer_load_dwordx4 v[120:123], v1, s[44:47], s92 offen offset:2048 sc1
    buffer_load_dwordx4 v[124:127], v1, s[44:47], s92 offen offset:3072 sc1
    s_add_u32 s92, s92, 4096
    buffer_load_dwordx4 v[128:131], v1, s[44:47], s92 offen offset:0 sc1
    buffer_load_dwordx4 v[132:135], v1, s[44:47], s92 offen offset:1024 sc1
    buffer_load_dwordx4 v[136:139], v1, s[44:47], s92 offen offset:2048 sc1
    buffer_load_dwordx4 v[140:143], v1, s[44:47], s92 offen offset:3072 sc1
    s_add_u32 s92, s92, 4096
    buffer_load_dwordx4 v[144:147], v1, s[44:47], s92 offen offset:0 sc1
    buffer_load_dwordx4 v[148:151], v1, s[44:47], s92 offen offset:1024 sc1
    buffer_load_dwordx4 v[152:155], v1, s[44:47], s92 offen offset:2048 sc1
    buffer_load_dwordx4 v[156:159], v1, s[44:47], s92 offen offset:3072 sc1
    s_add_u32 s92, s92, 4096
    s_waitcnt vmcnt(0)
    v_xor_b32 v2, v97, v29
    v_bitop3_b32 v2, v99, v29, v2 bitop3:0xbe
    v_bitop3_b32 v2, v101, v29, v2 bitop3:0xbe
    v_bitop3_b32 v2, v103, v29, v2 bitop3:0xbe
    v_bitop3_b32 v2, v105, v29, v2 bitop3:0xbe
    v_bitop3_b32 v2, v107, v29, v2 bitop3:0xbe
    v_bitop3_b32 v2, v109, v29, v2 bitop3:0xbe
    v_bitop3_b32 v2, v111, v29, v2 bitop3:0xbe
    v_bitop3_b32 v2, v113, v29, v2 bitop3:0xbe
    v_bitop3_b32 v2, v115, v29, v2 bitop3:0xbe
    v_bitop3_b32 v2, v117, v29, v2 bitop3:0xbe
    v_bitop3_b32 v2, v119, v29, v2 bitop3:0xbe
    v_bitop3_b32 v2, v121, v29, v2 bitop3:0xbe
    v_bitop3_b32 v2, v123, v29, v2 bitop3:0xbe
    v_bitop3_b32 v2, v125, v29, v2 bitop3:0xbe
    v_bitop3_b32 v2, v127, v29, v2 bitop3:0xbe
    v_bitop3_b32 v2, v129, v29, v2 bitop3:0xbe
    v_bitop3_b32 v2, v131, v29, v2 bitop3:0xbe
    v_bitop3_b32 v2, v133, v29, v2 bitop3:0xbe
    v_bitop3_b32 v2, v135, v29, v2 bitop3:0xbe
    v_bitop3_b32 v2, v137, v29, v2 bitop3:0xbe
    v_bitop3_b32 v2, v139, v29, v2 bitop3:0xbe
    v_bitop3_b32 v2, v141, v29, v2 bitop3:0xbe
    v_bitop3_b32 v2, v143, v29, v2 bitop3:0xbe
    v_bitop3_b32 v2, v145, v29, v2 bitop3:0xbe
    v_bitop3_b32 v2, v147, v29, v2 bitop3:0xbe
    v_bitop3_b32 v2, v149, v29, v2 bitop3:0xbe
    v_bitop3_b32 v2, v151, v29, v2 bitop3:0xbe
    v_bitop3_b32 v2, v153, v29, v2 bitop3:0xbe
    v_bitop3_b32 v2, v155, v29, v2 bitop3:0xbe
    v_bitop3_b32 v2, v157, v29, v2 bitop3:0xbe
    v_bitop3_b32 v2, v159, v29, v2 bitop3:0xbe
    v_cmp_ne_u32 vcc, 0, v2
    s_nop 4
    s_cbranch_vccz L_jan2
    s_sleep 40
    s_sub_u32 s75, s75, 1
    s_cmp_lg_u32 s75, 0
    s_cbranch_scc1 L_jan
L_jan2:
    s_mov_b64 exec, 1
    buffer_store_dword v29, off, s[44:47], 0 sc1
    s_mov_b64 exec, -1
L_last:
    s_branch L_janret
.section .rodata,"a"
.p2align 6
.amdhsa_kernel parallel_sum__ssm_conv_s5__swiglu_ffn__prompt_kernel
  .amdhsa_next_free_vgpr 512
  .amdhsa_next_free_sgpr 102
  .amdhsa_accum_offset 256
  .amdhsa_group_segment_fixed_size 0
  .amdhsa_kernarg_size 128
  .amdhsa_user_sgpr_count 2
  .amdhsa_user_sgpr_kernarg_segment_ptr 1
  .amdhsa_system_sgpr_workgroup_id_x 1
  .amdhsa_float_denorm_mode_32 3
.end_amdhsa_kernel
```
